```python
import torch

def _softmax(x, axis=-1):
    return torch.softmax(x, dim=axis)

def _gelu(x):
    return torch.nn.functional.gelu(x, approximate='tanh')

def _silu(x):
    return torch.nn.functional.silu(x)

def _sigmoid(x):
    return torch.sigmoid(x)

def _layernorm(x, axis=-1, eps=1e-05):
    m = x.mean(dim=axis, keepdim=True)
    v = x.var(dim=axis, keepdim=True, unbiased=False)
    return (x - m) / torch.sqrt(v + eps)

def _scatter_add(tgt, idx, src, axis=0):
    return tgt.clone().index_add_(axis, idx, src)

def _segment_sum(src, seg, n):
    out = torch.zeros((n,) + src.shape[1:], dtype=src.dtype)
    return out.index_add_(0, seg, src)

def _pad(x, pw):
    flat = tuple((v for pair in reversed(pw) for v in pair))
    return torch.nn.functional.pad(x, flat)
kernel_name = 'parallel_sum__memory_aug_recurrent_mem_tr__dense_activation_mish__prompt'

def setup_inputs():

    _w = lambda a: (lambda t: t.to(torch.bfloat16) if t.is_floating_point() else t)(torch.as_tensor(a))

    def _A_setup():
        B, S, Dm = (1, 2048, 512)
        H, Dh = (32, 128)
        M, seg = (8, 32)
        seg = min(seg, S)
        S = S // seg * seg
        return {'x': _w((lambda *s: torch.randn(*s, dtype=torch.bfloat16) * 0.05)(B, S, Dm)), 'mem0': _w((lambda *s: torch.randn(*s, dtype=torch.bfloat16) * 0.2)(B, M, Dm)), 'Wq': _w((lambda *s: torch.randn(*s, dtype=torch.bfloat16) * 1.6)(Dm, H, Dh) * Dm ** (-0.5)), 'Wk': _w((lambda *s: torch.randn(*s, dtype=torch.bfloat16) * 1.6)(Dm, H, Dh) * Dm ** (-0.5)), 'Wv': _w((lambda *s: torch.randn(*s, dtype=torch.bfloat16) * 0.2)(Dm, H, Dh) * Dm ** (-0.5)), 'Wo': _w((lambda *s: torch.randn(*s, dtype=torch.bfloat16) * 0.2)(H, Dh, Dm) * (H * Dh) ** (-0.5)), 'seg_len': seg}
    _A_in = _A_setup()

    def _B_setup():
        B, S, D, F = (1, 2048, 512, 1792)
        return {'x': _w((lambda *s: torch.randn(*s, dtype=torch.bfloat16) * 0.05)(B, S, D)), 'w1': _w((lambda *s: torch.randn(*s, dtype=torch.bfloat16) * 0.8)(D, F) * D ** (-0.5)), 'b1': _w((lambda *s: torch.randn(*s, dtype=torch.bfloat16) * 0.2)(F)), 'w2': _w((lambda *s: torch.randn(*s, dtype=torch.bfloat16) * 0.1)(F, D) * F ** (-0.5))}
    _B_in = _B_setup()
    return {'A_x': _A_in['x'], 'A_mem0': _A_in['mem0'], 'A_Wq': _A_in['Wq'], 'A_Wk': _A_in['Wk'], 'A_Wv': _A_in['Wv'], 'A_Wo': _A_in['Wo'], 'A_seg_len': _A_in['seg_len'], 'B_x': _B_in['x'], 'B_w1': _B_in['w1'], 'B_b1': _B_in['b1'], 'B_w2': _B_in['w2']}

def reference(A_x, A_mem0, A_Wq, A_Wk, A_Wv, A_Wo, A_seg_len, B_x, B_w1, B_b1, B_w2):

    def _A_ref(x, mem0, Wq, Wk, Wv, Wo, seg_len):
        B, S, Dm = x.shape
        H, Dh = (Wq.shape[1], Wq.shape[2])
        M = mem0.shape[1]
        scale = Dh ** (-0.5)
        n_seg = S // seg_len
        L = M + seg_len
        idx = torch.arange(L)
        mask = (idx[:, None] < M) | (idx[:, None] >= idx[None, :])
        mem = mem0
        outs = []
        for s in range(n_seg):
            xs = x[:, s * seg_len:(s + 1) * seg_len, :].clone()
            h = torch.concatenate([mem, xs], axis=1)
            q = torch.einsum('btd,dhe->bhte', h, Wq)
            k = torch.einsum('btd,dhe->bhte', h, Wk)
            v = torch.einsum('btd,dhe->bhte', h, Wv)
            scores = torch.einsum('bhqe,bhke->bhqk', q, k) * scale
            scores = torch.where(mask[None, None], scores, -1000000000.0)
            p = _softmax(scores, axis=-1)
            o = torch.einsum('bhqk,bhke->bhqe', p, v)
            o = torch.einsum('bhte,hed->btd', o, Wo)
            mem = o[:, :M, :].clone()
            outs.append(o[:, M:, :])
        return torch.concatenate(outs, axis=1)

    def _B_ref(x, w1, b1, w2):
        h = torch.einsum('bsd,df->bsf', x, w1) + b1
        sp = torch.log1p(torch.exp(-torch.abs(h))) + torch.where(h > 0, h, torch.zeros_like(h))
        act = h * torch.tanh(sp)
        return torch.einsum('bsf,fd->bsd', act, w2)
    x = A_x
    xn = _layernorm(x, axis=-1)
    return x + _A_ref(xn, A_mem0, A_Wq, A_Wk, A_Wv, A_Wo, A_seg_len) + _B_ref(xn, B_w1, B_b1, B_w2)
```

```asm
; @launch grid=(256,1,1) block=(256,1,1) lds=163840
.amdgcn_target "amdgcn-amd-amdhsa--gfx950"
.text
.globl parallel_sum__memory_aug_recurrent_mem_tr__dense_activation_mish__prompt_kernel
.p2align 8
.type parallel_sum__memory_aug_recurrent_mem_tr__dense_activation_mish__prompt_kernel,@function
parallel_sum__memory_aug_recurrent_mem_tr__dense_activation_mish__prompt_kernel:
    s_cmp_ge_u32 s2, 256
    s_cbranch_scc1 L_end
    s_nop 0
    s_load_dwordx2 s[52:53], s[0:1], 96
    s_load_dwordx2 s[8:9], s[0:1], 104
    s_getreg_b32 s6, hwreg(HW_REG_XCC_ID, 0, 4)
    s_and_b32 s6, s6, 7
    v_lshrrev_b32 v1, 6, v0
    s_nop 0
    v_readfirstlane_b32 s5, v1
    s_waitcnt lgkmcnt(0)
    s_and_b32 s9, s9, 0xffff
    s_mov_b32 s10, 268435456
    s_mov_b32 s11, 0x20000
    s_and_b32 s53, s53, 0xffff
    s_mov_b32 s54, 256
    s_mov_b32 s55, 0x20000
    s_cmp_eq_u32 s5, 0
    s_cbranch_scc0 L_ticket
    v_mov_b32 v1, 1
    v_mov_b32 v2, 0
    s_lshl_b32 s3, s6, 2
    s_mov_b64 exec, 1
    buffer_atomic_add v1, off, s[52:55], s3 sc0 sc1
    s_waitcnt vmcnt(0)
    ds_write_b32 v2, v1
    s_waitcnt lgkmcnt(0)
    s_mov_b64 exec, -1
L_ticket:
    s_barrier
    v_mov_b32_e64 v2, 0
    ds_read_b32 v1, v2
    s_waitcnt lgkmcnt(0)
    v_readfirstlane_b32 s4, v1
    s_nop 3
    s_barrier
    s_cmp_ge_u32 s4, 32
    s_cbranch_scc1 L_end
    s_cmp_eq_u32 s6, 0
    s_cbranch_scc0 L_worker
    s_mov_b32 s17, 0
    v_and_b32 v100, 63, v0
    v_and_b32 v101, 15, v100
    v_lshrrev_b32 v102, 4, v100
    v_mov_b32 v20, -1
    v_mov_b32 v21, -1
    v_mov_b32 v22, -1
    v_mov_b32_e64 v23, -1
    s_lshl_b32 s41, s4, 13
    s_lshl_b32 s42, s5, 11
    s_add_u32 s41, s41, s42
    s_add_u32 s41, s41, 60817408
    s_add_u32 s42, s41, 262144
    v_lshlrev_b32_e64 v103, 4, v100
    buffer_store_dwordx4 v[20:23], v103, s[8:11], s41 offen offset:0
    buffer_store_dwordx4 v[20:23], v103, s[8:11], s41 offen offset:1024
    v_lshlrev_b32 v103, 13, v102
    v_lshlrev_b32 v104, 4, v101
    v_add_u32_e64 v103, v103, v104
    v_mov_b32 v104, 0x7ff00000
    v_cmp_gt_u32 vcc, 32, v100
    s_nop 1
    v_cndmask_b32 v103, v104, v103, vcc
    s_lshl_b32 s41, s4, 8
    s_add_u32 s41, s41, 61341696
    buffer_store_dwordx4 v[20:23], v103, s[8:11], s41 offen
    s_load_dwordx2 s[56:57], s[0:1], 8
    s_load_dwordx2 s[58:59], s[0:1], 16
    s_load_dwordx2 s[60:61], s[0:1], 24
    s_load_dwordx2 s[62:63], s[0:1], 32
    s_load_dwordx2 s[64:65], s[0:1], 40
    v_and_b32 v103, 3, v0
    v_lshlrev_b32 v103, 11, v103
    v_bfe_u32 v104, v0, 2, 1
    v_lshlrev_b32 v104, 6, v104
    v_add_u32 v103, v103, v104
    v_bfe_u32 v104, v0, 3, 4
    v_lshlrev_b32 v104, 1, v104
    v_add_u32 v103, v103, v104
    v_lshrrev_b32 v104, 7, v0
    v_lshlrev_b32 v104, 7, v104
    v_add_u32_e64 v103, v103, v104
    s_waitcnt lgkmcnt(0)
    s_mov_b32 s48, s56
    s_and_b32 s49, s57, 0xffff
    s_mov_b32 s50, 8192
    s_mov_b32 s51, 0x20000
    buffer_load_ushort v64, v103, s[48:51], 0 offen offset:0
    buffer_load_ushort v65, v103, s[48:51], 0 offen offset:32
    buffer_load_ushort v66, v103, s[48:51], 0 offen offset:1024
    buffer_load_ushort v67, v103, s[48:51], 0 offen offset:1056
    buffer_load_ushort v68, v103, s[48:51], 0 offen offset:256
    buffer_load_ushort v69, v103, s[48:51], 0 offen offset:288
    buffer_load_ushort v70, v103, s[48:51], 0 offen offset:1280
    buffer_load_ushort v71, v103, s[48:51], 0 offen offset:1312
    buffer_load_ushort v72, v103, s[48:51], 0 offen offset:512
    buffer_load_ushort v73, v103, s[48:51], 0 offen offset:544
    buffer_load_ushort v74, v103, s[48:51], 0 offen offset:1536
    buffer_load_ushort v75, v103, s[48:51], 0 offen offset:1568
    buffer_load_ushort v76, v103, s[48:51], 0 offen offset:768
    buffer_load_ushort v77, v103, s[48:51], 0 offen offset:800
    buffer_load_ushort v78, v103, s[48:51], 0 offen offset:1792
    buffer_load_ushort v79, v103, s[48:51], 0 offen offset:1824
    s_mov_b32 s68, s60
    s_nop 0
    s_and_b32 s69, s61, 0xffff
    s_mov_b32 s70, 0x400000
    s_mov_b32 s71, 0x20000
    s_mov_b32 s72, s62
    s_nop 0
    s_and_b32 s73, s63, 0xffff
    s_mov_b32 s74, 0x400000
    s_mov_b32 s75, 0x20000
    s_mov_b32 s76, s64
    s_nop 0
    s_and_b32 s77, s65, 0xffff
    s_mov_b32 s78, 0x400000
    s_mov_b32 s79, 0x20000
    s_mov_b32 s80, s58
    s_nop 0
    s_and_b32 s81, s59, 0xffff
    s_mov_b32 s82, 0x400000
    s_mov_b32 s83, 0x20000
    s_and_b32 s41, s5, 1
    s_lshl_b32 s41, s41, 3
    v_and_b32 v103, 1, v102
    v_lshlrev_b32 v103, 1, v103
    v_or_b32 v103, s41, v103
    v_xor_b32 v103, v103, v101
    s_lshl_b32 s42, s5, 4
    s_lshl_b32 s43, s4, 8
    v_xor_b32 v104, 0, v103
    v_lshlrev_b32 v104, 4, v104
    v_add_u32 v105, s42, v102
    v_add_u32 v105, 0, v105
    v_lshlrev_b32 v24, 13, v105
    v_add_u32 v24, v24, v104
    v_add_u32 v24, s43, v24
    v_lshlrev_b32 v28, 10, v105
    v_add_u32 v28, v28, v104
    v_xor_b32 v104, 4, v103
    v_lshlrev_b32 v104, 4, v104
    v_add_u32 v105, s42, v102
    v_add_u32 v105, 4, v105
    v_lshlrev_b32 v25, 13, v105
    v_add_u32 v25, v25, v104
    v_add_u32 v25, s43, v25
    v_lshlrev_b32 v29, 10, v105
    v_add_u32 v29, v29, v104
    v_xor_b32 v104, 0, v103
    v_lshlrev_b32 v104, 4, v104
    v_add_u32 v105, s42, v102
    v_add_u32 v105, 8, v105
    v_lshlrev_b32 v26, 13, v105
    v_add_u32 v26, v26, v104
    v_add_u32 v26, s43, v26
    v_lshlrev_b32 v30, 10, v105
    v_add_u32 v30, v30, v104
    v_xor_b32 v104, 4, v103
    v_lshlrev_b32 v104, 4, v104
    v_add_u32 v105, s42, v102
    v_add_u32 v105, 12, v105
    v_lshlrev_b32 v27, 13, v105
    v_add_u32 v27, v27, v104
    v_add_u32 v27, s43, v27
    v_lshlrev_b32 v31, 10, v105
    v_add_u32 v31, v31, v104
    v_lshrrev_b32 v103, 2, v101
    v_and_b32 v104, 3, v101
    v_lshrrev_b32 v105, 1, v102
    v_lshlrev_b32 v32, 5, v105
    v_and_b32 v105, 1, v102
    v_lshlrev_b32 v33, 2, v105
    v_add_u32 v32, v32, v33
    v_lshrrev_b32 v105, 1, v103
    v_lshlrev_b32 v34, 4, v105
    v_add_u32 v32, v32, v34
    v_lshlrev_b32 v34, 3, v105
    v_add_u32 v33, v33, v34
    v_and_b32 v105, 1, v103
    v_add_u32 v32, v32, v105
    v_lshlrev_b32 v34, 1, v105
    v_add_u32 v33, v33, v34
    v_lshlrev_b32 v32, 8, v32
    v_lshlrev_b32 v34, 3, v104
    v_add_u32 v32, v32, v34
    v_lshlrev_b32 v33, 4, v33
    s_lshl_b32 s41, s5, 6
    s_add_u32 s41, s41, 0
    v_xor_b32 v35, s41, v33
    v_add_u32 v35, v35, v32
    s_lshl_b32 s41, s5, 6
    s_add_u32 s41, s41, 32
    v_xor_b32 v36, s41, v33
    v_add_u32 v36, v36, v32
    s_lshl_b32 s41, s5, 12
    v_lshlrev_b32 v103, 4, v100
    v_add_u32_e64 v2, s41, v103
    v_add_u32 v3, 0x10000, v2
    v_add_u32 v4, 131072, v103
    s_lshl_b32 s41, s5, 12
    s_add_u32 m0, s41, 0
    s_mov_b32 s42, 0
    buffer_load_dwordx4 v24, s[68:71], s42 offen lds
    s_lshl_b32 s41, s5, 12
    s_add_u32 m0, s41, 1024
    s_mov_b32 s42, 0
    buffer_load_dwordx4 v25, s[68:71], s42 offen lds
    s_lshl_b32 s41, s5, 12
    s_add_u32 m0, s41, 2048
    s_mov_b32 s42, 0
    buffer_load_dwordx4 v26, s[68:71], s42 offen lds
    s_lshl_b32 s41, s5, 12
    s_add_u32 m0, s41, 3072
    s_mov_b32 s42, 0
    buffer_load_dwordx4 v27, s[68:71], s42 offen lds
    s_lshl_b32 s41, s5, 12
    s_add_u32 m0, s41, 16384
    s_mov_b32 s42, 524288
    buffer_load_dwordx4 v24, s[68:71], s42 offen lds
    s_lshl_b32 s41, s5, 12
    s_nop 0
    s_add_u32 m0, s41, 17408
    s_mov_b32 s42, 524288
    buffer_load_dwordx4 v25, s[68:71], s42 offen lds
    s_lshl_b32 s41, s5, 12
    s_nop 0
    s_add_u32 m0, s41, 18432
    s_mov_b32 s42, 524288
    buffer_load_dwordx4 v26, s[68:71], s42 offen lds
    s_lshl_b32 s41, s5, 12
    s_nop 0
    s_add_u32 m0, s41, 19456
    s_mov_b32 s42, 524288
    buffer_load_dwordx4 v27, s[68:71], s42 offen lds
    s_lshl_b32 s41, s5, 12
    s_nop 0
    s_add_u32 m0, s41, 32768
    s_mov_b32 s42, 1048576
    buffer_load_dwordx4 v24, s[68:71], s42 offen lds
    s_lshl_b32 s41, s5, 12
    s_nop 0
    s_add_u32 m0, s41, 33792
    s_mov_b32 s42, 1048576
    buffer_load_dwordx4 v25, s[68:71], s42 offen lds
    s_lshl_b32 s41, s5, 12
    s_nop 0
    s_add_u32 m0, s41, 34816
    s_mov_b32 s42, 1048576
    buffer_load_dwordx4 v26, s[68:71], s42 offen lds
    s_lshl_b32 s41, s5, 12
    s_nop 0
    s_add_u32 m0, s41, 35840
    s_mov_b32 s42, 1048576
    buffer_load_dwordx4 v27, s[68:71], s42 offen lds
    s_lshl_b32 s41, s5, 12
    s_nop 0
    s_add_u32 m0, s41, 49152
    s_mov_b32 s42, 1572864
    buffer_load_dwordx4 v24, s[68:71], s42 offen lds
    s_lshl_b32 s41, s5, 12
    s_nop 0
    s_add_u32 m0, s41, 50176
    s_mov_b32 s42, 1572864
    buffer_load_dwordx4 v25, s[68:71], s42 offen lds
    s_lshl_b32 s41, s5, 12
    s_nop 0
    s_add_u32 m0, s41, 51200
    s_mov_b32 s42, 1572864
    buffer_load_dwordx4 v26, s[68:71], s42 offen lds
    s_lshl_b32 s41, s5, 12
    s_nop 0
    s_add_u32 m0, s41, 52224
    s_mov_b32 s42, 1572864
    buffer_load_dwordx4 v27, s[68:71], s42 offen lds
    s_lshl_b32 s41, s5, 12
    s_nop 0
    s_add_u32 m0, s41, 65536
    s_mov_b32 s42, 2097152
    buffer_load_dwordx4 v24, s[68:71], s42 offen lds
    s_lshl_b32 s41, s5, 12
    s_nop 0
    s_add_u32 m0, s41, 66560
    s_mov_b32 s42, 2097152
    buffer_load_dwordx4 v25, s[68:71], s42 offen lds
    s_lshl_b32 s41, s5, 12
    s_nop 0
    s_add_u32 m0, s41, 67584
    s_mov_b32 s42, 2097152
    buffer_load_dwordx4 v26, s[68:71], s42 offen lds
    s_lshl_b32 s41, s5, 12
    s_nop 0
    s_add_u32 m0, s41, 68608
    s_mov_b32 s42, 2097152
    buffer_load_dwordx4 v27, s[68:71], s42 offen lds
    s_lshl_b32 s41, s5, 12
    s_nop 0
    s_add_u32 m0, s41, 81920
    s_mov_b32 s42, 2621440
    buffer_load_dwordx4 v24, s[68:71], s42 offen lds
    s_lshl_b32 s41, s5, 12
    s_nop 0
    s_add_u32 m0, s41, 82944
    s_mov_b32 s42, 2621440
    buffer_load_dwordx4 v25, s[68:71], s42 offen lds
    s_lshl_b32 s41, s5, 12
    s_nop 0
    s_add_u32 m0, s41, 83968
    s_mov_b32 s42, 2621440
    buffer_load_dwordx4 v26, s[68:71], s42 offen lds
    s_lshl_b32 s41, s5, 12
    s_nop 0
    s_add_u32 m0, s41, 84992
    s_mov_b32 s42, 2621440
    buffer_load_dwordx4 v27, s[68:71], s42 offen lds
    s_lshl_b32 s41, s5, 12
    s_nop 0
    s_add_u32 m0, s41, 98304
    s_mov_b32 s42, 3145728
    buffer_load_dwordx4 v24, s[68:71], s42 offen lds
    s_lshl_b32 s41, s5, 12
    s_nop 0
    s_add_u32 m0, s41, 99328
    s_mov_b32 s42, 3145728
    buffer_load_dwordx4 v25, s[68:71], s42 offen lds
    s_lshl_b32 s41, s5, 12
    s_nop 0
    s_add_u32 m0, s41, 100352
    s_mov_b32 s42, 3145728
    buffer_load_dwordx4 v26, s[68:71], s42 offen lds
    s_lshl_b32 s41, s5, 12
    s_nop 0
    s_add_u32 m0, s41, 101376
    s_mov_b32 s42, 3145728
    buffer_load_dwordx4 v27, s[68:71], s42 offen lds
    s_lshl_b32 s41, s5, 12
    s_nop 0
    s_add_u32 m0, s41, 114688
    s_mov_b32 s42, 3670016
    buffer_load_dwordx4 v24, s[68:71], s42 offen lds
    s_lshl_b32 s41, s5, 12
    s_nop 0
    s_add_u32 m0, s41, 115712
    s_mov_b32 s42, 3670016
    buffer_load_dwordx4 v25, s[68:71], s42 offen lds
    s_lshl_b32 s41, s5, 12
    s_nop 0
    s_add_u32 m0, s41, 116736
    s_mov_b32 s42, 3670016
    buffer_load_dwordx4 v26, s[68:71], s42 offen lds
    s_lshl_b32 s41, s5, 12
    s_nop 0
    s_add_u32 m0, s41, 117760
    s_mov_b32 s42, 3670016
    buffer_load_dwordx4 v27, s[68:71], s42 offen lds
    s_waitcnt vmcnt(28)
    s_barrier
    s_cmp_eq_u32 s5, 0
    s_cbranch_scc0 L_arr_1
    v_mov_b32 v103, 1
    s_mov_b64 s[56:57], exec
    s_mov_b64 exec, 1
    s_mov_b32 s41, 36
    buffer_atomic_add v103, off, s[52:55], s41 sc1
    s_mov_b64 exec, s[56:57]
L_arr_1:
    v_lshlrev_b32 v103, 3, v0
    v_add_u32 v103, 139264, v103
    v_lshl_or_b32 v64, v65, 16, v64
    v_lshl_or_b32 v65, v67, 16, v66
    ds_write_b64 v103, v[64:65] offset:0
    v_lshl_or_b32 v68, v69, 16, v68
    v_lshl_or_b32 v69, v71, 16, v70
    ds_write_b64 v103, v[68:69] offset:2048
    v_lshl_or_b32 v72, v73, 16, v72
    v_lshl_or_b32 v73, v75, 16, v74
    ds_write_b64 v103, v[72:73] offset:4096
    v_lshl_or_b32 v76, v77, 16, v76
    v_lshl_or_b32 v77, v79, 16, v78
    ds_write_b64 v103, v[76:77] offset:6144
    v_add_u32 v37, 0, v35
    v_add_u32 v38, 0, v36
    ds_read_b64_tr_b16 a[0:1], v37 offset:0
    ds_read_b64_tr_b16 a[2:3], v37 offset:512
    ds_read_b64_tr_b16 a[4:5], v37 offset:2048
    ds_read_b64_tr_b16 a[6:7], v37 offset:2560
    ds_read_b64_tr_b16 a[64:65], v38 offset:0
    ds_read_b64_tr_b16 a[66:67], v38 offset:512
    ds_read_b64_tr_b16 a[68:69], v38 offset:2048
    ds_read_b64_tr_b16 a[70:71], v38 offset:2560
    s_waitcnt lgkmcnt(0)
    s_barrier
    s_lshl_b32 s41, s5, 12
    s_add_u32 m0, s41, 0
    s_mov_b32 s42, 0
    buffer_load_dwordx4 v24, s[72:75], s42 offen lds
    s_lshl_b32 s41, s5, 12
    s_add_u32 m0, s41, 1024
    s_mov_b32 s42, 0
    buffer_load_dwordx4 v25, s[72:75], s42 offen lds
    s_lshl_b32 s41, s5, 12
    s_add_u32 m0, s41, 2048
    s_mov_b32 s42, 0
    buffer_load_dwordx4 v26, s[72:75], s42 offen lds
    s_lshl_b32 s41, s5, 12
    s_add_u32 m0, s41, 3072
    s_mov_b32 s42, 0
    buffer_load_dwordx4 v27, s[72:75], s42 offen lds
    s_waitcnt vmcnt(28)
    s_barrier
    s_nop 0
    v_add_u32 v37, 16384, v35
    v_add_u32 v38, 16384, v36
    ds_read_b64_tr_b16 a[8:9], v37 offset:0
    ds_read_b64_tr_b16 a[10:11], v37 offset:512
    ds_read_b64_tr_b16 a[12:13], v37 offset:2048
    ds_read_b64_tr_b16 a[14:15], v37 offset:2560
    ds_read_b64_tr_b16 a[72:73], v38 offset:0
    ds_read_b64_tr_b16 a[74:75], v38 offset:512
    ds_read_b64_tr_b16 a[76:77], v38 offset:2048
    ds_read_b64_tr_b16 a[78:79], v38 offset:2560
    s_waitcnt lgkmcnt(0)
    s_barrier
    s_lshl_b32 s41, s5, 12
    s_nop 0
    s_add_u32 m0, s41, 16384
    s_mov_b32 s42, 524288
    buffer_load_dwordx4 v24, s[72:75], s42 offen lds
    s_lshl_b32 s41, s5, 12
    s_nop 0
    s_add_u32 m0, s41, 17408
    s_mov_b32 s42, 524288
    buffer_load_dwordx4 v25, s[72:75], s42 offen lds
    s_lshl_b32 s41, s5, 12
    s_nop 0
    s_add_u32 m0, s41, 18432
    s_mov_b32 s42, 524288
    buffer_load_dwordx4 v26, s[72:75], s42 offen lds
    s_lshl_b32 s41, s5, 12
    s_nop 0
    s_add_u32 m0, s41, 19456
    s_mov_b32 s42, 524288
    buffer_load_dwordx4 v27, s[72:75], s42 offen lds
    s_waitcnt vmcnt(28)
    s_barrier
    v_add_u32 v37, 32768, v35
    v_add_u32 v38, 32768, v36
    ds_read_b64_tr_b16 a[16:17], v37 offset:0
    ds_read_b64_tr_b16 a[18:19], v37 offset:512
    ds_read_b64_tr_b16 a[20:21], v37 offset:2048
    ds_read_b64_tr_b16 a[22:23], v37 offset:2560
    ds_read_b64_tr_b16 a[80:81], v38 offset:0
    ds_read_b64_tr_b16 a[82:83], v38 offset:512
    ds_read_b64_tr_b16 a[84:85], v38 offset:2048
    ds_read_b64_tr_b16 a[86:87], v38 offset:2560
    s_waitcnt lgkmcnt(0)
    s_barrier
    s_lshl_b32 s41, s5, 12
    s_nop 0
    s_add_u32 m0, s41, 32768
    s_mov_b32 s42, 1048576
    buffer_load_dwordx4 v24, s[72:75], s42 offen lds
    s_lshl_b32 s41, s5, 12
    s_nop 0
    s_add_u32 m0, s41, 33792
    s_mov_b32 s42, 1048576
    buffer_load_dwordx4 v25, s[72:75], s42 offen lds
    s_lshl_b32 s41, s5, 12
    s_nop 0
    s_add_u32 m0, s41, 34816
    s_mov_b32 s42, 1048576
    buffer_load_dwordx4 v26, s[72:75], s42 offen lds
    s_lshl_b32 s41, s5, 12
    s_nop 0
    s_add_u32 m0, s41, 35840
    s_mov_b32 s42, 1048576
    buffer_load_dwordx4 v27, s[72:75], s42 offen lds
    s_waitcnt vmcnt(28)
    s_barrier
    v_add_u32 v37, 49152, v35
    v_add_u32 v38, 49152, v36
    ds_read_b64_tr_b16 a[24:25], v37 offset:0
    ds_read_b64_tr_b16 a[26:27], v37 offset:512
    ds_read_b64_tr_b16 a[28:29], v37 offset:2048
    ds_read_b64_tr_b16 a[30:31], v37 offset:2560
    ds_read_b64_tr_b16 a[88:89], v38 offset:0
    ds_read_b64_tr_b16 a[90:91], v38 offset:512
    ds_read_b64_tr_b16 a[92:93], v38 offset:2048
    ds_read_b64_tr_b16 a[94:95], v38 offset:2560
    s_waitcnt lgkmcnt(0)
    s_barrier
    s_lshl_b32 s41, s5, 12
    s_nop 0
    s_add_u32 m0, s41, 49152
    s_mov_b32 s42, 1572864
    buffer_load_dwordx4 v24, s[72:75], s42 offen lds
    s_lshl_b32 s41, s5, 12
    s_nop 0
    s_add_u32 m0, s41, 50176
    s_mov_b32 s42, 1572864
    buffer_load_dwordx4 v25, s[72:75], s42 offen lds
    s_lshl_b32 s41, s5, 12
    s_nop 0
    s_add_u32 m0, s41, 51200
    s_mov_b32 s42, 1572864
    buffer_load_dwordx4 v26, s[72:75], s42 offen lds
    s_lshl_b32 s41, s5, 12
    s_nop 0
    s_add_u32 m0, s41, 52224
    s_mov_b32 s42, 1572864
    buffer_load_dwordx4 v27, s[72:75], s42 offen lds
    s_waitcnt vmcnt(28)
    s_barrier
    v_add_u32 v37, 65536, v35
    v_add_u32 v38, 65536, v36
    ds_read_b64_tr_b16 a[32:33], v37 offset:0
    ds_read_b64_tr_b16 a[34:35], v37 offset:512
    ds_read_b64_tr_b16 a[36:37], v37 offset:2048
    ds_read_b64_tr_b16 a[38:39], v37 offset:2560
    ds_read_b64_tr_b16 a[96:97], v38 offset:0
    ds_read_b64_tr_b16 a[98:99], v38 offset:512
    ds_read_b64_tr_b16 a[100:101], v38 offset:2048
    ds_read_b64_tr_b16 a[102:103], v38 offset:2560
    s_waitcnt lgkmcnt(0)
    s_barrier
    s_lshl_b32 s41, s5, 12
    s_nop 0
    s_add_u32 m0, s41, 65536
    s_mov_b32 s42, 2097152
    buffer_load_dwordx4 v24, s[72:75], s42 offen lds
    s_lshl_b32 s41, s5, 12
    s_nop 0
    s_add_u32 m0, s41, 66560
    s_mov_b32 s42, 2097152
    buffer_load_dwordx4 v25, s[72:75], s42 offen lds
    s_lshl_b32 s41, s5, 12
    s_nop 0
    s_add_u32 m0, s41, 67584
    s_mov_b32 s42, 2097152
    buffer_load_dwordx4 v26, s[72:75], s42 offen lds
    s_lshl_b32 s41, s5, 12
    s_nop 0
    s_add_u32 m0, s41, 68608
    s_mov_b32 s42, 2097152
    buffer_load_dwordx4 v27, s[72:75], s42 offen lds
    s_waitcnt vmcnt(28)
    s_barrier
    v_add_u32 v37, 81920, v35
    v_add_u32 v38, 81920, v36
    ds_read_b64_tr_b16 a[40:41], v37 offset:0
    ds_read_b64_tr_b16 a[42:43], v37 offset:512
    ds_read_b64_tr_b16 a[44:45], v37 offset:2048
    ds_read_b64_tr_b16 a[46:47], v37 offset:2560
    ds_read_b64_tr_b16 a[104:105], v38 offset:0
    ds_read_b64_tr_b16 a[106:107], v38 offset:512
    ds_read_b64_tr_b16 a[108:109], v38 offset:2048
    ds_read_b64_tr_b16 a[110:111], v38 offset:2560
    s_waitcnt lgkmcnt(0)
    s_barrier
    s_lshl_b32 s41, s5, 12
    s_nop 0
    s_add_u32 m0, s41, 81920
    s_mov_b32 s42, 2621440
    buffer_load_dwordx4 v24, s[72:75], s42 offen lds
    s_lshl_b32 s41, s5, 12
    s_nop 0
    s_add_u32 m0, s41, 82944
    s_mov_b32 s42, 2621440
    buffer_load_dwordx4 v25, s[72:75], s42 offen lds
    s_lshl_b32 s41, s5, 12
    s_nop 0
    s_add_u32 m0, s41, 83968
    s_mov_b32 s42, 2621440
    buffer_load_dwordx4 v26, s[72:75], s42 offen lds
    s_lshl_b32 s41, s5, 12
    s_nop 0
    s_add_u32 m0, s41, 84992
    s_mov_b32 s42, 2621440
    buffer_load_dwordx4 v27, s[72:75], s42 offen lds
    s_waitcnt vmcnt(28)
    s_barrier
    v_add_u32 v37, 98304, v35
    v_add_u32 v38, 98304, v36
    ds_read_b64_tr_b16 a[48:49], v37 offset:0
    ds_read_b64_tr_b16 a[50:51], v37 offset:512
    ds_read_b64_tr_b16 a[52:53], v37 offset:2048
    ds_read_b64_tr_b16 a[54:55], v37 offset:2560
    ds_read_b64_tr_b16 a[112:113], v38 offset:0
    ds_read_b64_tr_b16 a[114:115], v38 offset:512
    ds_read_b64_tr_b16 a[116:117], v38 offset:2048
    ds_read_b64_tr_b16 a[118:119], v38 offset:2560
    s_waitcnt lgkmcnt(0)
    s_barrier
    s_lshl_b32 s41, s5, 12
    s_nop 0
    s_add_u32 m0, s41, 98304
    s_mov_b32 s42, 3145728
    buffer_load_dwordx4 v24, s[72:75], s42 offen lds
    s_lshl_b32 s41, s5, 12
    s_nop 0
    s_add_u32 m0, s41, 99328
    s_mov_b32 s42, 3145728
    buffer_load_dwordx4 v25, s[72:75], s42 offen lds
    s_lshl_b32 s41, s5, 12
    s_nop 0
    s_add_u32 m0, s41, 100352
    s_mov_b32 s42, 3145728
    buffer_load_dwordx4 v26, s[72:75], s42 offen lds
    s_lshl_b32 s41, s5, 12
    s_nop 0
    s_add_u32 m0, s41, 101376
    s_mov_b32 s42, 3145728
    buffer_load_dwordx4 v27, s[72:75], s42 offen lds
    s_waitcnt vmcnt(28)
    s_barrier
    v_add_u32 v37, 114688, v35
    v_add_u32 v38, 114688, v36
    ds_read_b64_tr_b16 a[56:57], v37 offset:0
    ds_read_b64_tr_b16 a[58:59], v37 offset:512
    ds_read_b64_tr_b16 a[60:61], v37 offset:2048
    ds_read_b64_tr_b16 a[62:63], v37 offset:2560
    ds_read_b64_tr_b16 a[120:121], v38 offset:0
    ds_read_b64_tr_b16 a[122:123], v38 offset:512
    ds_read_b64_tr_b16 a[124:125], v38 offset:2048
    ds_read_b64_tr_b16 a[126:127], v38 offset:2560
    s_waitcnt lgkmcnt(0)
    s_barrier
    s_lshl_b32 s41, s5, 12
    s_nop 0
    s_add_u32 m0, s41, 114688
    s_mov_b32 s42, 3670016
    buffer_load_dwordx4 v24, s[72:75], s42 offen lds
    s_lshl_b32 s41, s5, 12
    s_nop 0
    s_add_u32 m0, s41, 115712
    s_mov_b32 s42, 3670016
    buffer_load_dwordx4 v25, s[72:75], s42 offen lds
    s_lshl_b32 s41, s5, 12
    s_nop 0
    s_add_u32 m0, s41, 116736
    s_mov_b32 s42, 3670016
    buffer_load_dwordx4 v26, s[72:75], s42 offen lds
    s_lshl_b32 s41, s5, 12
    s_nop 0
    s_add_u32 m0, s41, 117760
    s_mov_b32 s42, 3670016
    buffer_load_dwordx4 v27, s[72:75], s42 offen lds
    s_waitcnt vmcnt(28)
    s_barrier
    v_add_u32 v37, 0, v35
    v_add_u32 v38, 0, v36
    ds_read_b64_tr_b16 a[128:129], v37 offset:0
    ds_read_b64_tr_b16 a[130:131], v37 offset:512
    ds_read_b64_tr_b16 a[132:133], v37 offset:2048
    ds_read_b64_tr_b16 a[134:135], v37 offset:2560
    ds_read_b64_tr_b16 a[192:193], v38 offset:0
    ds_read_b64_tr_b16 a[194:195], v38 offset:512
    ds_read_b64_tr_b16 a[196:197], v38 offset:2048
    ds_read_b64_tr_b16 a[198:199], v38 offset:2560
    s_waitcnt lgkmcnt(0)
    s_barrier
    s_lshl_b32 s41, s5, 12
    s_add_u32 m0, s41, 0
    s_lshl_b32 s42, s4, 17
    s_add_u32 s42, s42, 0
    buffer_load_dwordx4 v28, s[76:79], s42 offen lds
    s_lshl_b32 s41, s5, 12
    s_add_u32 m0, s41, 1024
    s_lshl_b32 s42, s4, 17
    s_add_u32 s42, s42, 0
    buffer_load_dwordx4 v29, s[76:79], s42 offen lds
    s_lshl_b32 s41, s5, 12
    s_add_u32 m0, s41, 2048
    s_lshl_b32 s42, s4, 17
    s_add_u32 s42, s42, 0
    buffer_load_dwordx4 v30, s[76:79], s42 offen lds
    s_lshl_b32 s41, s5, 12
    s_add_u32 m0, s41, 3072
    s_lshl_b32 s42, s4, 17
    s_add_u32 s42, s42, 0
    buffer_load_dwordx4 v31, s[76:79], s42 offen lds
    s_waitcnt vmcnt(28)
    s_barrier
    s_nop 0
    v_add_u32 v37, 16384, v35
    v_add_u32 v38, 16384, v36
    ds_read_b64_tr_b16 a[136:137], v37 offset:0
    ds_read_b64_tr_b16 a[138:139], v37 offset:512
    ds_read_b64_tr_b16 a[140:141], v37 offset:2048
    ds_read_b64_tr_b16 a[142:143], v37 offset:2560
    ds_read_b64_tr_b16 a[200:201], v38 offset:0
    ds_read_b64_tr_b16 a[202:203], v38 offset:512
    ds_read_b64_tr_b16 a[204:205], v38 offset:2048
    ds_read_b64_tr_b16 a[206:207], v38 offset:2560
    s_waitcnt lgkmcnt(0)
    s_barrier
    s_lshl_b32 s41, s5, 12
    s_add_u32 m0, s41, 16384
    s_lshl_b32 s42, s4, 17
    s_add_u32 s42, s42, 256
    buffer_load_dwordx4 v28, s[76:79], s42 offen lds
    s_lshl_b32 s41, s5, 12
    s_add_u32 m0, s41, 17408
    s_lshl_b32 s42, s4, 17
    s_add_u32 s42, s42, 256
    buffer_load_dwordx4 v29, s[76:79], s42 offen lds
    s_lshl_b32 s41, s5, 12
    s_add_u32 m0, s41, 18432
    s_lshl_b32 s42, s4, 17
    s_add_u32 s42, s42, 256
    buffer_load_dwordx4 v30, s[76:79], s42 offen lds
    s_lshl_b32 s41, s5, 12
    s_add_u32 m0, s41, 19456
    s_lshl_b32 s42, s4, 17
    s_add_u32 s42, s42, 256
    buffer_load_dwordx4 v31, s[76:79], s42 offen lds
    s_waitcnt vmcnt(28)
    s_barrier
    v_add_u32 v37, 32768, v35
    v_add_u32 v38, 32768, v36
    ds_read_b64_tr_b16 a[144:145], v37 offset:0
    ds_read_b64_tr_b16 a[146:147], v37 offset:512
    ds_read_b64_tr_b16 a[148:149], v37 offset:2048
    ds_read_b64_tr_b16 a[150:151], v37 offset:2560
    ds_read_b64_tr_b16 a[208:209], v38 offset:0
    ds_read_b64_tr_b16 a[210:211], v38 offset:512
    ds_read_b64_tr_b16 a[212:213], v38 offset:2048
    ds_read_b64_tr_b16 a[214:215], v38 offset:2560
    s_waitcnt lgkmcnt(0)
    s_barrier
    s_lshl_b32 s41, s5, 12
    s_add_u32 m0, s41, 32768
    s_lshl_b32 s42, s4, 17
    s_add_u32 s42, s42, 512
    buffer_load_dwordx4 v28, s[76:79], s42 offen lds
    s_lshl_b32 s41, s5, 12
    s_add_u32 m0, s41, 33792
    s_lshl_b32 s42, s4, 17
    s_add_u32 s42, s42, 512
    buffer_load_dwordx4 v29, s[76:79], s42 offen lds
    s_lshl_b32 s41, s5, 12
    s_add_u32 m0, s41, 34816
    s_lshl_b32 s42, s4, 17
    s_add_u32 s42, s42, 512
    buffer_load_dwordx4 v30, s[76:79], s42 offen lds
    s_lshl_b32 s41, s5, 12
    s_add_u32 m0, s41, 35840
    s_lshl_b32 s42, s4, 17
    s_add_u32 s42, s42, 512
    buffer_load_dwordx4 v31, s[76:79], s42 offen lds
    s_waitcnt vmcnt(28)
    s_barrier
    v_add_u32 v37, 49152, v35
    v_add_u32 v38, 49152, v36
    ds_read_b64_tr_b16 a[152:153], v37 offset:0
    ds_read_b64_tr_b16 a[154:155], v37 offset:512
    ds_read_b64_tr_b16 a[156:157], v37 offset:2048
    ds_read_b64_tr_b16 a[158:159], v37 offset:2560
    ds_read_b64_tr_b16 a[216:217], v38 offset:0
    ds_read_b64_tr_b16 a[218:219], v38 offset:512
    ds_read_b64_tr_b16 a[220:221], v38 offset:2048
    ds_read_b64_tr_b16 a[222:223], v38 offset:2560
    s_waitcnt lgkmcnt(0)
    s_barrier
    s_lshl_b32 s41, s5, 12
    s_add_u32 m0, s41, 49152
    s_lshl_b32 s42, s4, 17
    s_add_u32 s42, s42, 768
    buffer_load_dwordx4 v28, s[76:79], s42 offen lds
    s_lshl_b32 s41, s5, 12
    s_add_u32 m0, s41, 50176
    s_lshl_b32 s42, s4, 17
    s_add_u32 s42, s42, 768
    buffer_load_dwordx4 v29, s[76:79], s42 offen lds
    s_lshl_b32 s41, s5, 12
    s_add_u32 m0, s41, 51200
    s_lshl_b32 s42, s4, 17
    s_add_u32 s42, s42, 768
    buffer_load_dwordx4 v30, s[76:79], s42 offen lds
    s_lshl_b32 s41, s5, 12
    s_add_u32 m0, s41, 52224
    s_lshl_b32 s42, s4, 17
    s_add_u32 s42, s42, 768
    buffer_load_dwordx4 v31, s[76:79], s42 offen lds
    s_waitcnt vmcnt(28)
    s_barrier
    v_add_u32 v37, 65536, v35
    v_add_u32 v38, 65536, v36
    ds_read_b64_tr_b16 a[160:161], v37 offset:0
    ds_read_b64_tr_b16 a[162:163], v37 offset:512
    ds_read_b64_tr_b16 a[164:165], v37 offset:2048
    ds_read_b64_tr_b16 a[166:167], v37 offset:2560
    ds_read_b64_tr_b16 a[224:225], v38 offset:0
    ds_read_b64_tr_b16 a[226:227], v38 offset:512
    ds_read_b64_tr_b16 a[228:229], v38 offset:2048
    ds_read_b64_tr_b16 a[230:231], v38 offset:2560
    s_waitcnt lgkmcnt(0)
    s_barrier
    s_lshl_b32 s41, s5, 12
    s_add_u32 m0, s41, 65536
    s_lshl_b32 s42, s4, 17
    s_add_u32 s42, s42, 65536
    buffer_load_dwordx4 v28, s[76:79], s42 offen lds
    s_lshl_b32 s41, s5, 12
    s_add_u32 m0, s41, 66560
    s_lshl_b32 s42, s4, 17
    s_add_u32 s42, s42, 65536
    buffer_load_dwordx4 v29, s[76:79], s42 offen lds
    s_lshl_b32 s41, s5, 12
    s_add_u32 m0, s41, 67584
    s_lshl_b32 s42, s4, 17
    s_add_u32 s42, s42, 65536
    buffer_load_dwordx4 v30, s[76:79], s42 offen lds
    s_lshl_b32 s41, s5, 12
    s_add_u32 m0, s41, 68608
    s_lshl_b32 s42, s4, 17
    s_add_u32 s42, s42, 65536
    buffer_load_dwordx4 v31, s[76:79], s42 offen lds
    s_waitcnt vmcnt(28)
    s_barrier
    v_add_u32 v37, 81920, v35
    v_add_u32 v38, 81920, v36
    ds_read_b64_tr_b16 a[168:169], v37 offset:0
    ds_read_b64_tr_b16 a[170:171], v37 offset:512
    ds_read_b64_tr_b16 a[172:173], v37 offset:2048
    ds_read_b64_tr_b16 a[174:175], v37 offset:2560
    ds_read_b64_tr_b16 a[232:233], v38 offset:0
    ds_read_b64_tr_b16 a[234:235], v38 offset:512
    ds_read_b64_tr_b16 a[236:237], v38 offset:2048
    ds_read_b64_tr_b16 a[238:239], v38 offset:2560
    s_waitcnt lgkmcnt(0)
    s_barrier
    s_lshl_b32 s41, s5, 12
    s_add_u32 m0, s41, 81920
    s_lshl_b32 s42, s4, 17
    s_add_u32 s42, s42, 65792
    buffer_load_dwordx4 v28, s[76:79], s42 offen lds
    s_lshl_b32 s41, s5, 12
    s_add_u32 m0, s41, 82944
    s_lshl_b32 s42, s4, 17
    s_add_u32 s42, s42, 65792
    buffer_load_dwordx4 v29, s[76:79], s42 offen lds
    s_lshl_b32 s41, s5, 12
    s_add_u32 m0, s41, 83968
    s_lshl_b32 s42, s4, 17
    s_add_u32 s42, s42, 65792
    buffer_load_dwordx4 v30, s[76:79], s42 offen lds
    s_lshl_b32 s41, s5, 12
    s_add_u32 m0, s41, 84992
    s_lshl_b32 s42, s4, 17
    s_add_u32 s42, s42, 65792
    buffer_load_dwordx4 v31, s[76:79], s42 offen lds
    s_waitcnt vmcnt(28)
    s_barrier
    v_add_u32 v37, 98304, v35
    v_add_u32 v38, 98304, v36
    ds_read_b64_tr_b16 a[176:177], v37 offset:0
    ds_read_b64_tr_b16 a[178:179], v37 offset:512
    ds_read_b64_tr_b16 a[180:181], v37 offset:2048
    ds_read_b64_tr_b16 a[182:183], v37 offset:2560
    ds_read_b64_tr_b16 a[240:241], v38 offset:0
    ds_read_b64_tr_b16 a[242:243], v38 offset:512
    ds_read_b64_tr_b16 a[244:245], v38 offset:2048
    ds_read_b64_tr_b16 a[246:247], v38 offset:2560
    s_waitcnt lgkmcnt(0)
    s_barrier
    s_lshl_b32 s41, s5, 12
    s_add_u32 m0, s41, 98304
    s_lshl_b32 s42, s4, 17
    s_add_u32 s42, s42, 66048
    buffer_load_dwordx4 v28, s[76:79], s42 offen lds
    s_lshl_b32 s41, s5, 12
    s_add_u32 m0, s41, 99328
    s_lshl_b32 s42, s4, 17
    s_add_u32 s42, s42, 66048
    buffer_load_dwordx4 v29, s[76:79], s42 offen lds
    s_lshl_b32 s41, s5, 12
    s_add_u32 m0, s41, 100352
    s_lshl_b32 s42, s4, 17
    s_add_u32 s42, s42, 66048
    buffer_load_dwordx4 v30, s[76:79], s42 offen lds
    s_lshl_b32 s41, s5, 12
    s_add_u32 m0, s41, 101376
    s_lshl_b32 s42, s4, 17
    s_add_u32 s42, s42, 66048
    buffer_load_dwordx4 v31, s[76:79], s42 offen lds
    s_waitcnt vmcnt(28)
    s_barrier
    v_add_u32 v37, 114688, v35
    v_add_u32 v38, 114688, v36
    ds_read_b64_tr_b16 a[184:185], v37 offset:0
    ds_read_b64_tr_b16 a[186:187], v37 offset:512
    ds_read_b64_tr_b16 a[188:189], v37 offset:2048
    ds_read_b64_tr_b16 a[190:191], v37 offset:2560
    ds_read_b64_tr_b16 a[248:249], v38 offset:0
    ds_read_b64_tr_b16 a[250:251], v38 offset:512
    ds_read_b64_tr_b16 a[252:253], v38 offset:2048
    ds_read_b64_tr_b16 a[254:255], v38 offset:2560
    s_waitcnt lgkmcnt(0)
    s_barrier
    s_lshl_b32 s41, s5, 12
    s_add_u32 m0, s41, 114688
    s_lshl_b32 s42, s4, 17
    s_add_u32 s42, s42, 66304
    buffer_load_dwordx4 v28, s[76:79], s42 offen lds
    s_lshl_b32 s41, s5, 12
    s_add_u32 m0, s41, 115712
    s_lshl_b32 s42, s4, 17
    s_add_u32 s42, s42, 66304
    buffer_load_dwordx4 v29, s[76:79], s42 offen lds
    s_lshl_b32 s41, s5, 12
    s_add_u32 m0, s41, 116736
    s_lshl_b32 s42, s4, 17
    s_add_u32 s42, s42, 66304
    buffer_load_dwordx4 v30, s[76:79], s42 offen lds
    s_lshl_b32 s41, s5, 12
    s_add_u32 m0, s41, 117760
    s_lshl_b32 s42, s4, 17
    s_add_u32 s42, s42, 66304
    buffer_load_dwordx4 v31, s[76:79], s42 offen lds
    s_waitcnt vmcnt(28)
    s_barrier
    s_cmp_eq_u32 s5, 0
    s_cbranch_scc0 L_wo_2
    v_xor_b32 v37, 0, v33
    v_add_u32 v37, v37, v32
    v_add_u32_e64 v37, 0, v37
    ds_read_b64_tr_b16 v[128:129], v37 offset:0
    ds_read_b64_tr_b16 v[130:131], v37 offset:512
    ds_read_b64_tr_b16 v[132:133], v37 offset:2048
    ds_read_b64_tr_b16 v[134:135], v37 offset:2560
    v_xor_b32 v37, 32, v33
    v_add_u32 v37, v37, v32
    v_add_u32_e64 v37, 0, v37
    ds_read_b64_tr_b16 v[144:145], v37 offset:0
    ds_read_b64_tr_b16 v[146:147], v37 offset:512
    ds_read_b64_tr_b16 v[148:149], v37 offset:2048
    ds_read_b64_tr_b16 v[150:151], v37 offset:2560
    s_waitcnt lgkmcnt(0)
    v_xor_b32 v37, 64, v33
    v_add_u32 v37, v37, v32
    v_add_u32 v37, 0, v37
    ds_read_b64_tr_b16 v[160:161], v37 offset:0
    ds_read_b64_tr_b16 v[162:163], v37 offset:512
    ds_read_b64_tr_b16 v[164:165], v37 offset:2048
    ds_read_b64_tr_b16 v[166:167], v37 offset:2560
    v_xor_b32 v37, 96, v33
    v_add_u32 v37, v37, v32
    v_add_u32 v37, 0, v37
    ds_read_b64_tr_b16 v[176:177], v37 offset:0
    ds_read_b64_tr_b16 v[178:179], v37 offset:512
    ds_read_b64_tr_b16 v[180:181], v37 offset:2048
    ds_read_b64_tr_b16 v[182:183], v37 offset:2560
    s_waitcnt lgkmcnt(0)
    v_xor_b32 v37, 128, v33
    v_add_u32 v37, v37, v32
    v_add_u32_e64 v37, 0, v37
    ds_read_b64_tr_b16 v[192:193], v37 offset:0
    ds_read_b64_tr_b16 v[194:195], v37 offset:512
    ds_read_b64_tr_b16 v[196:197], v37 offset:2048
    ds_read_b64_tr_b16 v[198:199], v37 offset:2560
    v_xor_b32 v37, 160, v33
    v_add_u32 v37, v37, v32
    v_add_u32 v37, 0, v37
    ds_read_b64_tr_b16 v[208:209], v37 offset:0
    ds_read_b64_tr_b16 v[210:211], v37 offset:512
    ds_read_b64_tr_b16 v[212:213], v37 offset:2048
    ds_read_b64_tr_b16 v[214:215], v37 offset:2560
    s_waitcnt lgkmcnt(0)
    v_xor_b32 v37, 192, v33
    v_add_u32 v37, v37, v32
    v_add_u32_e64 v37, 0, v37
    ds_read_b64_tr_b16 v[224:225], v37 offset:0
    ds_read_b64_tr_b16 v[226:227], v37 offset:512
    ds_read_b64_tr_b16 v[228:229], v37 offset:2048
    ds_read_b64_tr_b16 v[230:231], v37 offset:2560
    v_xor_b32 v37, 224, v33
    v_add_u32 v37, v37, v32
    v_add_u32 v37, 0, v37
    ds_read_b64_tr_b16 v[240:241], v37 offset:0
    ds_read_b64_tr_b16 v[242:243], v37 offset:512
    ds_read_b64_tr_b16 v[244:245], v37 offset:2048
    ds_read_b64_tr_b16 v[246:247], v37 offset:2560
    s_waitcnt lgkmcnt(0)
L_wo_2:
    s_waitcnt lgkmcnt(0)
    s_barrier
    s_lshl_b32 s41, s5, 12
    s_add_u32 m0, s41, 0
    s_mov_b32 s42, 0
    buffer_load_dwordx4 v24, s[80:83], s42 offen lds
    s_lshl_b32 s41, s5, 12
    s_add_u32 m0, s41, 1024
    s_mov_b32 s42, 0
    buffer_load_dwordx4 v25, s[80:83], s42 offen lds
    s_lshl_b32 s41, s5, 12
    s_add_u32 m0, s41, 2048
    s_mov_b32 s42, 0
    buffer_load_dwordx4 v26, s[80:83], s42 offen lds
    s_lshl_b32 s41, s5, 12
    s_add_u32 m0, s41, 3072
    s_mov_b32 s42, 0
    buffer_load_dwordx4 v27, s[80:83], s42 offen lds
    s_waitcnt vmcnt(28)
    s_barrier
    s_cmp_eq_u32 s5, 1
    s_cbranch_scc0 L_wo_3
    v_xor_b32 v37, 0, v33
    v_add_u32 v37, v37, v32
    v_add_u32 v37, 16384, v37
    ds_read_b64_tr_b16 v[128:129], v37 offset:0
    ds_read_b64_tr_b16 v[130:131], v37 offset:512
    ds_read_b64_tr_b16 v[132:133], v37 offset:2048
    ds_read_b64_tr_b16 v[134:135], v37 offset:2560
    v_xor_b32 v37, 32, v33
    v_add_u32 v37, v37, v32
    v_add_u32 v37, 16384, v37
    ds_read_b64_tr_b16 v[144:145], v37 offset:0
    ds_read_b64_tr_b16 v[146:147], v37 offset:512
    ds_read_b64_tr_b16 v[148:149], v37 offset:2048
    ds_read_b64_tr_b16 v[150:151], v37 offset:2560
    s_waitcnt lgkmcnt(0)
    v_xor_b32 v37, 64, v33
    v_add_u32_e64 v37, v37, v32
    v_add_u32 v37, 16384, v37
    ds_read_b64_tr_b16 v[160:161], v37 offset:0
    ds_read_b64_tr_b16 v[162:163], v37 offset:512
    ds_read_b64_tr_b16 v[164:165], v37 offset:2048
    ds_read_b64_tr_b16 v[166:167], v37 offset:2560
    v_xor_b32 v37, 96, v33
    v_add_u32_e64 v37, v37, v32
    v_add_u32 v37, 16384, v37
    ds_read_b64_tr_b16 v[176:177], v37 offset:0
    ds_read_b64_tr_b16 v[178:179], v37 offset:512
    ds_read_b64_tr_b16 v[180:181], v37 offset:2048
    ds_read_b64_tr_b16 v[182:183], v37 offset:2560
    s_waitcnt lgkmcnt(0)
    v_xor_b32 v37, 128, v33
    v_add_u32 v37, v37, v32
    v_add_u32 v37, 16384, v37
    ds_read_b64_tr_b16 v[192:193], v37 offset:0
    ds_read_b64_tr_b16 v[194:195], v37 offset:512
    ds_read_b64_tr_b16 v[196:197], v37 offset:2048
    ds_read_b64_tr_b16 v[198:199], v37 offset:2560
    v_xor_b32 v37, 160, v33
    v_add_u32_e64 v37, v37, v32
    v_add_u32 v37, 16384, v37
    ds_read_b64_tr_b16 v[208:209], v37 offset:0
    ds_read_b64_tr_b16 v[210:211], v37 offset:512
    ds_read_b64_tr_b16 v[212:213], v37 offset:2048
    ds_read_b64_tr_b16 v[214:215], v37 offset:2560
    s_waitcnt lgkmcnt(0)
    v_xor_b32 v37, 192, v33
    v_add_u32 v37, v37, v32
    v_add_u32 v37, 16384, v37
    ds_read_b64_tr_b16 v[224:225], v37 offset:0
    ds_read_b64_tr_b16 v[226:227], v37 offset:512
    ds_read_b64_tr_b16 v[228:229], v37 offset:2048
    ds_read_b64_tr_b16 v[230:231], v37 offset:2560
    v_xor_b32 v37, 224, v33
    v_add_u32_e64 v37, v37, v32
    v_add_u32 v37, 16384, v37
    ds_read_b64_tr_b16 v[240:241], v37 offset:0
    ds_read_b64_tr_b16 v[242:243], v37 offset:512
    ds_read_b64_tr_b16 v[244:245], v37 offset:2048
    ds_read_b64_tr_b16 v[246:247], v37 offset:2560
    s_waitcnt lgkmcnt(0)
L_wo_3:
    s_waitcnt lgkmcnt(0)
    s_barrier
    s_lshl_b32 s41, s5, 12
    s_add_u32 m0, s41, 16384
    s_mov_b32 s42, 524288
    buffer_load_dwordx4 v24, s[80:83], s42 offen lds
    s_lshl_b32 s41, s5, 12
    s_nop 0
    s_add_u32 m0, s41, 17408
    s_mov_b32 s42, 524288
    buffer_load_dwordx4 v25, s[80:83], s42 offen lds
    s_lshl_b32 s41, s5, 12
    s_nop 0
    s_add_u32 m0, s41, 18432
    s_mov_b32 s42, 524288
    buffer_load_dwordx4 v26, s[80:83], s42 offen lds
    s_lshl_b32 s41, s5, 12
    s_nop 0
    s_add_u32 m0, s41, 19456
    s_mov_b32 s42, 524288
    buffer_load_dwordx4 v27, s[80:83], s42 offen lds
    s_waitcnt vmcnt(28)
    s_barrier
    s_cmp_eq_u32 s5, 2
    s_cbranch_scc0 L_wo_4
    v_xor_b32 v37, 0, v33
    v_add_u32 v37, v37, v32
    v_add_u32 v37, 32768, v37
    ds_read_b64_tr_b16 v[128:129], v37 offset:0
    ds_read_b64_tr_b16 v[130:131], v37 offset:512
    ds_read_b64_tr_b16 v[132:133], v37 offset:2048
    ds_read_b64_tr_b16 v[134:135], v37 offset:2560
    v_xor_b32 v37, 32, v33
    v_add_u32 v37, v37, v32
    v_add_u32 v37, 32768, v37
    ds_read_b64_tr_b16 v[144:145], v37 offset:0
    ds_read_b64_tr_b16 v[146:147], v37 offset:512
    ds_read_b64_tr_b16 v[148:149], v37 offset:2048
    ds_read_b64_tr_b16 v[150:151], v37 offset:2560
    s_waitcnt lgkmcnt(0)
    v_xor_b32 v37, 64, v33
    v_add_u32_e64 v37, v37, v32
    v_add_u32 v37, 32768, v37
    ds_read_b64_tr_b16 v[160:161], v37 offset:0
    ds_read_b64_tr_b16 v[162:163], v37 offset:512
    ds_read_b64_tr_b16 v[164:165], v37 offset:2048
    ds_read_b64_tr_b16 v[166:167], v37 offset:2560
    v_xor_b32 v37, 96, v33
    v_add_u32_e64 v37, v37, v32
    v_add_u32 v37, 32768, v37
    ds_read_b64_tr_b16 v[176:177], v37 offset:0
    ds_read_b64_tr_b16 v[178:179], v37 offset:512
    ds_read_b64_tr_b16 v[180:181], v37 offset:2048
    ds_read_b64_tr_b16 v[182:183], v37 offset:2560
    s_waitcnt lgkmcnt(0)
    v_xor_b32 v37, 128, v33
    v_add_u32 v37, v37, v32
    v_add_u32 v37, 32768, v37
    ds_read_b64_tr_b16 v[192:193], v37 offset:0
    ds_read_b64_tr_b16 v[194:195], v37 offset:512
    ds_read_b64_tr_b16 v[196:197], v37 offset:2048
    ds_read_b64_tr_b16 v[198:199], v37 offset:2560
    v_xor_b32 v37, 160, v33
    v_add_u32_e64 v37, v37, v32
    v_add_u32 v37, 32768, v37
    ds_read_b64_tr_b16 v[208:209], v37 offset:0
    ds_read_b64_tr_b16 v[210:211], v37 offset:512
    ds_read_b64_tr_b16 v[212:213], v37 offset:2048
    ds_read_b64_tr_b16 v[214:215], v37 offset:2560
    s_waitcnt lgkmcnt(0)
    v_xor_b32 v37, 192, v33
    v_add_u32 v37, v37, v32
    v_add_u32 v37, 32768, v37
    ds_read_b64_tr_b16 v[224:225], v37 offset:0
    ds_read_b64_tr_b16 v[226:227], v37 offset:512
    ds_read_b64_tr_b16 v[228:229], v37 offset:2048
    ds_read_b64_tr_b16 v[230:231], v37 offset:2560
    v_xor_b32 v37, 224, v33
    v_add_u32_e64 v37, v37, v32
    v_add_u32 v37, 32768, v37
    ds_read_b64_tr_b16 v[240:241], v37 offset:0
    ds_read_b64_tr_b16 v[242:243], v37 offset:512
    ds_read_b64_tr_b16 v[244:245], v37 offset:2048
    ds_read_b64_tr_b16 v[246:247], v37 offset:2560
    s_waitcnt lgkmcnt(0)
L_wo_4:
    s_waitcnt lgkmcnt(0)
    s_barrier
    s_lshl_b32 s41, s5, 12
    s_add_u32 m0, s41, 32768
    s_mov_b32 s42, 1048576
    buffer_load_dwordx4 v24, s[80:83], s42 offen lds
    s_lshl_b32 s41, s5, 12
    s_nop 0
    s_add_u32 m0, s41, 33792
    s_mov_b32 s42, 1048576
    buffer_load_dwordx4 v25, s[80:83], s42 offen lds
    s_lshl_b32 s41, s5, 12
    s_nop 0
    s_add_u32 m0, s41, 34816
    s_mov_b32 s42, 1048576
    buffer_load_dwordx4 v26, s[80:83], s42 offen lds
    s_lshl_b32 s41, s5, 12
    s_nop 0
    s_add_u32 m0, s41, 35840
    s_mov_b32 s42, 1048576
    buffer_load_dwordx4 v27, s[80:83], s42 offen lds
    s_waitcnt vmcnt(28)
    s_barrier
    s_cmp_eq_u32 s5, 3
    s_cbranch_scc0 L_wo_5
    v_xor_b32 v37, 0, v33
    v_add_u32 v37, v37, v32
    v_add_u32 v37, 49152, v37
    ds_read_b64_tr_b16 v[128:129], v37 offset:0
    ds_read_b64_tr_b16 v[130:131], v37 offset:512
    ds_read_b64_tr_b16 v[132:133], v37 offset:2048
    ds_read_b64_tr_b16 v[134:135], v37 offset:2560
    v_xor_b32 v37, 32, v33
    v_add_u32 v37, v37, v32
    v_add_u32 v37, 49152, v37
    ds_read_b64_tr_b16 v[144:145], v37 offset:0
    ds_read_b64_tr_b16 v[146:147], v37 offset:512
    ds_read_b64_tr_b16 v[148:149], v37 offset:2048
    ds_read_b64_tr_b16 v[150:151], v37 offset:2560
    s_waitcnt lgkmcnt(0)
    v_xor_b32 v37, 64, v33
    v_add_u32_e64 v37, v37, v32
    v_add_u32 v37, 49152, v37
    ds_read_b64_tr_b16 v[160:161], v37 offset:0
    ds_read_b64_tr_b16 v[162:163], v37 offset:512
    ds_read_b64_tr_b16 v[164:165], v37 offset:2048
    ds_read_b64_tr_b16 v[166:167], v37 offset:2560
    v_xor_b32 v37, 96, v33
    v_add_u32_e64 v37, v37, v32
    v_add_u32 v37, 49152, v37
    ds_read_b64_tr_b16 v[176:177], v37 offset:0
    ds_read_b64_tr_b16 v[178:179], v37 offset:512
    ds_read_b64_tr_b16 v[180:181], v37 offset:2048
    ds_read_b64_tr_b16 v[182:183], v37 offset:2560
    s_waitcnt lgkmcnt(0)
    v_xor_b32 v37, 128, v33
    v_add_u32 v37, v37, v32
    v_add_u32 v37, 49152, v37
    ds_read_b64_tr_b16 v[192:193], v37 offset:0
    ds_read_b64_tr_b16 v[194:195], v37 offset:512
    ds_read_b64_tr_b16 v[196:197], v37 offset:2048
    ds_read_b64_tr_b16 v[198:199], v37 offset:2560
    v_xor_b32 v37, 160, v33
    v_add_u32_e64 v37, v37, v32
    v_add_u32 v37, 49152, v37
    ds_read_b64_tr_b16 v[208:209], v37 offset:0
    ds_read_b64_tr_b16 v[210:211], v37 offset:512
    ds_read_b64_tr_b16 v[212:213], v37 offset:2048
    ds_read_b64_tr_b16 v[214:215], v37 offset:2560
    s_waitcnt lgkmcnt(0)
    v_xor_b32 v37, 192, v33
    v_add_u32 v37, v37, v32
    v_add_u32 v37, 49152, v37
    ds_read_b64_tr_b16 v[224:225], v37 offset:0
    ds_read_b64_tr_b16 v[226:227], v37 offset:512
    ds_read_b64_tr_b16 v[228:229], v37 offset:2048
    ds_read_b64_tr_b16 v[230:231], v37 offset:2560
    v_xor_b32 v37, 224, v33
    v_add_u32_e64 v37, v37, v32
    v_add_u32 v37, 49152, v37
    ds_read_b64_tr_b16 v[240:241], v37 offset:0
    ds_read_b64_tr_b16 v[242:243], v37 offset:512
    ds_read_b64_tr_b16 v[244:245], v37 offset:2048
    ds_read_b64_tr_b16 v[246:247], v37 offset:2560
    s_waitcnt lgkmcnt(0)
L_wo_5:
    s_waitcnt lgkmcnt(0)
    s_barrier
    s_lshl_b32 s41, s5, 12
    s_add_u32 m0, s41, 49152
    s_mov_b32 s42, 1572864
    buffer_load_dwordx4 v24, s[80:83], s42 offen lds
    s_lshl_b32 s41, s5, 12
    s_nop 0
    s_add_u32 m0, s41, 50176
    s_mov_b32 s42, 1572864
    buffer_load_dwordx4 v25, s[80:83], s42 offen lds
    s_lshl_b32 s41, s5, 12
    s_nop 0
    s_add_u32 m0, s41, 51200
    s_mov_b32 s42, 1572864
    buffer_load_dwordx4 v26, s[80:83], s42 offen lds
    s_lshl_b32 s41, s5, 12
    s_nop 0
    s_add_u32 m0, s41, 52224
    s_mov_b32 s42, 1572864
    buffer_load_dwordx4 v27, s[80:83], s42 offen lds
    s_waitcnt vmcnt(28)
    s_barrier
    s_cmp_eq_u32 s5, 0
    s_cbranch_scc0 L_wo_6
    v_xor_b32 v37, 0, v33
    v_add_u32 v37, v37, v32
    v_add_u32 v37, 65536, v37
    ds_read_b64_tr_b16 v[136:137], v37 offset:0
    ds_read_b64_tr_b16 v[138:139], v37 offset:512
    ds_read_b64_tr_b16 v[140:141], v37 offset:2048
    ds_read_b64_tr_b16 v[142:143], v37 offset:2560
    v_xor_b32 v37, 32, v33
    v_add_u32 v37, v37, v32
    v_add_u32 v37, 65536, v37
    ds_read_b64_tr_b16 v[152:153], v37 offset:0
    ds_read_b64_tr_b16 v[154:155], v37 offset:512
    ds_read_b64_tr_b16 v[156:157], v37 offset:2048
    ds_read_b64_tr_b16 v[158:159], v37 offset:2560
    s_waitcnt lgkmcnt(0)
    v_xor_b32 v37, 64, v33
    v_add_u32_e64 v37, v37, v32
    v_add_u32 v37, 65536, v37
    ds_read_b64_tr_b16 v[168:169], v37 offset:0
    ds_read_b64_tr_b16 v[170:171], v37 offset:512
    ds_read_b64_tr_b16 v[172:173], v37 offset:2048
    ds_read_b64_tr_b16 v[174:175], v37 offset:2560
    v_xor_b32 v37, 96, v33
    v_add_u32_e64 v37, v37, v32
    v_add_u32 v37, 65536, v37
    ds_read_b64_tr_b16 v[184:185], v37 offset:0
    ds_read_b64_tr_b16 v[186:187], v37 offset:512
    ds_read_b64_tr_b16 v[188:189], v37 offset:2048
    ds_read_b64_tr_b16 v[190:191], v37 offset:2560
    s_waitcnt lgkmcnt(0)
    v_xor_b32 v37, 128, v33
    v_add_u32 v37, v37, v32
    v_add_u32 v37, 65536, v37
    ds_read_b64_tr_b16 v[200:201], v37 offset:0
    ds_read_b64_tr_b16 v[202:203], v37 offset:512
    ds_read_b64_tr_b16 v[204:205], v37 offset:2048
    ds_read_b64_tr_b16 v[206:207], v37 offset:2560
    v_xor_b32 v37, 160, v33
    v_add_u32_e64 v37, v37, v32
    v_add_u32 v37, 65536, v37
    ds_read_b64_tr_b16 v[216:217], v37 offset:0
    ds_read_b64_tr_b16 v[218:219], v37 offset:512
    ds_read_b64_tr_b16 v[220:221], v37 offset:2048
    ds_read_b64_tr_b16 v[222:223], v37 offset:2560
    s_waitcnt lgkmcnt(0)
    v_xor_b32 v37, 192, v33
    v_add_u32 v37, v37, v32
    v_add_u32 v37, 65536, v37
    ds_read_b64_tr_b16 v[232:233], v37 offset:0
    ds_read_b64_tr_b16 v[234:235], v37 offset:512
    ds_read_b64_tr_b16 v[236:237], v37 offset:2048
    ds_read_b64_tr_b16 v[238:239], v37 offset:2560
    v_xor_b32 v37, 224, v33
    v_add_u32_e64 v37, v37, v32
    v_add_u32 v37, 65536, v37
    ds_read_b64_tr_b16 v[248:249], v37 offset:0
    ds_read_b64_tr_b16 v[250:251], v37 offset:512
    ds_read_b64_tr_b16 v[252:253], v37 offset:2048
    ds_read_b64_tr_b16 v[254:255], v37 offset:2560
    s_waitcnt lgkmcnt(0)
L_wo_6:
    s_waitcnt lgkmcnt(0)
    s_barrier
    s_lshl_b32 s41, s5, 12
    s_add_u32 m0, s41, 65536
    s_mov_b32 s42, 2097152
    buffer_load_dwordx4 v24, s[80:83], s42 offen lds
    s_lshl_b32 s41, s5, 12
    s_nop 0
    s_add_u32 m0, s41, 66560
    s_mov_b32 s42, 2097152
    buffer_load_dwordx4 v25, s[80:83], s42 offen lds
    s_lshl_b32 s41, s5, 12
    s_nop 0
    s_add_u32 m0, s41, 67584
    s_mov_b32 s42, 2097152
    buffer_load_dwordx4 v26, s[80:83], s42 offen lds
    s_lshl_b32 s41, s5, 12
    s_nop 0
    s_add_u32 m0, s41, 68608
    s_mov_b32 s42, 2097152
    buffer_load_dwordx4 v27, s[80:83], s42 offen lds
    s_waitcnt vmcnt(28)
    s_barrier
    s_cmp_eq_u32 s5, 1
    s_cbranch_scc0 L_wo_7
    v_xor_b32 v37, 0, v33
    v_add_u32 v37, v37, v32
    v_add_u32 v37, 81920, v37
    ds_read_b64_tr_b16 v[136:137], v37 offset:0
    ds_read_b64_tr_b16 v[138:139], v37 offset:512
    ds_read_b64_tr_b16 v[140:141], v37 offset:2048
    ds_read_b64_tr_b16 v[142:143], v37 offset:2560
    v_xor_b32 v37, 32, v33
    v_add_u32 v37, v37, v32
    v_add_u32 v37, 81920, v37
    ds_read_b64_tr_b16 v[152:153], v37 offset:0
    ds_read_b64_tr_b16 v[154:155], v37 offset:512
    ds_read_b64_tr_b16 v[156:157], v37 offset:2048
    ds_read_b64_tr_b16 v[158:159], v37 offset:2560
    s_waitcnt lgkmcnt(0)
    v_xor_b32 v37, 64, v33
    v_add_u32_e64 v37, v37, v32
    v_add_u32 v37, 81920, v37
    ds_read_b64_tr_b16 v[168:169], v37 offset:0
    ds_read_b64_tr_b16 v[170:171], v37 offset:512
    ds_read_b64_tr_b16 v[172:173], v37 offset:2048
    ds_read_b64_tr_b16 v[174:175], v37 offset:2560
    v_xor_b32 v37, 96, v33
    v_add_u32_e64 v37, v37, v32
    v_add_u32 v37, 81920, v37
    ds_read_b64_tr_b16 v[184:185], v37 offset:0
    ds_read_b64_tr_b16 v[186:187], v37 offset:512
    ds_read_b64_tr_b16 v[188:189], v37 offset:2048
    ds_read_b64_tr_b16 v[190:191], v37 offset:2560
    s_waitcnt lgkmcnt(0)
    v_xor_b32 v37, 128, v33
    v_add_u32 v37, v37, v32
    v_add_u32 v37, 81920, v37
    ds_read_b64_tr_b16 v[200:201], v37 offset:0
    ds_read_b64_tr_b16 v[202:203], v37 offset:512
    ds_read_b64_tr_b16 v[204:205], v37 offset:2048
    ds_read_b64_tr_b16 v[206:207], v37 offset:2560
    v_xor_b32 v37, 160, v33
    v_add_u32_e64 v37, v37, v32
    v_add_u32 v37, 81920, v37
    ds_read_b64_tr_b16 v[216:217], v37 offset:0
    ds_read_b64_tr_b16 v[218:219], v37 offset:512
    ds_read_b64_tr_b16 v[220:221], v37 offset:2048
    ds_read_b64_tr_b16 v[222:223], v37 offset:2560
    s_waitcnt lgkmcnt(0)
    v_xor_b32 v37, 192, v33
    v_add_u32 v37, v37, v32
    v_add_u32 v37, 81920, v37
    ds_read_b64_tr_b16 v[232:233], v37 offset:0
    ds_read_b64_tr_b16 v[234:235], v37 offset:512
    ds_read_b64_tr_b16 v[236:237], v37 offset:2048
    ds_read_b64_tr_b16 v[238:239], v37 offset:2560
    v_xor_b32 v37, 224, v33
    v_add_u32_e64 v37, v37, v32
    v_add_u32 v37, 81920, v37
    ds_read_b64_tr_b16 v[248:249], v37 offset:0
    ds_read_b64_tr_b16 v[250:251], v37 offset:512
    ds_read_b64_tr_b16 v[252:253], v37 offset:2048
    ds_read_b64_tr_b16 v[254:255], v37 offset:2560
    s_waitcnt lgkmcnt(0)
L_wo_7:
    s_waitcnt lgkmcnt(0)
    s_barrier
    s_lshl_b32 s41, s5, 12
    s_add_u32 m0, s41, 81920
    s_mov_b32 s42, 2621440
    buffer_load_dwordx4 v24, s[80:83], s42 offen lds
    s_lshl_b32 s41, s5, 12
    s_nop 0
    s_add_u32 m0, s41, 82944
    s_mov_b32 s42, 2621440
    buffer_load_dwordx4 v25, s[80:83], s42 offen lds
    s_lshl_b32 s41, s5, 12
    s_nop 0
    s_add_u32 m0, s41, 83968
    s_mov_b32 s42, 2621440
    buffer_load_dwordx4 v26, s[80:83], s42 offen lds
    s_lshl_b32 s41, s5, 12
    s_nop 0
    s_add_u32 m0, s41, 84992
    s_mov_b32 s42, 2621440
    buffer_load_dwordx4 v27, s[80:83], s42 offen lds
    s_waitcnt vmcnt(28)
    s_barrier
    s_cmp_eq_u32 s5, 2
    s_cbranch_scc0 L_wo_8
    v_xor_b32 v37, 0, v33
    v_add_u32 v37, v37, v32
    v_add_u32 v37, 98304, v37
    ds_read_b64_tr_b16 v[136:137], v37 offset:0
    ds_read_b64_tr_b16 v[138:139], v37 offset:512
    ds_read_b64_tr_b16 v[140:141], v37 offset:2048
    ds_read_b64_tr_b16 v[142:143], v37 offset:2560
    v_xor_b32 v37, 32, v33
    v_add_u32 v37, v37, v32
    v_add_u32 v37, 98304, v37
    ds_read_b64_tr_b16 v[152:153], v37 offset:0
    ds_read_b64_tr_b16 v[154:155], v37 offset:512
    ds_read_b64_tr_b16 v[156:157], v37 offset:2048
    ds_read_b64_tr_b16 v[158:159], v37 offset:2560
    s_waitcnt lgkmcnt(0)
    v_xor_b32 v37, 64, v33
    v_add_u32_e64 v37, v37, v32
    v_add_u32 v37, 98304, v37
    ds_read_b64_tr_b16 v[168:169], v37 offset:0
    ds_read_b64_tr_b16 v[170:171], v37 offset:512
    ds_read_b64_tr_b16 v[172:173], v37 offset:2048
    ds_read_b64_tr_b16 v[174:175], v37 offset:2560
    v_xor_b32 v37, 96, v33
    v_add_u32_e64 v37, v37, v32
    v_add_u32 v37, 98304, v37
    ds_read_b64_tr_b16 v[184:185], v37 offset:0
    ds_read_b64_tr_b16 v[186:187], v37 offset:512
    ds_read_b64_tr_b16 v[188:189], v37 offset:2048
    ds_read_b64_tr_b16 v[190:191], v37 offset:2560
    s_waitcnt lgkmcnt(0)
    v_xor_b32 v37, 128, v33
    v_add_u32 v37, v37, v32
    v_add_u32 v37, 98304, v37
    ds_read_b64_tr_b16 v[200:201], v37 offset:0
    ds_read_b64_tr_b16 v[202:203], v37 offset:512
    ds_read_b64_tr_b16 v[204:205], v37 offset:2048
    ds_read_b64_tr_b16 v[206:207], v37 offset:2560
    v_xor_b32 v37, 160, v33
    v_add_u32_e64 v37, v37, v32
    v_add_u32 v37, 98304, v37
    ds_read_b64_tr_b16 v[216:217], v37 offset:0
    ds_read_b64_tr_b16 v[218:219], v37 offset:512
    ds_read_b64_tr_b16 v[220:221], v37 offset:2048
    ds_read_b64_tr_b16 v[222:223], v37 offset:2560
    s_waitcnt lgkmcnt(0)
    v_xor_b32 v37, 192, v33
    v_add_u32 v37, v37, v32
    v_add_u32 v37, 98304, v37
    ds_read_b64_tr_b16 v[232:233], v37 offset:0
    ds_read_b64_tr_b16 v[234:235], v37 offset:512
    ds_read_b64_tr_b16 v[236:237], v37 offset:2048
    ds_read_b64_tr_b16 v[238:239], v37 offset:2560
    v_xor_b32 v37, 224, v33
    v_add_u32_e64 v37, v37, v32
    v_add_u32 v37, 98304, v37
    ds_read_b64_tr_b16 v[248:249], v37 offset:0
    ds_read_b64_tr_b16 v[250:251], v37 offset:512
    ds_read_b64_tr_b16 v[252:253], v37 offset:2048
    ds_read_b64_tr_b16 v[254:255], v37 offset:2560
    s_waitcnt lgkmcnt(0)
L_wo_8:
    s_waitcnt lgkmcnt(0)
    s_barrier
    s_lshl_b32 s41, s5, 12
    s_add_u32 m0, s41, 98304
    s_mov_b32 s42, 3145728
    buffer_load_dwordx4 v24, s[80:83], s42 offen lds
    s_lshl_b32 s41, s5, 12
    s_nop 0
    s_add_u32 m0, s41, 99328
    s_mov_b32 s42, 3145728
    buffer_load_dwordx4 v25, s[80:83], s42 offen lds
    s_lshl_b32 s41, s5, 12
    s_nop 0
    s_add_u32 m0, s41, 100352
    s_mov_b32 s42, 3145728
    buffer_load_dwordx4 v26, s[80:83], s42 offen lds
    s_lshl_b32 s41, s5, 12
    s_nop 0
    s_add_u32 m0, s41, 101376
    s_mov_b32 s42, 3145728
    buffer_load_dwordx4 v27, s[80:83], s42 offen lds
    s_waitcnt vmcnt(28)
    s_barrier
    s_cmp_eq_u32 s5, 3
    s_cbranch_scc0 L_wo_9
    v_xor_b32 v37, 0, v33
    v_add_u32 v37, v37, v32
    v_add_u32 v37, 114688, v37
    ds_read_b64_tr_b16 v[136:137], v37 offset:0
    ds_read_b64_tr_b16 v[138:139], v37 offset:512
    ds_read_b64_tr_b16 v[140:141], v37 offset:2048
    ds_read_b64_tr_b16 v[142:143], v37 offset:2560
    v_xor_b32 v37, 32, v33
    v_add_u32 v37, v37, v32
    v_add_u32 v37, 114688, v37
    ds_read_b64_tr_b16 v[152:153], v37 offset:0
    ds_read_b64_tr_b16 v[154:155], v37 offset:512
    ds_read_b64_tr_b16 v[156:157], v37 offset:2048
    ds_read_b64_tr_b16 v[158:159], v37 offset:2560
    s_waitcnt lgkmcnt(0)
    v_xor_b32 v37, 64, v33
    v_add_u32_e64 v37, v37, v32
    v_add_u32 v37, 114688, v37
    ds_read_b64_tr_b16 v[168:169], v37 offset:0
    ds_read_b64_tr_b16 v[170:171], v37 offset:512
    ds_read_b64_tr_b16 v[172:173], v37 offset:2048
    ds_read_b64_tr_b16 v[174:175], v37 offset:2560
    v_xor_b32 v37, 96, v33
    v_add_u32_e64 v37, v37, v32
    v_add_u32 v37, 114688, v37
    ds_read_b64_tr_b16 v[184:185], v37 offset:0
    ds_read_b64_tr_b16 v[186:187], v37 offset:512
    ds_read_b64_tr_b16 v[188:189], v37 offset:2048
    ds_read_b64_tr_b16 v[190:191], v37 offset:2560
    s_waitcnt lgkmcnt(0)
    v_xor_b32 v37, 128, v33
    v_add_u32 v37, v37, v32
    v_add_u32 v37, 114688, v37
    ds_read_b64_tr_b16 v[200:201], v37 offset:0
    ds_read_b64_tr_b16 v[202:203], v37 offset:512
    ds_read_b64_tr_b16 v[204:205], v37 offset:2048
    ds_read_b64_tr_b16 v[206:207], v37 offset:2560
    v_xor_b32 v37, 160, v33
    v_add_u32_e64 v37, v37, v32
    v_add_u32 v37, 114688, v37
    ds_read_b64_tr_b16 v[216:217], v37 offset:0
    ds_read_b64_tr_b16 v[218:219], v37 offset:512
    ds_read_b64_tr_b16 v[220:221], v37 offset:2048
    ds_read_b64_tr_b16 v[222:223], v37 offset:2560
    s_waitcnt lgkmcnt(0)
    v_xor_b32 v37, 192, v33
    v_add_u32 v37, v37, v32
    v_add_u32 v37, 114688, v37
    ds_read_b64_tr_b16 v[232:233], v37 offset:0
    ds_read_b64_tr_b16 v[234:235], v37 offset:512
    ds_read_b64_tr_b16 v[236:237], v37 offset:2048
    ds_read_b64_tr_b16 v[238:239], v37 offset:2560
    v_xor_b32 v37, 224, v33
    v_add_u32_e64 v37, v37, v32
    v_add_u32 v37, 114688, v37
    ds_read_b64_tr_b16 v[248:249], v37 offset:0
    ds_read_b64_tr_b16 v[250:251], v37 offset:512
    ds_read_b64_tr_b16 v[252:253], v37 offset:2048
    ds_read_b64_tr_b16 v[254:255], v37 offset:2560
    s_waitcnt lgkmcnt(0)
L_wo_9:
    s_waitcnt lgkmcnt(0)
    s_barrier
    s_lshl_b32 s41, s5, 12
    s_add_u32 m0, s41, 114688
    s_mov_b32 s42, 3670016
    buffer_load_dwordx4 v24, s[80:83], s42 offen lds
    s_lshl_b32 s41, s5, 12
    s_nop 0
    s_add_u32 m0, s41, 115712
    s_mov_b32 s42, 3670016
    buffer_load_dwordx4 v25, s[80:83], s42 offen lds
    s_lshl_b32 s41, s5, 12
    s_nop 0
    s_add_u32 m0, s41, 116736
    s_mov_b32 s42, 3670016
    buffer_load_dwordx4 v26, s[80:83], s42 offen lds
    s_lshl_b32 s41, s5, 12
    s_nop 0
    s_add_u32 m0, s41, 117760
    s_mov_b32 s42, 3670016
    buffer_load_dwordx4 v27, s[80:83], s42 offen lds
    s_waitcnt vmcnt(28)
    s_barrier
    v_add_u32 v37, 0, v35
    v_add_u32 v38, 0, v36
    ds_read_b64_tr_b16 v[40:41], v37 offset:0
    ds_read_b64_tr_b16 v[42:43], v37 offset:512
    ds_read_b64_tr_b16 v[44:45], v37 offset:2048
    ds_read_b64_tr_b16 v[46:47], v37 offset:2560
    ds_read_b64_tr_b16 v[48:49], v38 offset:0
    ds_read_b64_tr_b16 v[50:51], v38 offset:512
    ds_read_b64_tr_b16 v[52:53], v38 offset:2048
    ds_read_b64_tr_b16 v[54:55], v38 offset:2560
    s_waitcnt lgkmcnt(0)
    s_barrier
    ds_write_b128 v2, v[40:43] offset:0
    ds_write_b128 v2, v[44:47] offset:1024
    ds_write_b128 v2, v[48:51] offset:2048
    ds_write_b128 v2, v[52:55] offset:3072
    s_waitcnt lgkmcnt(0)
    s_waitcnt vmcnt(24)
    s_barrier
    s_nop 0
    v_add_u32 v37, 16384, v35
    v_add_u32 v38, 16384, v36
    ds_read_b64_tr_b16 v[40:41], v37 offset:0
    ds_read_b64_tr_b16 v[42:43], v37 offset:512
    ds_read_b64_tr_b16 v[44:45], v37 offset:2048
    ds_read_b64_tr_b16 v[46:47], v37 offset:2560
    ds_read_b64_tr_b16 v[48:49], v38 offset:0
    ds_read_b64_tr_b16 v[50:51], v38 offset:512
    ds_read_b64_tr_b16 v[52:53], v38 offset:2048
    ds_read_b64_tr_b16 v[54:55], v38 offset:2560
    s_waitcnt lgkmcnt(0)
    s_barrier
    ds_write_b128 v2, v[40:43] offset:16384
    ds_write_b128 v2, v[44:47] offset:17408
    ds_write_b128 v2, v[48:51] offset:18432
    ds_write_b128 v2, v[52:55] offset:19456
    s_waitcnt lgkmcnt(0)
    s_waitcnt vmcnt(20)
    s_barrier
    s_nop 0
    v_add_u32 v37, 32768, v35
    v_add_u32 v38, 32768, v36
    ds_read_b64_tr_b16 v[40:41], v37 offset:0
    ds_read_b64_tr_b16 v[42:43], v37 offset:512
    ds_read_b64_tr_b16 v[44:45], v37 offset:2048
    ds_read_b64_tr_b16 v[46:47], v37 offset:2560
    ds_read_b64_tr_b16 v[48:49], v38 offset:0
    ds_read_b64_tr_b16 v[50:51], v38 offset:512
    ds_read_b64_tr_b16 v[52:53], v38 offset:2048
    ds_read_b64_tr_b16 v[54:55], v38 offset:2560
    s_waitcnt lgkmcnt(0)
    s_barrier
    ds_write_b128 v2, v[40:43] offset:32768
    ds_write_b128 v2, v[44:47] offset:33792
    ds_write_b128 v2, v[48:51] offset:34816
    ds_write_b128 v2, v[52:55] offset:35840
    s_waitcnt lgkmcnt(0)
    s_waitcnt vmcnt(16)
    s_barrier
    s_nop 0
    v_add_u32 v37, 49152, v35
    v_add_u32 v38, 49152, v36
    ds_read_b64_tr_b16 v[40:41], v37 offset:0
    ds_read_b64_tr_b16 v[42:43], v37 offset:512
    ds_read_b64_tr_b16 v[44:45], v37 offset:2048
    ds_read_b64_tr_b16 v[46:47], v37 offset:2560
    ds_read_b64_tr_b16 v[48:49], v38 offset:0
    ds_read_b64_tr_b16 v[50:51], v38 offset:512
    ds_read_b64_tr_b16 v[52:53], v38 offset:2048
    ds_read_b64_tr_b16 v[54:55], v38 offset:2560
    s_waitcnt lgkmcnt(0)
    s_barrier
    ds_write_b128 v2, v[40:43] offset:49152
    ds_write_b128 v2, v[44:47] offset:50176
    ds_write_b128 v2, v[48:51] offset:51200
    ds_write_b128 v2, v[52:55] offset:52224
    s_waitcnt lgkmcnt(0)
    s_waitcnt vmcnt(12)
    s_barrier
    s_nop 0
    v_add_u32 v37, 65536, v35
    v_add_u32 v38, 65536, v36
    ds_read_b64_tr_b16 v[40:41], v37 offset:0
    ds_read_b64_tr_b16 v[42:43], v37 offset:512
    ds_read_b64_tr_b16 v[44:45], v37 offset:2048
    ds_read_b64_tr_b16 v[46:47], v37 offset:2560
    ds_read_b64_tr_b16 v[48:49], v38 offset:0
    ds_read_b64_tr_b16 v[50:51], v38 offset:512
    ds_read_b64_tr_b16 v[52:53], v38 offset:2048
    ds_read_b64_tr_b16 v[54:55], v38 offset:2560
    s_waitcnt lgkmcnt(0)
    s_barrier
    ds_write_b128 v3, v[40:43] offset:0
    ds_write_b128 v3, v[44:47] offset:1024
    ds_write_b128 v3, v[48:51] offset:2048
    ds_write_b128 v3, v[52:55] offset:3072
    s_waitcnt lgkmcnt(0)
    s_waitcnt vmcnt(8)
    s_barrier
    s_nop 0
    v_add_u32 v37, 81920, v35
    v_add_u32 v38, 81920, v36
    ds_read_b64_tr_b16 v[40:41], v37 offset:0
    ds_read_b64_tr_b16 v[42:43], v37 offset:512
    ds_read_b64_tr_b16 v[44:45], v37 offset:2048
    ds_read_b64_tr_b16 v[46:47], v37 offset:2560
    ds_read_b64_tr_b16 v[48:49], v38 offset:0
    ds_read_b64_tr_b16 v[50:51], v38 offset:512
    ds_read_b64_tr_b16 v[52:53], v38 offset:2048
    ds_read_b64_tr_b16 v[54:55], v38 offset:2560
    s_waitcnt lgkmcnt(0)
    s_barrier
    ds_write_b128 v3, v[40:43] offset:16384
    ds_write_b128 v3, v[44:47] offset:17408
    ds_write_b128 v3, v[48:51] offset:18432
    ds_write_b128 v3, v[52:55] offset:19456
    s_waitcnt lgkmcnt(0)
    s_waitcnt vmcnt(4)
    s_barrier
    s_nop 0
    v_add_u32 v37, 98304, v35
    v_add_u32 v38, 98304, v36
    ds_read_b64_tr_b16 v[40:41], v37 offset:0
    ds_read_b64_tr_b16 v[42:43], v37 offset:512
    ds_read_b64_tr_b16 v[44:45], v37 offset:2048
    ds_read_b64_tr_b16 v[46:47], v37 offset:2560
    ds_read_b64_tr_b16 v[48:49], v38 offset:0
    ds_read_b64_tr_b16 v[50:51], v38 offset:512
    ds_read_b64_tr_b16 v[52:53], v38 offset:2048
    ds_read_b64_tr_b16 v[54:55], v38 offset:2560
    s_waitcnt lgkmcnt(0)
    s_barrier
    ds_write_b128 v3, v[40:43] offset:32768
    ds_write_b128 v3, v[44:47] offset:33792
    ds_write_b128 v3, v[48:51] offset:34816
    ds_write_b128 v3, v[52:55] offset:35840
    s_waitcnt lgkmcnt(0)
    s_waitcnt vmcnt(0)
    s_barrier
    s_nop 0
    v_add_u32 v37, 114688, v35
    v_add_u32 v38, 114688, v36
    ds_read_b64_tr_b16 v[40:41], v37 offset:0
    ds_read_b64_tr_b16 v[42:43], v37 offset:512
    ds_read_b64_tr_b16 v[44:45], v37 offset:2048
    ds_read_b64_tr_b16 v[46:47], v37 offset:2560
    ds_read_b64_tr_b16 v[48:49], v38 offset:0
    ds_read_b64_tr_b16 v[50:51], v38 offset:512
    ds_read_b64_tr_b16 v[52:53], v38 offset:2048
    ds_read_b64_tr_b16 v[54:55], v38 offset:2560
    s_waitcnt lgkmcnt(0)
    s_barrier
    ds_write_b128 v3, v[40:43] offset:49152
    ds_write_b128 v3, v[44:47] offset:50176
    ds_write_b128 v3, v[48:51] offset:51200
    ds_write_b128 v3, v[52:55] offset:52224
    s_waitcnt lgkmcnt(0)
    v_and_b32 v100, 63, v0
    v_lshrrev_b32 v103, 2, v101
    v_and_b32 v104, 3, v101
    v_and_b32 v105, 1, v100
    v_cmp_eq_u32 vcc, 1, v105
    v_mov_b32 v0, 0x44444444
    v_mov_b32 v105, 0xeeeeeeee
    v_cndmask_b32 v0, v0, v105, vcc
    v_lshrrev_b32 v105, 1, v102
    v_lshlrev_b32 v105, 3, v105
    v_add_u32 v105, v105, v103
    v_lshlrev_b32 v1, 6, v105
    v_and_b32 v105, 1, v102
    v_lshlrev_b32 v105, 5, v105
    v_add_u32 v1, v1, v105
    v_lshlrev_b32 v105, 3, v104
    v_add_u32 v1, v1, v105
    v_add_u32 v1, 131072, v1
    s_lshl_b32 s41, s5, 11
    v_add_u32 v5, s41, v4
    s_lshl_b32 s41, s5, 5
    v_add_u32 v105, s41, v101
    v_lshlrev_b32_e64 v6, 4, v105
    v_lshl_add_u32 v6, v102, 2, v6
    v_add_u32 v6, 131072, v6
    v_lshlrev_b32 v7, 5, v105
    v_add_u32 v105, v102, v103
    v_and_b32_e64 v105, 3, v105
    v_lshl_add_u32 v7, v105, 3, v7
    v_add_u32 v7, 131072, v7
    v_lshl_add_u32 v105, v102, 2, v103
    v_lshlrev_b32 v8, 4, v105
    v_lshlrev_b32 v9, 5, v105
    v_and_b32_e64 v105, 1, v104
    v_lshl_add_u32 v8, v105, 3, v8
    v_add_u32 v8, 131072, v8
    v_add_u32 v105, v104, v102
    v_and_b32 v105, 3, v105
    v_lshl_add_u32 v9, v105, 3, v9
    v_add_u32 v9, 131072, v9
    v_lshrrev_b32 v105, 1, v102
    v_lshlrev_b32 v10, 9, v105
    v_and_b32_e64 v105, 1, v102
    v_lshl_add_u32 v10, v105, 3, v10
    v_and_b32_e64 v105, 7, v101
    v_lshl_add_u32 v10, v105, 5, v10
    v_lshrrev_b32_e64 v105, 3, v101
    v_lshl_add_u32 v10, v105, 4, v10
    s_lshr_b32 s41, s5, 1
    s_lshl_b32 s41, s41, 10
    s_and_b32 s42, s5, 1
    s_lshl_b32 s42, s42, 8
    s_add_u32 s41, s41, s42
    s_add_u32 s41, s41, 157696
    v_add_u32 v10, s41, v10
    s_lshl_b32 s41, s5, 3
    v_add_u32 v105, s41, v103
    v_lshlrev_b32_e64 v11, 13, v105
    v_bfe_u32 v105, v101, 1, 1
    v_lshl_add_u32 v11, v105, 12, v11
    v_lshl_add_u32 v105, v103, 1, v105
    s_add_u32 s41, s41, s4
    v_add_u32 v105, s41, v105
    v_and_b32_e64 v105, 31, v105
    v_lshl_add_u32 v11, v105, 7, v11
    v_and_b32_e64 v105, 1, v101
    v_lshl_add_u32 v11, v105, 6, v11
    v_lshl_add_u32 v11, v102, 4, v11
    v_mov_b32 v14, 0
    v_and_b32 v105, 8, v100
    v_cmp_ne_u32 s[22:23], 0, v105
    s_mov_b32 s20, 0x3e0293ee
    s_mov_b32 s21, 0x3e0293ee
    s_mov_b32 s24, 60817408
    s_mov_b32 s25, 60850176
    s_mov_b32 s32, 61341696
    s_mov_b32 s26, 60817408
    s_mov_b32 s27, 60850176
    s_mov_b32 s33, 61349888
    s_lshl_b32 s41, s4, 13
    s_and_b32 s42, s5, 1
    s_lshl_b32 s42, s42, 12
    s_add_u32 s41, s41, s42
    s_add_u32 s28, s41, 60686336
    s_add_u32 s35, s41, 18743296
    s_add_u32 s36, s41, 35520512
    s_lshl_b32 s43, s5, 11
    s_nop 0
    s_add_u32 s30, s43, 61210624
    s_add_u32 s31, s43, 61218816
    s_lshl_b32 s41, s4, 12
    s_lshl_b32 s43, s5, 10
    s_add_u32 s41, s41, s43
    s_add_u32 s34, s41, 52297728
    s_lshl_b32 s41, s4, 2
    s_add_u32 s37, s41, 61407232
    s_add_u32 s38, s41, 61415424
    s_mov_b32 s16, 0
    v_lshrrev_b32 v105, 1, v102
    v_lshlrev_b32_e64 v12, 5, v105
    v_lshl_add_u32 v12, v104, 3, v12
    v_and_b32_e64 v105, 1, v102
    v_lshl_add_u32 v12, v105, 2, v12
    v_bfe_u32 v105, v101, 2, 1
    v_lshl_add_u32 v12, v105, 6, v12
    s_lshl_b32 s41, s4, 8
    s_and_b32 s43, s5, 1
    s_lshl_b32 s43, s43, 7
    s_add_u32 s41, s41, s43
    v_add_u32 v12, s41, v12
    v_and_b32 v105, 8, v100
    v_cmp_ne_u32_e64 vcc, 0, v105
    v_mov_b32 v105, 0x7ff00000
    s_nop 0
    v_cndmask_b32 v12, v12, v105, vcc
    v_bfe_u32 v105, v101, 2, 1
    v_lshlrev_b32_e64 v105, 4, v105
    v_mov_b32 v15, 0x3f80
    v_lshlrev_b32 v15, v105, v15
    v_lshrrev_b32 v105, 3, v101
    v_lshlrev_b32 v105, 1, v105
    v_and_b32 v106, 3, v101
    v_add_u32_e64 v105, v105, v106
    v_bfe_u32 v106, v101, 1, 1
    v_lshlrev_b32 v106, 4, v106
    v_add_u32 v105, v105, v106
    v_cmp_eq_u32 s[56:57], 0, v105
    v_cmp_eq_u32 s[58:59], 1, v105
    v_cmp_eq_u32 s[60:61], 2, v105
    v_cmp_eq_u32 s[62:63], 3, v105
    s_cmp_lt_u32 s5, 2
    s_cbranch_scc1 L_nof_10
    s_mov_b32 s18, 0
L_pw_c0_11:
    s_cmp_eq_u32 s17, 1
    s_cbranch_scc1 L_pw_c0_11_d
    buffer_load_dword v105, off, s[52:55], 32 sc1
    s_waitcnt vmcnt(0)
    v_readfirstlane_b32 s41, v105
    s_nop 3
    s_cmp_ge_u32 s41, 224
    s_cbranch_scc1 L_pw_c0_11_d
    s_sleep 2
    s_add_u32 s18, s18, 1
    s_cmp_lt_u32 s18, 524288
    s_cbranch_scc1 L_pw_c0_11
    s_mov_b32 s17, 1
L_pw_c0_11_d:
    s_mov_b32 s18, 0
L_pw_kv0_12:
    s_cmp_eq_u32 s17, 1
    s_cbranch_scc1 L_pw_kv0_12_d
    buffer_load_dword v105, off, s[8:11], s37 sc1
    s_waitcnt vmcnt(0)
    v_readfirstlane_b32 s41, v105
    s_nop 3
    s_cmp_eq_u32 s41, 1
    s_cbranch_scc1 L_pw_kv0_12_d
    s_sleep 2
    s_add_u32 s18, s18, 1
    s_cmp_lt_u32 s18, 524288
    s_cbranch_scc1 L_pw_kv0_12
    s_mov_b32 s17, 1
L_pw_kv0_12_d:
    s_and_b32 s42, s5, 1
    s_lshl_b32 s42, s42, 12
    s_add_u32 m0, s42, 131072
    s_nop 0
    buffer_load_dwordx4 v4, s[8:11], s35 offen offset:0  lds
    buffer_load_dwordx4 v4, s[8:11], s35 offen offset:1024  lds
    buffer_load_dwordx4 v4, s[8:11], s35 offen offset:2048  lds
    buffer_load_dwordx4 v4, s[8:11], s35 offen offset:3072  lds
    s_add_u32 s35, s35, 262144
    s_and_b32 s42, s5, 1
    s_lshl_b32 s42, s42, 12
    s_add_u32 m0, s42, 147456
    s_nop 0
    s_nop 0
    buffer_load_dwordx4 v4, s[8:11], s36 offen offset:0  lds
    buffer_load_dwordx4 v4, s[8:11], s36 offen offset:1024  lds
    buffer_load_dwordx4 v4, s[8:11], s36 offen offset:2048  lds
    buffer_load_dwordx4 v4, s[8:11], s36 offen offset:3072  lds
    s_add_u32 s36, s36, 262144
    s_add_u32 s37, s37, 128
    buffer_load_dword v13, off, s[8:11], s37 sc1
L_nof_10:
    s_mov_b32 s18, 0
L_pw_team_13:
    s_cmp_eq_u32 s17, 1
    s_cbranch_scc1 L_pw_team_13_d
    buffer_load_dword v105, off, s[52:55], 36 sc1
    s_waitcnt vmcnt(0)
    v_readfirstlane_b32 s41, v105
    s_nop 3
    s_cmp_ge_u32 s41, 32
    s_cbranch_scc1 L_pw_team_13_d
    s_sleep 2
    s_add_u32 s18, s18, 1
    s_cmp_lt_u32 s18, 524288
    s_cbranch_scc1 L_pw_team_13
    s_mov_b32 s17, 1
L_pw_team_13_d:
    s_barrier
    s_nop 0
    ds_read_b128 v[48:51], v2 offset:0
    ds_read_b128 v[52:55], v2 offset:1024
    ds_read_b128 v[56:59], v2 offset:2048
    ds_read_b128 v[60:63], v2 offset:3072
    ds_read_b128 v[64:67], v2 offset:16384
    ds_read_b128 v[68:71], v2 offset:17408
    ds_read_b128 v[72:75], v2 offset:18432
    ds_read_b128 v[76:79], v2 offset:19456
    ds_read_b128 v[80:83], v2 offset:32768
    ds_read_b128 v[84:87], v2 offset:33792
    ds_read_b128 v[88:91], v2 offset:34816
    ds_read_b128 v[92:95], v2 offset:35840
    ds_read_b128 v[96:99], v2 offset:49152
    ds_read_b128 v[100:103], v2 offset:50176
    v_mov_b64 v[104:105], 0
    v_mov_b64 v[106:107], 0
    v_mov_b64 v[108:109], 0
    v_mov_b64 v[110:111], 0
    v_mov_b64 v[112:113], 0
    v_mov_b64 v[114:115], 0
    v_mov_b64 v[116:117], 0
    v_mov_b64 v[118:119], 0
    v_mov_b64 v[120:121], 0
    v_mov_b64 v[122:123], 0
    v_mov_b64 v[124:125], 0
    v_mov_b64 v[126:127], 0
    s_waitcnt vmcnt(0) lgkmcnt(0)
    s_cmp_eq_u32 s5, 0
    s_cselect_b32 s40, 1, 0
    s_mov_b32 s39, 0
    s_sub_u32 s19, s37, 128
    s_barrier
    s_cmp_ge_u32 s5, 2
    s_cbranch_scc1 L_recF_loop
.p2align 3
L_recP_loop:
    ds_read_b64_tr_b16 v[16:17], v1 offset:8192
    ds_read_b64_tr_b16 v[18:19], v1 offset:8448
    ds_read_b64_tr_b16 v[20:21], v1 offset:9216
    ds_read_b64_tr_b16 v[22:23], v1 offset:9472
    ds_read_b64_tr_b16 v[24:25], v1 offset:10240
    ds_read_b64_tr_b16 v[26:27], v1 offset:10496
    ds_read_b64_tr_b16 v[28:29], v1 offset:11264
    ds_read_b64_tr_b16 v[30:31], v1 offset:11520
    ds_read_b64_tr_b16 v[32:33], v1 offset:12288
    ds_read_b64_tr_b16 v[34:35], v1 offset:12544
    ds_read_b64_tr_b16 v[36:37], v1 offset:13312
    ds_read_b64_tr_b16 v[38:39], v1 offset:13568
    ds_read_b64_tr_b16 v[40:41], v1 offset:14336
    ds_read_b64_tr_b16 v[42:43], v1 offset:14592
    ds_read_b64_tr_b16 v[44:45], v1 offset:15360
    ds_read_b64_tr_b16 v[46:47], v1 offset:15616
    s_cmp_eq_u32 s39, 0
    s_cbranch_scc1 L_kvmf_15
    buffer_store_dword v0, off, s[8:11], s38 sc1
    s_add_u32 s38, s38, 128
L_kvmf_15:
    s_mov_b32 s39, s40
    s_waitcnt lgkmcnt(14)
    v_smfmac_f32_16x16x64_bf16 v[104:107], v[16:19], v[48:55], v0
    ds_read_b128 v[48:51], v2 offset:51200
    v_smfmac_f32_16x16x64_bf16 v[112:115], v[16:19], a[0:7], v0
    ds_read_b128 v[52:55], v2 offset:52224
    v_smfmac_f32_16x16x64_bf16 v[108:111], v[16:19], v[56:63], v0
    ds_read_b128 v[56:59], v3 offset:0
    v_smfmac_f32_16x16x64_bf16 v[116:119], v[16:19], a[64:71], v0
    ds_read_b128 v[60:63], v3 offset:1024
    s_waitcnt lgkmcnt(15)
    s_nop 0
    v_smfmac_f32_16x16x64_bf16 v[104:107], v[20:23], v[64:71], v0
    ds_read_b128 v[64:67], v3 offset:2048
    v_smfmac_f32_16x16x64_bf16 v[112:115], v[20:23], a[8:15], v0
    ds_read_b128 v[68:71], v3 offset:3072
    v_smfmac_f32_16x16x64_bf16 v[108:111], v[20:23], v[72:79], v0
    ds_read_b128 v[72:75], v3 offset:16384
    v_smfmac_f32_16x16x64_bf16 v[116:119], v[20:23], a[72:79], v0
    ds_read_b128 v[76:79], v3 offset:17408
    s_waitcnt lgkmcnt(8)
    s_barrier
    v_smfmac_f32_16x16x64_bf16 v[104:107], v[24:27], v[80:87], v0
    ds_read_b128 v[80:83], v3 offset:18432
    v_smfmac_f32_16x16x64_bf16 v[112:115], v[24:27], a[16:23], v0
    ds_read_b128 v[84:87], v3 offset:19456
    v_smfmac_f32_16x16x64_bf16 v[108:111], v[24:27], v[88:95], v0
    ds_read_b128 v[88:91], v3 offset:32768
    v_smfmac_f32_16x16x64_bf16 v[116:119], v[24:27], a[80:87], v0
    ds_read_b128 v[92:95], v3 offset:33792
    v_smfmac_f32_16x16x64_bf16 v[104:107], v[28:31], v[96:103], v0
    ds_read_b128 v[96:99], v3 offset:34816
    v_smfmac_f32_16x16x64_bf16 v[112:115], v[28:31], a[24:31], v0
    ds_read_b128 v[100:103], v3 offset:35840
    s_waitcnt lgkmcnt(12)
    s_nop 0
    v_smfmac_f32_16x16x64_bf16 v[108:111], v[28:31], v[48:55], v0
    ds_read_b128 v[48:51], v3 offset:49152
    v_smfmac_f32_16x16x64_bf16 v[116:119], v[28:31], a[88:95], v0
    ds_read_b128 v[52:55], v3 offset:50176
    s_waitcnt lgkmcnt(12)
    s_nop 0
    v_smfmac_f32_16x16x64_bf16 v[104:107], v[32:35], v[56:63], v0
    ds_read_b128 v[56:59], v3 offset:51200
    v_smfmac_f32_16x16x64_bf16 v[112:115], v[32:35], a[32:39], v0
    ds_read_b128 v[60:63], v3 offset:52224
    s_waitcnt lgkmcnt(12)
    s_nop 0
    v_smfmac_f32_16x16x64_bf16 v[108:111], v[32:35], v[64:71], v0
    ds_read_b128 v[64:67], v4 offset:0
    v_smfmac_f32_16x16x64_bf16 v[116:119], v[32:35], a[96:103], v0
    ds_read_b128 v[68:71], v4 offset:4096
    s_waitcnt lgkmcnt(12)
    s_nop 0
    v_smfmac_f32_16x16x64_bf16 v[104:107], v[36:39], v[72:79], v0
    ds_read_b128 v[72:75], v4 offset:1024
    v_smfmac_f32_16x16x64_bf16 v[112:115], v[36:39], a[40:47], v0
    ds_read_b128 v[76:79], v4 offset:5120
    s_waitcnt lgkmcnt(12)
    s_nop 0
    v_smfmac_f32_16x16x64_bf16 v[108:111], v[36:39], v[80:87], v0
    ds_read_b128 v[80:83], v4 offset:2048
    v_smfmac_f32_16x16x64_bf16 v[116:119], v[36:39], a[104:111], v0
    ds_read_b128 v[84:87], v4 offset:6144
    s_waitcnt lgkmcnt(12)
    s_nop 0
    v_smfmac_f32_16x16x64_bf16 v[104:107], v[40:43], v[88:95], v0
    ds_read_b128 v[88:91], v4 offset:3072
    v_smfmac_f32_16x16x64_bf16 v[112:115], v[40:43], a[48:55], v0
    ds_read_b128 v[92:95], v4 offset:7168
    s_waitcnt lgkmcnt(12)
    s_nop 0
    v_smfmac_f32_16x16x64_bf16 v[108:111], v[40:43], v[96:103], v0
    v_smfmac_f32_16x16x64_bf16 v[116:119], v[40:43], a[112:119], v0
    s_waitcnt lgkmcnt(10)
    v_smfmac_f32_16x16x64_bf16 v[104:107], v[44:47], v[48:55], v0
    s_waitcnt lgkmcnt(8)
    v_smfmac_f32_16x16x64_bf16 v[108:111], v[44:47], v[56:63], v0
    v_smfmac_f32_16x16x64_bf16 v[112:115], v[44:47], a[56:63], v0
    v_smfmac_f32_16x16x64_bf16 v[116:119], v[44:47], a[120:127], v0
    v_add_f32 v104, v104, v105
    v_add_f32 v106, v106, v107
    v_add_f32 v108, v108, v109
    v_add_f32 v110, v110, v111
    v_cvt_pk_bf16_f32 v105, v104, v106
    v_cvt_pk_bf16_f32 v109, v108, v110
    ds_write_b32 v6, v105 offset:24576
    ds_write_b32 v6, v109 offset:24832
    v_add_f32 v112, v112, v113
    v_add_f32 v114, v114, v115
    v_add_f32 v116, v116, v117
    v_add_f32 v118, v118, v119
    v_cvt_pk_bf16_f32 v56, v112, v114
    v_cvt_pk_bf16_f32 v57, v116, v118
    ds_write_b32 v7, v56 offset:28672
    ds_write_b32 v7, v57 offset:29184
    v_smfmac_f32_16x16x64_bf16 v[120:123], v[16:19], a[128:135], v0
    v_smfmac_f32_16x16x64_bf16 v[124:127], v[16:19], a[192:199], v0
    v_smfmac_f32_16x16x64_bf16 v[120:123], v[20:23], a[136:143], v0
    v_smfmac_f32_16x16x64_bf16 v[124:127], v[20:23], a[200:207], v0
    s_waitcnt lgkmcnt(0)
    s_barrier
    ds_read_b64_tr_b16 v[96:97], v8 offset:24576
    ds_read_b64_tr_b16 v[98:99], v8 offset:24832
    ds_read_b64_tr_b16 v[60:61], v9 offset:28672
    ds_read_b64_tr_b16 v[62:63], v9 offset:29184
    ds_read_b64_tr_b16 v[100:101], v8 offset:25088
    ds_read_b64_tr_b16 v[102:103], v8 offset:25344
    ds_read_b64_tr_b16 v[116:117], v9 offset:29696
    ds_read_b64_tr_b16 v[118:119], v9 offset:30208
    ds_read_b64_tr_b16 v[48:49], v8 offset:25600
    ds_read_b64_tr_b16 v[50:51], v8 offset:25856
    ds_read_b64_tr_b16 v[52:53], v8 offset:26112
    ds_read_b64_tr_b16 v[54:55], v8 offset:26368
    v_smfmac_f32_16x16x64_bf16 v[120:123], v[24:27], a[144:151], v0
    v_smfmac_f32_16x16x64_bf16 v[124:127], v[24:27], a[208:215], v0
    v_smfmac_f32_16x16x64_bf16 v[120:123], v[28:31], a[152:159], v0
    v_smfmac_f32_16x16x64_bf16 v[124:127], v[28:31], a[216:223], v0
    s_waitcnt lgkmcnt(10)
    s_nop 0
    v_mfma_f32_16x16x32_bf16 v[104:107], v[64:67], v[96:99], 0
    v_mfma_f32_16x16x32_bf16 v[108:111], v[68:71], v[96:99], 0
    ds_read_b64_tr_b16 v[64:65], v9 offset:30720
    ds_read_b64_tr_b16 v[66:67], v9 offset:31232
    s_waitcnt lgkmcnt(10)
    v_mfma_f32_16x16x32_bf16 v[112:115], v[60:63], v[96:99], 0
    s_waitcnt lgkmcnt(8)
    v_mfma_f32_16x16x32_bf16 v[104:107], v[72:75], v[100:103], v[104:107]
    v_mfma_f32_16x16x32_bf16 v[108:111], v[76:79], v[100:103], v[108:111]
    ds_read_b64_tr_b16 v[72:73], v9 offset:31744
    ds_read_b64_tr_b16 v[74:75], v9 offset:32256
    s_waitcnt lgkmcnt(8)
    v_mfma_f32_16x16x32_bf16 v[112:115], v[116:119], v[100:103], v[112:115]
    s_waitcnt lgkmcnt(6)
    v_mfma_f32_16x16x32_bf16 v[104:107], v[80:83], v[48:51], v[104:107]
    v_mfma_f32_16x16x32_bf16 v[108:111], v[84:87], v[48:51], v[108:111]
    s_waitcnt lgkmcnt(4)
    s_nop 0
    v_mfma_f32_16x16x32_bf16 v[104:107], v[88:91], v[52:55], v[104:107]
    v_mfma_f32_16x16x32_bf16 v[108:111], v[92:95], v[52:55], v[108:111]
    s_waitcnt lgkmcnt(2)
    v_mfma_f32_16x16x32_bf16 v[112:115], v[64:67], v[48:51], v[112:115]
    s_waitcnt lgkmcnt(0)
    v_mfma_f32_16x16x32_bf16 v[112:115], v[72:75], v[52:55], v[112:115]
    ds_read_b128 v[76:79], v5 offset:16384
    ds_read_b128 v[84:87], v5 offset:17408
    v_mov_b32_e64 v92, -1
    buffer_store_dword v92, v12, s[8:11], s32 offen
    v_smfmac_f32_16x16x64_bf16 v[120:123], v[32:35], a[160:167], v0
    v_smfmac_f32_16x16x64_bf16 v[124:127], v[32:35], a[224:231], v0
    v_max3_f32 v68, v104, v105, v106
    v_max3_f32 v69, v107, v108, v109
    v_max3_f32 v68, v68, v110, v111
    v_max3_f32 v69, v69, v112, v113
    v_max_f32 v70, v68, v69
    v_max_f32 v68, v68, v69
    v_smfmac_f32_16x16x64_bf16 v[120:123], v[36:39], a[168:175], v0
    s_nop 0
    v_permlane32_swap_b32 v68, v70
    v_max_f32 v69, v68, v70
    v_max_f32 v68, v68, v70
    v_smfmac_f32_16x16x64_bf16 v[124:127], v[36:39], a[232:239], v0
    s_nop 0
    v_permlane16_swap_b32 v68, v69
    v_max_f32 v68, v68, v69
    v_mul_f32 v68, s20, v68
    v_fma_f32 v104, v104, s20, -v68
    v_fma_f32 v105, v105, s20, -v68
    v_fma_f32 v106, v106, s20, -v68
    v_fma_f32 v107, v107, s20, -v68
    v_fma_f32 v108, v108, s20, -v68
    v_fma_f32 v109, v109, s20, -v68
    v_fma_f32 v110, v110, s20, -v68
    v_fma_f32 v111, v111, s20, -v68
    v_fma_f32 v112, v112, s20, -v68
    v_fma_f32 v113, v113, s20, -v68
    v_exp_f32 v104, v104
    v_exp_f32 v105, v105
    v_smfmac_f32_16x16x64_bf16 v[120:123], v[40:43], a[176:183], v0
    v_exp_f32 v106, v106
    v_exp_f32 v107, v107
    v_smfmac_f32_16x16x64_bf16 v[124:127], v[40:43], a[240:247], v0
    v_exp_f32 v108, v108
    v_exp_f32 v109, v109
    v_smfmac_f32_16x16x64_bf16 v[120:123], v[44:47], a[184:191], v0
    v_exp_f32 v110, v110
    v_exp_f32 v111, v111
    v_smfmac_f32_16x16x64_bf16 v[124:127], v[44:47], a[248:255], v0
    v_exp_f32 v112, v112
    v_exp_f32 v113, v113
    v_cvt_pk_bf16_f32 v72, v104, v105
    v_cvt_pk_bf16_f32 v73, v106, v107
    v_cvt_pk_bf16_f32 v74, v108, v109
    v_cvt_pk_bf16_f32 v75, v110, v111
    v_cvt_pk_bf16_f32 v114, v112, v113
    v_cvt_pk_bf16_f32 v65, v112, v113
    s_waitcnt lgkmcnt(0)
    v_mfma_f32_16x16x32_bf16 v[96:99], v[76:79], v[72:75], 0
    v_mov_b32 v115, 0
    v_mov_b32_e64 v64, 0
    v_mfma_f32_16x16x32_bf16 v[100:103], v[84:87], v[72:75], 0
    v_add_f32 v120, v120, v121
    v_add_f32 v122, v122, v123
    v_add_f32 v124, v124, v125
    v_add_f32 v126, v126, v127
    v_cvt_pk_bf16_f32 v58, v120, v122
    v_cvt_pk_bf16_f32 v59, v124, v126
    v_add_f32 v104, v104, v105
    v_add_f32 v106, v106, v107
    v_mfma_f32_16x16x16_bf16 v[96:99], v[58:59], v[114:115], v[96:99]
    v_add_f32 v108, v108, v109
    v_add_f32 v110, v110, v111
    v_mfma_f32_16x16x16_bf16 v[100:103], v[58:59], v[64:65], v[100:103]
    v_add_f32 v112, v112, v113
    v_add_f32 v104, v104, v106
    v_mfma_f32_32x32x1_2b_f32 v[16:47], v14, v14, 0
    buffer_store_dwordx4 v[56:59], v4, s[8:11], s34 offen sc1
    v_add_f32 v108, v108, v110
    v_add_f32 v104, v104, v112
    v_add_f32 v70, v104, v108
    v_add_f32 v71, v104, v108
    s_add_u32 s34, s34, 131072
    s_nop 0
    v_permlane32_swap_b32 v70, v71
    v_add_f32 v68, v70, v71
    v_add_f32 v70, v70, v71
    s_nop 1
    v_permlane16_swap_b32 v70, v68
    v_add_f32 v70, v70, v68
    v_rcp_f32 v70, v70
    v_cndmask_b32 v96, v96, v100, s[22:23]
    v_cndmask_b32 v97, v97, v101, s[22:23]
    v_cndmask_b32 v98, v98, v102, s[22:23]
    v_cndmask_b32 v99, v99, v103, s[22:23]
    v_mul_f32 v96, v96, v70
    v_mul_f32 v97, v97, v70
    v_mul_f32 v98, v98, v70
    v_mul_f32 v99, v99, v70
    v_cvt_pk_bf16_f32 v96, v96, v97
    v_cvt_pk_bf16_f32 v97, v98, v99
    ds_write_b64 v10, v[96:97]
    s_waitcnt vmcnt(1) lgkmcnt(0)
    s_barrier
    ds_read_b128 v[48:51], v4 offset:26624
    ds_read_b128 v[52:55], v4 offset:27648
    s_waitcnt lgkmcnt(0)
    s_nop 0
    v_smfmac_f32_16x16x64_bf16 v[16:19], v[48:51], v[128:135], v0
    v_smfmac_f32_16x16x64_bf16 v[16:19], v[52:55], v[136:143], v0
    v_smfmac_f32_16x16x64_bf16 v[20:23], v[48:51], v[144:151], v0
    v_smfmac_f32_16x16x64_bf16 v[20:23], v[52:55], v[152:159], v0
    v_add_f32_e64 v16, v16, v17
    v_smfmac_f32_16x16x64_bf16 v[24:27], v[48:51], v[160:167], v0
    v_add_f32_e64 v18, v18, v19
    v_cvt_pk_bf16_f32 v104, v16, v18
    v_smfmac_f32_16x16x64_bf16 v[24:27], v[52:55], v[168:175], v0
    v_and_b32_e64 v104, -2, v104
    v_smfmac_f32_16x16x64_bf16 v[28:31], v[48:51], v[176:183], v0
    v_add_f32 v20, v20, v21
    v_add_f32 v22, v22, v23
    v_smfmac_f32_16x16x64_bf16 v[28:31], v[52:55], v[184:191], v0
    v_cvt_pk_bf16_f32 v105, v20, v22
    v_smfmac_f32_16x16x64_bf16 v[32:35], v[48:51], v[192:199], v0
    v_add_f32 v24, v24, v25
    v_add_f32 v26, v26, v27
    v_smfmac_f32_16x16x64_bf16 v[32:35], v[52:55], v[200:207], v0
    v_cvt_pk_bf16_f32 v106, v24, v26
    v_smfmac_f32_16x16x64_bf16 v[36:39], v[48:51], v[208:215], v0
    v_add_f32 v28, v28, v29
    v_add_f32 v30, v30, v31
    v_smfmac_f32_16x16x64_bf16 v[36:39], v[52:55], v[216:223], v0
    v_cvt_pk_bf16_f32 v107, v28, v30
    buffer_store_dwordx4 v[104:107], v11, s[8:11], s24 offen
    v_smfmac_f32_16x16x64_bf16 v[40:43], v[48:51], v[224:231], v0
    v_add_f32 v32, v32, v33
    v_add_f32 v34, v34, v35
    v_smfmac_f32_16x16x64_bf16 v[40:43], v[52:55], v[232:239], v0
    v_cvt_pk_bf16_f32 v108, v32, v34
    v_smfmac_f32_16x16x64_bf16 v[44:47], v[48:51], v[240:247], v0
    v_and_b32 v108, -2, v108
    v_add_f32 v36, v36, v37
    v_smfmac_f32_16x16x64_bf16 v[44:47], v[52:55], v[248:255], v0
    v_add_f32_e64 v38, v38, v39
    v_cvt_pk_bf16_f32 v109, v36, v38
    v_add_f32 v40, v40, v41
    v_add_f32 v42, v42, v43
    v_cvt_pk_bf16_f32 v110, v40, v42
    s_nop 3
    v_add_f32 v44, v44, v45
    v_add_f32_e64 v46, v46, v47
    v_cvt_pk_bf16_f32 v111, v44, v46
    buffer_store_dwordx4 v[108:111], v11, s[8:11], s25 offen
L_stepend_14:
    ds_read_b128 v[48:51], v2 offset:0
    ds_read_b128 v[52:55], v2 offset:1024
    ds_read_b128 v[56:59], v2 offset:2048
    ds_read_b128 v[60:63], v2 offset:3072
    ds_read_b128 v[64:67], v2 offset:16384
    ds_read_b128 v[68:71], v2 offset:17408
    ds_read_b128 v[72:75], v2 offset:18432
    ds_read_b128 v[76:79], v2 offset:19456
    ds_read_b128 v[80:83], v2 offset:32768
    ds_read_b128 v[84:87], v2 offset:33792
    ds_read_b128 v[88:91], v2 offset:34816
    ds_read_b128 v[92:95], v2 offset:35840
    ds_read_b128 v[96:99], v2 offset:49152
    ds_read_b128 v[100:103], v2 offset:50176
    v_cndmask_b32 v108, v14, v15, s[56:57]
    v_cndmask_b32 v109, v14, v15, s[58:59]
    v_cndmask_b32 v110, v14, v15, s[60:61]
    v_cndmask_b32 v111, v14, v15, s[62:63]
    s_nop 15
    s_mov_b32 s18, 0
    buffer_load_dwordx4 v[16:19], v4, s[8:11], s28 offen offset:0 sc1
    buffer_load_dwordx4 v[20:23], v4, s[8:11], s28 offen offset:1024 sc1
    buffer_load_dwordx4 v[24:27], v4, s[8:11], s28 offen offset:2048 sc1
    buffer_load_dwordx4 v[28:31], v4, s[8:11], s28 offen offset:3072 sc1
    s_nop 15
    s_nop 15
    buffer_load_dwordx4 v[32:35], v4, s[8:11], s28 offen offset:0 sc1
    buffer_load_dwordx4 v[36:39], v4, s[8:11], s28 offen offset:1024 sc1
    buffer_load_dwordx4 v[40:43], v4, s[8:11], s28 offen offset:2048 sc1
    buffer_load_dwordx4 v[44:47], v4, s[8:11], s28 offen offset:3072 sc1
L_h1_16_r:
    s_waitcnt vmcnt(4)
    s_mov_b64 exec, -1
    v_or3_b32 v112, v16, v20, v24
    v_mfma_f32_16x16x32_bf16 v[104:107], v[108:111], v[16:19], 0
    v_or_b32_e64 v112, v112, v28
    v_mfma_f32_16x16x32_bf16 v[104:107], v[108:111], v[20:23], v[104:107]
    v_and_b32_e64 v112, 1, v112
    v_mfma_f32_16x16x32_bf16 v[104:107], v[108:111], v[24:27], v[104:107]
    v_cmp_ne_u32_e64 vcc, 0, v112
    v_mfma_f32_16x16x32_bf16 v[104:107], v[108:111], v[28:31], v[104:107]
    s_cbranch_vccz L_h1_16_d
    s_cmp_eq_u32 s17, 1
    s_cbranch_scc1 L_h1_16_d
    s_mov_b64 exec, vcc
    buffer_load_dwordx4 v[16:19], v4, s[8:11], s28 offen offset:0 sc1
    buffer_load_dwordx4 v[20:23], v4, s[8:11], s28 offen offset:1024 sc1
    buffer_load_dwordx4 v[24:27], v4, s[8:11], s28 offen offset:2048 sc1
    buffer_load_dwordx4 v[28:31], v4, s[8:11], s28 offen offset:3072 sc1
    s_waitcnt vmcnt(4)
    s_mov_b64 exec, -1
    v_or3_b32 v112, v32, v36, v40
    v_mfma_f32_16x16x32_bf16 v[104:107], v[108:111], v[32:35], 0
    v_or_b32_e64 v112, v112, v44
    v_mfma_f32_16x16x32_bf16 v[104:107], v[108:111], v[36:39], v[104:107]
    v_and_b32_e64 v112, 1, v112
    v_mfma_f32_16x16x32_bf16 v[104:107], v[108:111], v[40:43], v[104:107]
    v_cmp_ne_u32_e64 vcc, 0, v112
    v_mfma_f32_16x16x32_bf16 v[104:107], v[108:111], v[44:47], v[104:107]
    s_cbranch_vccz L_h1_16_d
    s_mov_b64 exec, vcc
    buffer_load_dwordx4 v[32:35], v4, s[8:11], s28 offen offset:0 sc1
    buffer_load_dwordx4 v[36:39], v4, s[8:11], s28 offen offset:1024 sc1
    buffer_load_dwordx4 v[40:43], v4, s[8:11], s28 offen offset:2048 sc1
    buffer_load_dwordx4 v[44:47], v4, s[8:11], s28 offen offset:3072 sc1
    s_add_u32 s18, s18, 1
    s_cmp_lt_u32 s18, 524288
    s_cbranch_scc1 L_h1_16_r
    s_mov_b32 s17, 1
    s_waitcnt vmcnt(0)
    s_mov_b64 exec, -1
L_h1_16_d:
    s_nop 6
    v_add_f32_dpp v104, v104, v104 row_ror:8 row_mask:0xf bank_mask:0xf
    v_add_f32_dpp v105, v105, v105 row_ror:8 row_mask:0xf bank_mask:0xf
    v_cvt_pk_bf16_f32 v104, v104, v105
    buffer_store_dword v104, v12, s[8:11], s32 offen
    s_barrier
    s_nop 15
    s_mov_b32 s18, 0
    s_nop 0
    buffer_load_dwordx4 v[16:19], v4, s[8:11], s30 offen offset:0 sc1
    buffer_load_dwordx4 v[20:23], v4, s[8:11], s30 offen offset:1024 sc1
    v_mov_b64 v[104:105], 0
    v_mov_b64 v[106:107], 0
    v_mov_b64 v[108:109], 0
    v_mov_b64 v[110:111], 0
    v_mov_b64 v[112:113], 0
    v_mov_b64 v[114:115], 0
    v_mov_b64 v[116:117], 0
    v_mov_b64 v[118:119], 0
    v_mov_b64 v[120:121], 0
    v_mov_b64 v[122:123], 0
    v_mov_b64 v[124:125], 0
    v_mov_b64 v[126:127], 0
    s_nop 15
    s_nop 7
    buffer_load_dwordx4 v[24:27], v4, s[8:11], s30 offen offset:0 sc1
    buffer_load_dwordx4 v[28:31], v4, s[8:11], s30 offen offset:1024 sc1
L_h2_17_r:
    s_waitcnt vmcnt(2)
    s_mov_b64 exec, -1
    v_max3_u32 v40, v16, v17, v18
    v_max3_u32 v41, v19, v20, v21
    v_max3_u32 v40, v40, v22, v23
    v_max_u32 v40, v40, v41
    v_cmp_eq_u32 vcc, -1, v40
    s_cbranch_vccz L_h2_17_da
    s_cmp_eq_u32 s17, 1
    s_cbranch_scc1 L_h2_17_da
    s_mov_b64 exec, vcc
    buffer_load_dwordx4 v[16:19], v4, s[8:11], s30 offen offset:0 sc1
    buffer_load_dwordx4 v[20:23], v4, s[8:11], s30 offen offset:1024 sc1
    s_waitcnt vmcnt(2)
    s_mov_b64 exec, -1
    v_max3_u32 v40, v24, v25, v26
    v_max3_u32 v41, v27, v28, v29
    v_max3_u32 v40, v40, v30, v31
    v_max_u32 v40, v40, v41
    v_cmp_eq_u32 vcc, -1, v40
    s_cbranch_vccz L_h2_17_db
    s_mov_b64 exec, vcc
    buffer_load_dwordx4 v[24:27], v4, s[8:11], s30 offen offset:0 sc1
    buffer_load_dwordx4 v[28:31], v4, s[8:11], s30 offen offset:1024 sc1
    s_add_u32 s18, s18, 1
    s_cmp_lt_u32 s18, 524288
    s_cbranch_scc1 L_h2_17_r
    s_mov_b32 s17, 1
    s_waitcnt vmcnt(0)
    s_mov_b64 exec, -1
    s_branch L_h2_17_da
L_h2_17_db:
    ds_write_b128 v5, v[24:27] offset:16384
    ds_write_b128 v5, v[28:31] offset:17408
    s_branch L_h2_17_j
L_h2_17_da:
    s_nop 0
    ds_write_b128 v5, v[16:19] offset:16384
    ds_write_b128 v5, v[20:23] offset:17408
L_h2_17_j:
    s_waitcnt vmcnt(0)
    s_waitcnt lgkmcnt(0)
    s_add_u32 s16, s16, 1
    s_barrier
    ds_read_b64_tr_b16 v[16:17], v1 offset:16384
    ds_read_b64_tr_b16 v[18:19], v1 offset:16640
    ds_read_b64_tr_b16 v[20:21], v1 offset:17408
    ds_read_b64_tr_b16 v[22:23], v1 offset:17664
    ds_read_b64_tr_b16 v[24:25], v1 offset:18432
    ds_read_b64_tr_b16 v[26:27], v1 offset:18688
    ds_read_b64_tr_b16 v[28:29], v1 offset:19456
    ds_read_b64_tr_b16 v[30:31], v1 offset:19712
    ds_read_b64_tr_b16 v[32:33], v1 offset:20480
    ds_read_b64_tr_b16 v[34:35], v1 offset:20736
    ds_read_b64_tr_b16 v[36:37], v1 offset:21504
    ds_read_b64_tr_b16 v[38:39], v1 offset:21760
    ds_read_b64_tr_b16 v[40:41], v1 offset:22528
    ds_read_b64_tr_b16 v[42:43], v1 offset:22784
    ds_read_b64_tr_b16 v[44:45], v1 offset:23552
    ds_read_b64_tr_b16 v[46:47], v1 offset:23808
    s_cmp_eq_u32 s39, 0
    s_cbranch_scc1 L_kvmf_19
    buffer_store_dword v0, off, s[8:11], s38 sc1
    s_add_u32 s38, s38, 128
L_kvmf_19:
    s_mov_b32 s39, s40
    s_waitcnt lgkmcnt(14)
    v_smfmac_f32_16x16x64_bf16 v[104:107], v[16:19], v[48:55], v0
    ds_read_b128 v[48:51], v2 offset:51200
    v_smfmac_f32_16x16x64_bf16 v[112:115], v[16:19], a[0:7], v0
    ds_read_b128 v[52:55], v2 offset:52224
    v_smfmac_f32_16x16x64_bf16 v[108:111], v[16:19], v[56:63], v0
    ds_read_b128 v[56:59], v3 offset:0
    v_smfmac_f32_16x16x64_bf16 v[116:119], v[16:19], a[64:71], v0
    ds_read_b128 v[60:63], v3 offset:1024
    s_waitcnt lgkmcnt(15)
    s_nop 0
    v_smfmac_f32_16x16x64_bf16 v[104:107], v[20:23], v[64:71], v0
    ds_read_b128 v[64:67], v3 offset:2048
    v_smfmac_f32_16x16x64_bf16 v[112:115], v[20:23], a[8:15], v0
    ds_read_b128 v[68:71], v3 offset:3072
    v_smfmac_f32_16x16x64_bf16 v[108:111], v[20:23], v[72:79], v0
    ds_read_b128 v[72:75], v3 offset:16384
    v_smfmac_f32_16x16x64_bf16 v[116:119], v[20:23], a[72:79], v0
    ds_read_b128 v[76:79], v3 offset:17408
    s_waitcnt lgkmcnt(8)
    s_barrier
    v_smfmac_f32_16x16x64_bf16 v[104:107], v[24:27], v[80:87], v0
    ds_read_b128 v[80:83], v3 offset:18432
    v_smfmac_f32_16x16x64_bf16 v[112:115], v[24:27], a[16:23], v0
    ds_read_b128 v[84:87], v3 offset:19456
    v_smfmac_f32_16x16x64_bf16 v[108:111], v[24:27], v[88:95], v0
    ds_read_b128 v[88:91], v3 offset:32768
    v_smfmac_f32_16x16x64_bf16 v[116:119], v[24:27], a[80:87], v0
    ds_read_b128 v[92:95], v3 offset:33792
    v_smfmac_f32_16x16x64_bf16 v[104:107], v[28:31], v[96:103], v0
    ds_read_b128 v[96:99], v3 offset:34816
    v_smfmac_f32_16x16x64_bf16 v[112:115], v[28:31], a[24:31], v0
    ds_read_b128 v[100:103], v3 offset:35840
    s_waitcnt lgkmcnt(12)
    s_nop 0
    v_smfmac_f32_16x16x64_bf16 v[108:111], v[28:31], v[48:55], v0
    ds_read_b128 v[48:51], v3 offset:49152
    v_smfmac_f32_16x16x64_bf16 v[116:119], v[28:31], a[88:95], v0
    ds_read_b128 v[52:55], v3 offset:50176
    s_waitcnt lgkmcnt(12)
    s_nop 0
    v_smfmac_f32_16x16x64_bf16 v[104:107], v[32:35], v[56:63], v0
    ds_read_b128 v[56:59], v3 offset:51200
    v_smfmac_f32_16x16x64_bf16 v[112:115], v[32:35], a[32:39], v0
    ds_read_b128 v[60:63], v3 offset:52224
    s_waitcnt lgkmcnt(12)
    s_nop 0
    v_smfmac_f32_16x16x64_bf16 v[108:111], v[32:35], v[64:71], v0
    ds_read_b128 v[64:67], v4 offset:0
    v_smfmac_f32_16x16x64_bf16 v[116:119], v[32:35], a[96:103], v0
    ds_read_b128 v[68:71], v4 offset:4096
    s_waitcnt lgkmcnt(12)
    s_nop 0
    v_smfmac_f32_16x16x64_bf16 v[104:107], v[36:39], v[72:79], v0
    ds_read_b128 v[72:75], v4 offset:1024
    v_smfmac_f32_16x16x64_bf16 v[112:115], v[36:39], a[40:47], v0
    ds_read_b128 v[76:79], v4 offset:5120
    s_waitcnt lgkmcnt(12)
    s_nop 0
    v_smfmac_f32_16x16x64_bf16 v[108:111], v[36:39], v[80:87], v0
    ds_read_b128 v[80:83], v4 offset:2048
    v_smfmac_f32_16x16x64_bf16 v[116:119], v[36:39], a[104:111], v0
    ds_read_b128 v[84:87], v4 offset:6144
    s_waitcnt lgkmcnt(12)
    s_nop 0
    v_smfmac_f32_16x16x64_bf16 v[104:107], v[40:43], v[88:95], v0
    ds_read_b128 v[88:91], v4 offset:3072
    v_smfmac_f32_16x16x64_bf16 v[112:115], v[40:43], a[48:55], v0
    ds_read_b128 v[92:95], v4 offset:7168
    s_waitcnt lgkmcnt(12)
    s_nop 0
    v_smfmac_f32_16x16x64_bf16 v[108:111], v[40:43], v[96:103], v0
    v_smfmac_f32_16x16x64_bf16 v[116:119], v[40:43], a[112:119], v0
    s_waitcnt lgkmcnt(10)
    v_smfmac_f32_16x16x64_bf16 v[104:107], v[44:47], v[48:55], v0
    s_waitcnt lgkmcnt(8)
    v_smfmac_f32_16x16x64_bf16 v[108:111], v[44:47], v[56:63], v0
    v_smfmac_f32_16x16x64_bf16 v[112:115], v[44:47], a[56:63], v0
    v_smfmac_f32_16x16x64_bf16 v[116:119], v[44:47], a[120:127], v0
    v_add_f32 v104, v104, v105
    v_add_f32 v106, v106, v107
    v_add_f32 v108, v108, v109
    v_add_f32 v110, v110, v111
    v_cvt_pk_bf16_f32 v105, v104, v106
    v_cvt_pk_bf16_f32 v109, v108, v110
    ds_write_b32 v6, v105 offset:24576
    ds_write_b32 v6, v109 offset:24832
    v_add_f32 v112, v112, v113
    v_add_f32 v114, v114, v115
    v_add_f32 v116, v116, v117
    v_add_f32 v118, v118, v119
    v_cvt_pk_bf16_f32 v56, v112, v114
    v_cvt_pk_bf16_f32 v57, v116, v118
    ds_write_b32 v7, v56 offset:28672
    ds_write_b32 v7, v57 offset:29184
    v_smfmac_f32_16x16x64_bf16 v[120:123], v[16:19], a[128:135], v0
    v_smfmac_f32_16x16x64_bf16 v[124:127], v[16:19], a[192:199], v0
    v_smfmac_f32_16x16x64_bf16 v[120:123], v[20:23], a[136:143], v0
    v_smfmac_f32_16x16x64_bf16 v[124:127], v[20:23], a[200:207], v0
    s_waitcnt lgkmcnt(0)
    s_barrier
    ds_read_b64_tr_b16 v[96:97], v8 offset:24576
    ds_read_b64_tr_b16 v[98:99], v8 offset:24832
    ds_read_b64_tr_b16 v[60:61], v9 offset:28672
    ds_read_b64_tr_b16 v[62:63], v9 offset:29184
    ds_read_b64_tr_b16 v[100:101], v8 offset:25088
    ds_read_b64_tr_b16 v[102:103], v8 offset:25344
    ds_read_b64_tr_b16 v[116:117], v9 offset:29696
    ds_read_b64_tr_b16 v[118:119], v9 offset:30208
    ds_read_b64_tr_b16 v[48:49], v8 offset:25600
    ds_read_b64_tr_b16 v[50:51], v8 offset:25856
    ds_read_b64_tr_b16 v[52:53], v8 offset:26112
    ds_read_b64_tr_b16 v[54:55], v8 offset:26368
    v_smfmac_f32_16x16x64_bf16 v[120:123], v[24:27], a[144:151], v0
    v_smfmac_f32_16x16x64_bf16 v[124:127], v[24:27], a[208:215], v0
    v_smfmac_f32_16x16x64_bf16 v[120:123], v[28:31], a[152:159], v0
    v_smfmac_f32_16x16x64_bf16 v[124:127], v[28:31], a[216:223], v0
    s_waitcnt lgkmcnt(10)
    s_nop 0
    v_mfma_f32_16x16x32_bf16 v[104:107], v[64:67], v[96:99], 0
    v_mfma_f32_16x16x32_bf16 v[108:111], v[68:71], v[96:99], 0
    ds_read_b64_tr_b16 v[64:65], v9 offset:30720
    ds_read_b64_tr_b16 v[66:67], v9 offset:31232
    s_waitcnt lgkmcnt(10)
    v_mfma_f32_16x16x32_bf16 v[112:115], v[60:63], v[96:99], 0
    s_waitcnt lgkmcnt(8)
    v_mfma_f32_16x16x32_bf16 v[104:107], v[72:75], v[100:103], v[104:107]
    v_mfma_f32_16x16x32_bf16 v[108:111], v[76:79], v[100:103], v[108:111]
    ds_read_b64_tr_b16 v[72:73], v9 offset:31744
    ds_read_b64_tr_b16 v[74:75], v9 offset:32256
    s_waitcnt lgkmcnt(8)
    v_mfma_f32_16x16x32_bf16 v[112:115], v[116:119], v[100:103], v[112:115]
    s_waitcnt lgkmcnt(6)
    v_mfma_f32_16x16x32_bf16 v[104:107], v[80:83], v[48:51], v[104:107]
    v_mfma_f32_16x16x32_bf16 v[108:111], v[84:87], v[48:51], v[108:111]
    s_waitcnt lgkmcnt(4)
    s_nop 0
    v_mfma_f32_16x16x32_bf16 v[104:107], v[88:91], v[52:55], v[104:107]
    v_mfma_f32_16x16x32_bf16 v[108:111], v[92:95], v[52:55], v[108:111]
    s_waitcnt lgkmcnt(2)
    v_mfma_f32_16x16x32_bf16 v[112:115], v[64:67], v[48:51], v[112:115]
    s_waitcnt lgkmcnt(0)
    v_mfma_f32_16x16x32_bf16 v[112:115], v[72:75], v[52:55], v[112:115]
    ds_read_b128 v[76:79], v5 offset:8192
    ds_read_b128 v[84:87], v5 offset:9216
    v_mov_b32_e64 v92, -1
    buffer_store_dword v92, v12, s[8:11], s33 offen
    v_smfmac_f32_16x16x64_bf16 v[120:123], v[32:35], a[160:167], v0
    v_smfmac_f32_16x16x64_bf16 v[124:127], v[32:35], a[224:231], v0
    v_max3_f32 v68, v104, v105, v106
    v_max3_f32 v69, v107, v108, v109
    v_max3_f32 v68, v68, v110, v111
    v_max3_f32 v69, v69, v112, v113
    v_max_f32 v70, v68, v69
    v_max_f32 v68, v68, v69
    v_smfmac_f32_16x16x64_bf16 v[120:123], v[36:39], a[168:175], v0
    s_nop 0
    v_permlane32_swap_b32 v68, v70
    v_max_f32 v69, v68, v70
    v_max_f32 v68, v68, v70
    v_smfmac_f32_16x16x64_bf16 v[124:127], v[36:39], a[232:239], v0
    s_nop 0
    v_permlane16_swap_b32 v68, v69
    v_max_f32 v68, v68, v69
    v_mul_f32 v68, s20, v68
    v_fma_f32 v104, v104, s20, -v68
    v_fma_f32 v105, v105, s20, -v68
    v_fma_f32 v106, v106, s20, -v68
    v_fma_f32 v107, v107, s20, -v68
    v_fma_f32 v108, v108, s20, -v68
    v_fma_f32 v109, v109, s20, -v68
    v_fma_f32 v110, v110, s20, -v68
    v_fma_f32 v111, v111, s20, -v68
    v_fma_f32 v112, v112, s20, -v68
    v_fma_f32 v113, v113, s20, -v68
    v_exp_f32 v104, v104
    v_exp_f32 v105, v105
    v_smfmac_f32_16x16x64_bf16 v[120:123], v[40:43], a[176:183], v0
    v_exp_f32 v106, v106
    v_exp_f32 v107, v107
    v_smfmac_f32_16x16x64_bf16 v[124:127], v[40:43], a[240:247], v0
    v_exp_f32 v108, v108
    v_exp_f32 v109, v109
    v_smfmac_f32_16x16x64_bf16 v[120:123], v[44:47], a[184:191], v0
    v_exp_f32 v110, v110
    v_exp_f32 v111, v111
    v_smfmac_f32_16x16x64_bf16 v[124:127], v[44:47], a[248:255], v0
    v_exp_f32 v112, v112
    v_exp_f32 v113, v113
    v_cvt_pk_bf16_f32 v72, v104, v105
    v_cvt_pk_bf16_f32 v73, v106, v107
    v_cvt_pk_bf16_f32 v74, v108, v109
    v_cvt_pk_bf16_f32 v75, v110, v111
    v_cvt_pk_bf16_f32 v114, v112, v113
    v_cvt_pk_bf16_f32 v65, v112, v113
    s_waitcnt lgkmcnt(0)
    v_mfma_f32_16x16x32_bf16 v[96:99], v[76:79], v[72:75], 0
    v_mov_b32 v115, 0
    v_mov_b32_e64 v64, 0
    v_mfma_f32_16x16x32_bf16 v[100:103], v[84:87], v[72:75], 0
    v_add_f32 v120, v120, v121
    v_add_f32 v122, v122, v123
    v_add_f32 v124, v124, v125
    v_add_f32 v126, v126, v127
    v_cvt_pk_bf16_f32 v58, v120, v122
    v_cvt_pk_bf16_f32 v59, v124, v126
    v_add_f32 v104, v104, v105
    v_add_f32 v106, v106, v107
    v_mfma_f32_16x16x16_bf16 v[96:99], v[58:59], v[114:115], v[96:99]
    v_add_f32 v108, v108, v109
    v_add_f32 v110, v110, v111
    v_mfma_f32_16x16x16_bf16 v[100:103], v[58:59], v[64:65], v[100:103]
    v_add_f32 v112, v112, v113
    v_add_f32 v104, v104, v106
    v_mfma_f32_32x32x1_2b_f32 v[16:47], v14, v14, 0
    buffer_store_dwordx4 v[56:59], v4, s[8:11], s34 offen sc1
    s_cmp_eq_u32 s16, 63
    s_cbranch_scc1 L_rec_fin
    v_add_f32 v108, v108, v110
    v_add_f32 v104, v104, v112
    v_add_f32 v70, v104, v108
    v_add_f32 v71, v104, v108
    s_add_u32 s34, s34, 131072
    s_nop 0
    v_permlane32_swap_b32 v70, v71
    v_add_f32 v68, v70, v71
    v_add_f32 v70, v70, v71
    s_nop 1
    v_permlane16_swap_b32 v70, v68
    v_add_f32 v70, v70, v68
    v_rcp_f32 v70, v70
    v_cndmask_b32 v96, v96, v100, s[22:23]
    v_cndmask_b32 v97, v97, v101, s[22:23]
    v_cndmask_b32 v98, v98, v102, s[22:23]
    v_cndmask_b32 v99, v99, v103, s[22:23]
    v_mul_f32 v96, v96, v70
    v_mul_f32 v97, v97, v70
    v_mul_f32 v98, v98, v70
    v_mul_f32 v99, v99, v70
    v_cvt_pk_bf16_f32 v96, v96, v97
    v_cvt_pk_bf16_f32 v97, v98, v99
    ds_write_b64 v10, v[96:97]
    s_waitcnt vmcnt(1) lgkmcnt(0)
    s_barrier
    ds_read_b128 v[48:51], v4 offset:26624
    ds_read_b128 v[52:55], v4 offset:27648
    s_waitcnt lgkmcnt(0)
    s_nop 0
    v_smfmac_f32_16x16x64_bf16 v[16:19], v[48:51], v[128:135], v0
    v_smfmac_f32_16x16x64_bf16 v[16:19], v[52:55], v[136:143], v0
    v_smfmac_f32_16x16x64_bf16 v[20:23], v[48:51], v[144:151], v0
    v_smfmac_f32_16x16x64_bf16 v[20:23], v[52:55], v[152:159], v0
    v_add_f32_e64 v16, v16, v17
    v_smfmac_f32_16x16x64_bf16 v[24:27], v[48:51], v[160:167], v0
    v_add_f32_e64 v18, v18, v19
    v_cvt_pk_bf16_f32 v104, v16, v18
    v_smfmac_f32_16x16x64_bf16 v[24:27], v[52:55], v[168:175], v0
    v_or_b32_e64 v104, 1, v104
    v_smfmac_f32_16x16x64_bf16 v[28:31], v[48:51], v[176:183], v0
    v_add_f32 v20, v20, v21
    v_add_f32 v22, v22, v23
    v_smfmac_f32_16x16x64_bf16 v[28:31], v[52:55], v[184:191], v0
    v_cvt_pk_bf16_f32 v105, v20, v22
    v_smfmac_f32_16x16x64_bf16 v[32:35], v[48:51], v[192:199], v0
    v_add_f32 v24, v24, v25
    v_add_f32 v26, v26, v27
    v_smfmac_f32_16x16x64_bf16 v[32:35], v[52:55], v[200:207], v0
    v_cvt_pk_bf16_f32 v106, v24, v26
    v_smfmac_f32_16x16x64_bf16 v[36:39], v[48:51], v[208:215], v0
    v_add_f32 v28, v28, v29
    v_add_f32 v30, v30, v31
    v_smfmac_f32_16x16x64_bf16 v[36:39], v[52:55], v[216:223], v0
    v_cvt_pk_bf16_f32 v107, v28, v30
    buffer_store_dwordx4 v[104:107], v11, s[8:11], s24 offen
    v_smfmac_f32_16x16x64_bf16 v[40:43], v[48:51], v[224:231], v0
    v_add_f32 v32, v32, v33
    v_add_f32 v34, v34, v35
    v_smfmac_f32_16x16x64_bf16 v[40:43], v[52:55], v[232:239], v0
    v_cvt_pk_bf16_f32 v108, v32, v34
    v_smfmac_f32_16x16x64_bf16 v[44:47], v[48:51], v[240:247], v0
    v_or_b32 v108, 1, v108
    v_add_f32 v36, v36, v37
    v_smfmac_f32_16x16x64_bf16 v[44:47], v[52:55], v[248:255], v0
    v_add_f32_e64 v38, v38, v39
    v_cvt_pk_bf16_f32 v109, v36, v38
    v_add_f32 v40, v40, v41
    v_add_f32 v42, v42, v43
    v_cvt_pk_bf16_f32 v110, v40, v42
    s_nop 3
    v_add_f32 v44, v44, v45
    v_add_f32_e64 v46, v46, v47
    v_cvt_pk_bf16_f32 v111, v44, v46
    buffer_store_dwordx4 v[108:111], v11, s[8:11], s25 offen
L_stepend_18:
    ds_read_b128 v[48:51], v2 offset:0
    ds_read_b128 v[52:55], v2 offset:1024
    ds_read_b128 v[56:59], v2 offset:2048
    ds_read_b128 v[60:63], v2 offset:3072
    ds_read_b128 v[64:67], v2 offset:16384
    ds_read_b128 v[68:71], v2 offset:17408
    ds_read_b128 v[72:75], v2 offset:18432
    ds_read_b128 v[76:79], v2 offset:19456
    ds_read_b128 v[80:83], v2 offset:32768
    ds_read_b128 v[84:87], v2 offset:33792
    ds_read_b128 v[88:91], v2 offset:34816
    ds_read_b128 v[92:95], v2 offset:35840
    ds_read_b128 v[96:99], v2 offset:49152
    ds_read_b128 v[100:103], v2 offset:50176
    v_cndmask_b32 v108, v14, v15, s[56:57]
    v_cndmask_b32 v109, v14, v15, s[58:59]
    v_cndmask_b32 v110, v14, v15, s[60:61]
    v_cndmask_b32 v111, v14, v15, s[62:63]
    s_nop 15
    s_mov_b32 s18, 0
    buffer_load_dwordx4 v[16:19], v4, s[8:11], s28 offen offset:0 sc1
    buffer_load_dwordx4 v[20:23], v4, s[8:11], s28 offen offset:1024 sc1
    buffer_load_dwordx4 v[24:27], v4, s[8:11], s28 offen offset:2048 sc1
    buffer_load_dwordx4 v[28:31], v4, s[8:11], s28 offen offset:3072 sc1
    s_nop 15
    s_nop 15
    buffer_load_dwordx4 v[32:35], v4, s[8:11], s28 offen offset:0 sc1
    buffer_load_dwordx4 v[36:39], v4, s[8:11], s28 offen offset:1024 sc1
    buffer_load_dwordx4 v[40:43], v4, s[8:11], s28 offen offset:2048 sc1
    buffer_load_dwordx4 v[44:47], v4, s[8:11], s28 offen offset:3072 sc1
L_h1_20_r:
    s_waitcnt vmcnt(4)
    s_mov_b64 exec, -1
    v_bitop3_b32 v112, v16, v20, v24 bitop3:0x80
    v_mfma_f32_16x16x32_bf16 v[104:107], v[108:111], v[16:19], 0
    v_and_b32_e64 v112, v112, v28
    v_mfma_f32_16x16x32_bf16 v[104:107], v[108:111], v[20:23], v[104:107]
    v_and_b32_e64 v112, 1, v112
    v_mfma_f32_16x16x32_bf16 v[104:107], v[108:111], v[24:27], v[104:107]
    v_cmp_ne_u32_e64 vcc, 1, v112
    v_mfma_f32_16x16x32_bf16 v[104:107], v[108:111], v[28:31], v[104:107]
    s_cbranch_vccz L_h1_20_d
    s_cmp_eq_u32 s17, 1
    s_cbranch_scc1 L_h1_20_d
    s_mov_b64 exec, vcc
    buffer_load_dwordx4 v[16:19], v4, s[8:11], s28 offen offset:0 sc1
    buffer_load_dwordx4 v[20:23], v4, s[8:11], s28 offen offset:1024 sc1
    buffer_load_dwordx4 v[24:27], v4, s[8:11], s28 offen offset:2048 sc1
    buffer_load_dwordx4 v[28:31], v4, s[8:11], s28 offen offset:3072 sc1
    s_waitcnt vmcnt(4)
    s_mov_b64 exec, -1
    v_bitop3_b32 v112, v32, v36, v40 bitop3:0x80
    v_mfma_f32_16x16x32_bf16 v[104:107], v[108:111], v[32:35], 0
    v_and_b32_e64 v112, v112, v44
    v_mfma_f32_16x16x32_bf16 v[104:107], v[108:111], v[36:39], v[104:107]
    v_and_b32_e64 v112, 1, v112
    v_mfma_f32_16x16x32_bf16 v[104:107], v[108:111], v[40:43], v[104:107]
    v_cmp_ne_u32_e64 vcc, 1, v112
    v_mfma_f32_16x16x32_bf16 v[104:107], v[108:111], v[44:47], v[104:107]
    s_cbranch_vccz L_h1_20_d
    s_mov_b64 exec, vcc
    buffer_load_dwordx4 v[32:35], v4, s[8:11], s28 offen offset:0 sc1
    buffer_load_dwordx4 v[36:39], v4, s[8:11], s28 offen offset:1024 sc1
    buffer_load_dwordx4 v[40:43], v4, s[8:11], s28 offen offset:2048 sc1
    buffer_load_dwordx4 v[44:47], v4, s[8:11], s28 offen offset:3072 sc1
    s_add_u32 s18, s18, 1
    s_cmp_lt_u32 s18, 524288
    s_cbranch_scc1 L_h1_20_r
    s_mov_b32 s17, 1
    s_waitcnt vmcnt(0)
    s_mov_b64 exec, -1
L_h1_20_d:
    s_nop 6
    v_add_f32_dpp v104, v104, v104 row_ror:8 row_mask:0xf bank_mask:0xf
    v_add_f32_dpp v105, v105, v105 row_ror:8 row_mask:0xf bank_mask:0xf
    v_cvt_pk_bf16_f32 v104, v104, v105
    buffer_store_dword v104, v12, s[8:11], s33 offen
    s_barrier
    s_nop 15
    s_mov_b32 s18, 0
    s_nop 0
    buffer_load_dwordx4 v[16:19], v4, s[8:11], s31 offen offset:0 sc1
    buffer_load_dwordx4 v[20:23], v4, s[8:11], s31 offen offset:1024 sc1
    v_mov_b64 v[104:105], 0
    v_mov_b64 v[106:107], 0
    v_mov_b64 v[108:109], 0
    v_mov_b64 v[110:111], 0
    v_mov_b64 v[112:113], 0
    v_mov_b64 v[114:115], 0
    v_mov_b64 v[116:117], 0
    v_mov_b64 v[118:119], 0
    v_mov_b64 v[120:121], 0
    v_mov_b64 v[122:123], 0
    v_mov_b64 v[124:125], 0
    v_mov_b64 v[126:127], 0
    s_nop 15
    s_nop 7
    buffer_load_dwordx4 v[24:27], v4, s[8:11], s31 offen offset:0 sc1
    buffer_load_dwordx4 v[28:31], v4, s[8:11], s31 offen offset:1024 sc1
L_h2_21_r:
    s_waitcnt vmcnt(2)
    s_mov_b64 exec, -1
    v_max3_u32 v40, v16, v17, v18
    v_max3_u32 v41, v19, v20, v21
    v_max3_u32 v40, v40, v22, v23
    v_max_u32 v40, v40, v41
    v_cmp_eq_u32 vcc, -1, v40
    s_cbranch_vccz L_h2_21_da
    s_cmp_eq_u32 s17, 1
    s_cbranch_scc1 L_h2_21_da
    s_mov_b64 exec, vcc
    buffer_load_dwordx4 v[16:19], v4, s[8:11], s31 offen offset:0 sc1
    buffer_load_dwordx4 v[20:23], v4, s[8:11], s31 offen offset:1024 sc1
    s_waitcnt vmcnt(2)
    s_mov_b64 exec, -1
    v_max3_u32 v40, v24, v25, v26
    v_max3_u32 v41, v27, v28, v29
    v_max3_u32 v40, v40, v30, v31
    v_max_u32 v40, v40, v41
    v_cmp_eq_u32 vcc, -1, v40
    s_cbranch_vccz L_h2_21_db
    s_mov_b64 exec, vcc
    buffer_load_dwordx4 v[24:27], v4, s[8:11], s31 offen offset:0 sc1
    buffer_load_dwordx4 v[28:31], v4, s[8:11], s31 offen offset:1024 sc1
    s_add_u32 s18, s18, 1
    s_cmp_lt_u32 s18, 524288
    s_cbranch_scc1 L_h2_21_r
    s_mov_b32 s17, 1
    s_waitcnt vmcnt(0)
    s_mov_b64 exec, -1
    s_branch L_h2_21_da
L_h2_21_db:
    ds_write_b128 v5, v[24:27] offset:8192
    ds_write_b128 v5, v[28:31] offset:9216
    s_branch L_h2_21_j
L_h2_21_da:
    s_nop 0
    ds_write_b128 v5, v[16:19] offset:8192
    ds_write_b128 v5, v[20:23] offset:9216
L_h2_21_j:
    s_waitcnt vmcnt(0)
    s_waitcnt lgkmcnt(0)
    s_add_u32 s16, s16, 1
    s_barrier
    s_branch L_recP_loop
.p2align 3
L_recF_loop:
    ds_read_b64_tr_b16 v[16:17], v1 offset:8192
    ds_read_b64_tr_b16 v[18:19], v1 offset:8448
    ds_read_b64_tr_b16 v[20:21], v1 offset:9216
    ds_read_b64_tr_b16 v[22:23], v1 offset:9472
    ds_read_b64_tr_b16 v[24:25], v1 offset:10240
    ds_read_b64_tr_b16 v[26:27], v1 offset:10496
    ds_read_b64_tr_b16 v[28:29], v1 offset:11264
    ds_read_b64_tr_b16 v[30:31], v1 offset:11520
    ds_read_b64_tr_b16 v[32:33], v1 offset:12288
    ds_read_b64_tr_b16 v[34:35], v1 offset:12544
    ds_read_b64_tr_b16 v[36:37], v1 offset:13312
    ds_read_b64_tr_b16 v[38:39], v1 offset:13568
    ds_read_b64_tr_b16 v[40:41], v1 offset:14336
    ds_read_b64_tr_b16 v[42:43], v1 offset:14592
    ds_read_b64_tr_b16 v[44:45], v1 offset:15360
    ds_read_b64_tr_b16 v[46:47], v1 offset:15616
    v_readfirstlane_b32 s41, v13
    s_nop 3
    s_cmp_eq_u32 s41, 1
    s_cbranch_scc1 L_kvok_23
    s_mov_b32 s18, 0
L_pw_kv_24:
    s_cmp_eq_u32 s17, 1
    s_cbranch_scc1 L_pw_kv_24_d
    buffer_load_dword v13, off, s[8:11], s37 sc1
    s_waitcnt vmcnt(0)
    v_readfirstlane_b32 s41, v13
    s_nop 3
    s_cmp_eq_u32 s41, 1
    s_cbranch_scc1 L_pw_kv_24_d
    s_sleep 2
    s_add_u32 s18, s18, 1
    s_cmp_lt_u32 s18, 524288
    s_cbranch_scc1 L_pw_kv_24
    s_mov_b32 s17, 1
L_pw_kv_24_d:
L_kvok_23:
    s_waitcnt lgkmcnt(14)
    s_nop 0
    v_smfmac_f32_16x16x64_bf16 v[104:107], v[16:19], v[48:55], v0
    ds_read_b128 v[48:51], v2 offset:51200
    v_smfmac_f32_16x16x64_bf16 v[112:115], v[16:19], a[0:7], v0
    ds_read_b128 v[52:55], v2 offset:52224
    v_smfmac_f32_16x16x64_bf16 v[108:111], v[16:19], v[56:63], v0
    ds_read_b128 v[56:59], v3 offset:0
    v_smfmac_f32_16x16x64_bf16 v[116:119], v[16:19], a[64:71], v0
    ds_read_b128 v[60:63], v3 offset:1024
    s_waitcnt lgkmcnt(15)
    s_nop 0
    v_smfmac_f32_16x16x64_bf16 v[104:107], v[20:23], v[64:71], v0
    ds_read_b128 v[64:67], v3 offset:2048
    v_smfmac_f32_16x16x64_bf16 v[112:115], v[20:23], a[8:15], v0
    ds_read_b128 v[68:71], v3 offset:3072
    v_smfmac_f32_16x16x64_bf16 v[108:111], v[20:23], v[72:79], v0
    ds_read_b128 v[72:75], v3 offset:16384
    v_smfmac_f32_16x16x64_bf16 v[116:119], v[20:23], a[72:79], v0
    ds_read_b128 v[76:79], v3 offset:17408
    s_waitcnt lgkmcnt(8)
    s_barrier
    v_smfmac_f32_16x16x64_bf16 v[104:107], v[24:27], v[80:87], v0
    ds_read_b128 v[80:83], v3 offset:18432
    s_and_b32 s42, s5, 1
    s_lshl_b32 s42, s42, 12
    s_add_u32 m0, s42, 139264
    s_nop 0
    s_nop 0
    buffer_load_dwordx4 v4, s[8:11], s36 offen offset:0  lds
    v_smfmac_f32_16x16x64_bf16 v[112:115], v[24:27], a[16:23], v0
    ds_read_b128 v[84:87], v3 offset:19456
    v_smfmac_f32_16x16x64_bf16 v[108:111], v[24:27], v[88:95], v0
    ds_read_b128 v[88:91], v3 offset:32768
    v_smfmac_f32_16x16x64_bf16 v[116:119], v[24:27], a[80:87], v0
    ds_read_b128 v[92:95], v3 offset:33792
    v_smfmac_f32_16x16x64_bf16 v[104:107], v[28:31], v[96:103], v0
    ds_read_b128 v[96:99], v3 offset:34816
    buffer_load_dwordx4 v4, s[8:11], s36 offen offset:1024  lds
    v_smfmac_f32_16x16x64_bf16 v[112:115], v[28:31], a[24:31], v0
    ds_read_b128 v[100:103], v3 offset:35840
    s_waitcnt lgkmcnt(12)
    s_nop 0
    v_smfmac_f32_16x16x64_bf16 v[108:111], v[28:31], v[48:55], v0
    ds_read_b128 v[48:51], v3 offset:49152
    v_smfmac_f32_16x16x64_bf16 v[116:119], v[28:31], a[88:95], v0
    ds_read_b128 v[52:55], v3 offset:50176
    s_waitcnt lgkmcnt(12)
    s_nop 0
    v_smfmac_f32_16x16x64_bf16 v[104:107], v[32:35], v[56:63], v0
    ds_read_b128 v[56:59], v3 offset:51200
    buffer_load_dwordx4 v4, s[8:11], s36 offen offset:2048  lds
    v_smfmac_f32_16x16x64_bf16 v[112:115], v[32:35], a[32:39], v0
    ds_read_b128 v[60:63], v3 offset:52224
    s_waitcnt lgkmcnt(12)
    s_nop 0
    v_smfmac_f32_16x16x64_bf16 v[108:111], v[32:35], v[64:71], v0
    ds_read_b128 v[64:67], v4 offset:0
    v_smfmac_f32_16x16x64_bf16 v[116:119], v[32:35], a[96:103], v0
    ds_read_b128 v[68:71], v4 offset:4096
    s_waitcnt lgkmcnt(12)
    s_nop 0
    v_smfmac_f32_16x16x64_bf16 v[104:107], v[36:39], v[72:79], v0
    ds_read_b128 v[72:75], v4 offset:1024
    buffer_load_dwordx4 v4, s[8:11], s36 offen offset:3072  lds
    v_smfmac_f32_16x16x64_bf16 v[112:115], v[36:39], a[40:47], v0
    ds_read_b128 v[76:79], v4 offset:5120
    s_waitcnt lgkmcnt(12)
    s_nop 0
    v_smfmac_f32_16x16x64_bf16 v[108:111], v[36:39], v[80:87], v0
    ds_read_b128 v[80:83], v4 offset:2048
    v_smfmac_f32_16x16x64_bf16 v[116:119], v[36:39], a[104:111], v0
    ds_read_b128 v[84:87], v4 offset:6144
    s_waitcnt lgkmcnt(12)
    s_nop 0
    v_smfmac_f32_16x16x64_bf16 v[104:107], v[40:43], v[88:95], v0
    ds_read_b128 v[88:91], v4 offset:3072
    s_add_u32 s36, s36, 262144
    v_smfmac_f32_16x16x64_bf16 v[112:115], v[40:43], a[48:55], v0
    ds_read_b128 v[92:95], v4 offset:7168
    s_waitcnt lgkmcnt(12)
    s_nop 0
    v_smfmac_f32_16x16x64_bf16 v[108:111], v[40:43], v[96:103], v0
    v_smfmac_f32_16x16x64_bf16 v[116:119], v[40:43], a[112:119], v0
    s_waitcnt lgkmcnt(10)
    v_smfmac_f32_16x16x64_bf16 v[104:107], v[44:47], v[48:55], v0
    s_waitcnt lgkmcnt(8)
    v_smfmac_f32_16x16x64_bf16 v[108:111], v[44:47], v[56:63], v0
    v_smfmac_f32_16x16x64_bf16 v[112:115], v[44:47], a[56:63], v0
    v_smfmac_f32_16x16x64_bf16 v[116:119], v[44:47], a[120:127], v0
    v_add_f32 v104, v104, v105
    v_add_f32 v106, v106, v107
    v_add_f32 v108, v108, v109
    v_add_f32 v110, v110, v111
    v_cvt_pk_bf16_f32 v105, v104, v106
    v_cvt_pk_bf16_f32 v109, v108, v110
    ds_write_b32 v6, v105 offset:24576
    ds_write_b32 v6, v109 offset:24832
    v_add_f32 v112, v112, v113
    v_add_f32 v114, v114, v115
    v_add_f32 v116, v116, v117
    v_add_f32 v118, v118, v119
    v_cvt_pk_bf16_f32 v56, v112, v114
    v_cvt_pk_bf16_f32 v57, v116, v118
    ds_write_b32 v7, v56 offset:28672
    ds_write_b32 v7, v57 offset:29184
    v_smfmac_f32_16x16x64_bf16 v[120:123], v[16:19], a[128:135], v0
    v_smfmac_f32_16x16x64_bf16 v[124:127], v[16:19], a[192:199], v0
    v_smfmac_f32_16x16x64_bf16 v[120:123], v[20:23], a[136:143], v0
    v_smfmac_f32_16x16x64_bf16 v[124:127], v[20:23], a[200:207], v0
    s_waitcnt lgkmcnt(0)
    s_barrier
    ds_read_b64_tr_b16 v[96:97], v8 offset:24576
    ds_read_b64_tr_b16 v[98:99], v8 offset:24832
    ds_read_b64_tr_b16 v[60:61], v9 offset:28672
    ds_read_b64_tr_b16 v[62:63], v9 offset:29184
    ds_read_b64_tr_b16 v[100:101], v8 offset:25088
    ds_read_b64_tr_b16 v[102:103], v8 offset:25344
    ds_read_b64_tr_b16 v[116:117], v9 offset:29696
    ds_read_b64_tr_b16 v[118:119], v9 offset:30208
    ds_read_b64_tr_b16 v[48:49], v8 offset:25600
    ds_read_b64_tr_b16 v[50:51], v8 offset:25856
    ds_read_b64_tr_b16 v[52:53], v8 offset:26112
    ds_read_b64_tr_b16 v[54:55], v8 offset:26368
    v_smfmac_f32_16x16x64_bf16 v[120:123], v[24:27], a[144:151], v0
    s_and_b32 s42, s5, 1
    s_lshl_b32 s42, s42, 12
    s_add_u32 m0, s42, 131072
    s_nop 0
    s_nop 0
    buffer_load_dwordx4 v4, s[8:11], s35 offen offset:0  lds
    v_smfmac_f32_16x16x64_bf16 v[124:127], v[24:27], a[208:215], v0
    buffer_load_dwordx4 v4, s[8:11], s35 offen offset:1024  lds
    v_smfmac_f32_16x16x64_bf16 v[120:123], v[28:31], a[152:159], v0
    buffer_load_dwordx4 v4, s[8:11], s35 offen offset:2048  lds
    v_smfmac_f32_16x16x64_bf16 v[124:127], v[28:31], a[216:223], v0
    buffer_load_dwordx4 v4, s[8:11], s35 offen offset:3072  lds
    s_waitcnt lgkmcnt(10)
    s_nop 0
    v_mfma_f32_16x16x32_bf16 v[104:107], v[64:67], v[96:99], 0
    v_mfma_f32_16x16x32_bf16 v[108:111], v[68:71], v[96:99], 0
    ds_read_b64_tr_b16 v[64:65], v9 offset:30720
    ds_read_b64_tr_b16 v[66:67], v9 offset:31232
    s_add_u32 s35, s35, 262144
    s_min_u32 s41, s16, 61
    s_add_u32 s41, s41, 2
    s_lshl_b32 s41, s41, 7
    s_add_u32 s37, s41, s19
    buffer_load_dword v13, off, s[8:11], s37 sc1
    s_waitcnt lgkmcnt(10)
    v_mfma_f32_16x16x32_bf16 v[112:115], v[60:63], v[96:99], 0
    s_waitcnt lgkmcnt(8)
    v_mfma_f32_16x16x32_bf16 v[104:107], v[72:75], v[100:103], v[104:107]
    v_mfma_f32_16x16x32_bf16 v[108:111], v[76:79], v[100:103], v[108:111]
    ds_read_b64_tr_b16 v[72:73], v9 offset:31744
    ds_read_b64_tr_b16 v[74:75], v9 offset:32256
    s_waitcnt lgkmcnt(8)
    v_mfma_f32_16x16x32_bf16 v[112:115], v[116:119], v[100:103], v[112:115]
    s_waitcnt lgkmcnt(6)
    v_mfma_f32_16x16x32_bf16 v[104:107], v[80:83], v[48:51], v[104:107]
    v_mfma_f32_16x16x32_bf16 v[108:111], v[84:87], v[48:51], v[108:111]
    s_waitcnt lgkmcnt(4)
    s_nop 0
    v_mfma_f32_16x16x32_bf16 v[104:107], v[88:91], v[52:55], v[104:107]
    v_mfma_f32_16x16x32_bf16 v[108:111], v[92:95], v[52:55], v[108:111]
    s_waitcnt lgkmcnt(2)
    v_mfma_f32_16x16x32_bf16 v[112:115], v[64:67], v[48:51], v[112:115]
    s_waitcnt lgkmcnt(0)
    v_mfma_f32_16x16x32_bf16 v[112:115], v[72:75], v[52:55], v[112:115]
    ds_read_b128 v[76:79], v5 offset:16384
    ds_read_b128 v[84:87], v5 offset:17408
    v_smfmac_f32_16x16x64_bf16 v[120:123], v[32:35], a[160:167], v0
    v_smfmac_f32_16x16x64_bf16 v[124:127], v[32:35], a[224:231], v0
    v_max3_f32 v68, v104, v105, v106
    v_max3_f32 v69, v107, v108, v109
    v_max3_f32 v68, v68, v110, v111
    v_max3_f32 v69, v69, v112, v113
    v_max_f32 v70, v68, v69
    v_max_f32 v68, v68, v69
    v_smfmac_f32_16x16x64_bf16 v[120:123], v[36:39], a[168:175], v0
    s_nop 0
    v_permlane32_swap_b32 v68, v70
    v_max_f32 v69, v68, v70
    v_max_f32 v68, v68, v70
    v_smfmac_f32_16x16x64_bf16 v[124:127], v[36:39], a[232:239], v0
    s_nop 0
    v_permlane16_swap_b32 v68, v69
    v_max_f32 v68, v68, v69
    v_mul_f32 v68, s20, v68
    v_fma_f32 v104, v104, s20, -v68
    v_fma_f32 v105, v105, s20, -v68
    v_fma_f32 v106, v106, s20, -v68
    v_fma_f32 v107, v107, s20, -v68
    v_fma_f32 v108, v108, s20, -v68
    v_fma_f32 v109, v109, s20, -v68
    v_fma_f32 v110, v110, s20, -v68
    v_fma_f32 v111, v111, s20, -v68
    v_fma_f32 v112, v112, s20, -v68
    v_fma_f32 v113, v113, s20, -v68
    v_exp_f32 v104, v104
    v_exp_f32 v105, v105
    v_smfmac_f32_16x16x64_bf16 v[120:123], v[40:43], a[176:183], v0
    v_exp_f32 v106, v106
    v_exp_f32 v107, v107
    v_smfmac_f32_16x16x64_bf16 v[124:127], v[40:43], a[240:247], v0
    v_exp_f32 v108, v108
    v_exp_f32 v109, v109
    v_smfmac_f32_16x16x64_bf16 v[120:123], v[44:47], a[184:191], v0
    v_exp_f32 v110, v110
    v_exp_f32 v111, v111
    v_smfmac_f32_16x16x64_bf16 v[124:127], v[44:47], a[248:255], v0
    v_exp_f32 v112, v112
    v_exp_f32 v113, v113
    v_cvt_pk_bf16_f32 v72, v104, v105
    v_cvt_pk_bf16_f32 v73, v106, v107
    v_cvt_pk_bf16_f32 v74, v108, v109
    v_cvt_pk_bf16_f32 v75, v110, v111
    v_cvt_pk_bf16_f32 v114, v112, v113
    v_cvt_pk_bf16_f32 v65, v112, v113
    s_waitcnt lgkmcnt(0)
    v_mfma_f32_16x16x32_bf16 v[96:99], v[76:79], v[72:75], 0
    v_mov_b32 v115, 0
    v_mov_b32_e64 v64, 0
    v_mfma_f32_16x16x32_bf16 v[100:103], v[84:87], v[72:75], 0
    v_add_f32 v120, v120, v121
    v_add_f32 v122, v122, v123
    v_add_f32 v124, v124, v125
    v_add_f32 v126, v126, v127
    v_cvt_pk_bf16_f32 v58, v120, v122
    v_cvt_pk_bf16_f32 v59, v124, v126
    v_add_f32 v104, v104, v105
    v_add_f32 v106, v106, v107
    v_mfma_f32_16x16x16_bf16 v[96:99], v[58:59], v[114:115], v[96:99]
    v_add_f32 v108, v108, v109
    v_add_f32 v110, v110, v111
    v_mfma_f32_16x16x16_bf16 v[100:103], v[58:59], v[64:65], v[100:103]
    v_add_f32 v112, v112, v113
    v_add_f32 v104, v104, v106
    v_mfma_f32_32x32x1_2b_f32 v[16:47], v14, v14, 0
    buffer_store_dwordx4 v[56:59], v4, s[8:11], s34 offen sc1
    v_add_f32 v108, v108, v110
    v_add_f32 v104, v104, v112
    v_add_f32 v70, v104, v108
    v_add_f32 v71, v104, v108
    s_add_u32 s34, s34, 131072
    s_nop 0
    v_permlane32_swap_b32 v70, v71
    v_add_f32 v68, v70, v71
    v_add_f32 v70, v70, v71
    s_nop 1
    v_permlane16_swap_b32 v70, v68
    v_add_f32 v70, v70, v68
    v_rcp_f32 v70, v70
    v_cndmask_b32 v96, v96, v100, s[22:23]
    v_cndmask_b32 v97, v97, v101, s[22:23]
    v_cndmask_b32 v98, v98, v102, s[22:23]
    v_cndmask_b32 v99, v99, v103, s[22:23]
    v_mul_f32 v96, v96, v70
    v_mul_f32 v97, v97, v70
    v_mul_f32 v98, v98, v70
    v_mul_f32 v99, v99, v70
    v_cvt_pk_bf16_f32 v96, v96, v97
    v_cvt_pk_bf16_f32 v97, v98, v99
    ds_write_b64 v10, v[96:97]
    s_waitcnt lgkmcnt(0)
    s_barrier
    ds_read_b128 v[48:51], v4 offset:26624
    ds_read_b128 v[52:55], v4 offset:27648
    s_waitcnt lgkmcnt(0)
    s_nop 0
    v_smfmac_f32_16x16x64_bf16 v[16:19], v[48:51], v[128:135], v0
    v_smfmac_f32_16x16x64_bf16 v[16:19], v[52:55], v[136:143], v0
    v_smfmac_f32_16x16x64_bf16 v[20:23], v[48:51], v[144:151], v0
    v_smfmac_f32_16x16x64_bf16 v[20:23], v[52:55], v[152:159], v0
    v_add_f32_e64 v16, v16, v17
    v_smfmac_f32_16x16x64_bf16 v[24:27], v[48:51], v[160:167], v0
    v_add_f32_e64 v18, v18, v19
    v_cvt_pk_bf16_f32 v104, v16, v18
    v_smfmac_f32_16x16x64_bf16 v[24:27], v[52:55], v[168:175], v0
    v_and_b32_e64 v104, -2, v104
    v_smfmac_f32_16x16x64_bf16 v[28:31], v[48:51], v[176:183], v0
    v_add_f32 v20, v20, v21
    v_add_f32 v22, v22, v23
    v_smfmac_f32_16x16x64_bf16 v[28:31], v[52:55], v[184:191], v0
    v_cvt_pk_bf16_f32 v105, v20, v22
    v_smfmac_f32_16x16x64_bf16 v[32:35], v[48:51], v[192:199], v0
    v_add_f32 v24, v24, v25
    v_add_f32 v26, v26, v27
    v_smfmac_f32_16x16x64_bf16 v[32:35], v[52:55], v[200:207], v0
    v_cvt_pk_bf16_f32 v106, v24, v26
    v_smfmac_f32_16x16x64_bf16 v[36:39], v[48:51], v[208:215], v0
    v_add_f32 v28, v28, v29
    v_add_f32 v30, v30, v31
    v_smfmac_f32_16x16x64_bf16 v[36:39], v[52:55], v[216:223], v0
    v_cvt_pk_bf16_f32 v107, v28, v30
    buffer_store_dwordx4 v[104:107], v11, s[8:11], s24 offen
    v_smfmac_f32_16x16x64_bf16 v[40:43], v[48:51], v[224:231], v0
    v_add_f32 v32, v32, v33
    v_add_f32 v34, v34, v35
    v_smfmac_f32_16x16x64_bf16 v[40:43], v[52:55], v[232:239], v0
    v_cvt_pk_bf16_f32 v108, v32, v34
    v_smfmac_f32_16x16x64_bf16 v[44:47], v[48:51], v[240:247], v0
    v_and_b32 v108, -2, v108
    v_add_f32 v36, v36, v37
    v_smfmac_f32_16x16x64_bf16 v[44:47], v[52:55], v[248:255], v0
    v_add_f32_e64 v38, v38, v39
    v_cvt_pk_bf16_f32 v109, v36, v38
    v_add_f32 v40, v40, v41
    v_add_f32 v42, v42, v43
    v_cvt_pk_bf16_f32 v110, v40, v42
    s_nop 3
    v_add_f32 v44, v44, v45
    v_add_f32_e64 v46, v46, v47
    v_cvt_pk_bf16_f32 v111, v44, v46
    buffer_store_dwordx4 v[108:111], v11, s[8:11], s25 offen
L_stepend_22:
    ds_read_b128 v[48:51], v2 offset:0
    ds_read_b128 v[52:55], v2 offset:1024
    ds_read_b128 v[56:59], v2 offset:2048
    ds_read_b128 v[60:63], v2 offset:3072
    ds_read_b128 v[64:67], v2 offset:16384
    ds_read_b128 v[68:71], v2 offset:17408
    ds_read_b128 v[72:75], v2 offset:18432
    ds_read_b128 v[76:79], v2 offset:19456
    ds_read_b128 v[80:83], v2 offset:32768
    ds_read_b128 v[84:87], v2 offset:33792
    ds_read_b128 v[88:91], v2 offset:34816
    ds_read_b128 v[92:95], v2 offset:35840
    ds_read_b128 v[96:99], v2 offset:49152
    ds_read_b128 v[100:103], v2 offset:50176
    s_barrier
    s_nop 15
    s_mov_b32 s18, 0
    s_nop 0
    buffer_load_dwordx4 v[16:19], v4, s[8:11], s30 offen offset:0 sc1
    buffer_load_dwordx4 v[20:23], v4, s[8:11], s30 offen offset:1024 sc1
    v_mov_b64 v[104:105], 0
    v_mov_b64 v[106:107], 0
    v_mov_b64 v[108:109], 0
    v_mov_b64 v[110:111], 0
    v_mov_b64 v[112:113], 0
    v_mov_b64 v[114:115], 0
    v_mov_b64 v[116:117], 0
    v_mov_b64 v[118:119], 0
    v_mov_b64 v[120:121], 0
    v_mov_b64 v[122:123], 0
    v_mov_b64 v[124:125], 0
    v_mov_b64 v[126:127], 0
    s_nop 15
    s_nop 7
    buffer_load_dwordx4 v[24:27], v4, s[8:11], s30 offen offset:0 sc1
    buffer_load_dwordx4 v[28:31], v4, s[8:11], s30 offen offset:1024 sc1
L_h2_25_r:
    s_waitcnt vmcnt(2)
    s_mov_b64 exec, -1
    v_max3_u32 v40, v16, v17, v18
    v_max3_u32 v41, v19, v20, v21
    v_max3_u32 v40, v40, v22, v23
    v_max_u32 v40, v40, v41
    v_cmp_eq_u32 vcc, -1, v40
    s_cbranch_vccz L_h2_25_da
    s_cmp_eq_u32 s17, 1
    s_cbranch_scc1 L_h2_25_da
    s_mov_b64 exec, vcc
    buffer_load_dwordx4 v[16:19], v4, s[8:11], s30 offen offset:0 sc1
    buffer_load_dwordx4 v[20:23], v4, s[8:11], s30 offen offset:1024 sc1
    s_waitcnt vmcnt(2)
    s_mov_b64 exec, -1
    v_max3_u32 v40, v24, v25, v26
    v_max3_u32 v41, v27, v28, v29
    v_max3_u32 v40, v40, v30, v31
    v_max_u32 v40, v40, v41
    v_cmp_eq_u32 vcc, -1, v40
    s_cbranch_vccz L_h2_25_db
    s_mov_b64 exec, vcc
    buffer_load_dwordx4 v[24:27], v4, s[8:11], s30 offen offset:0 sc1
    buffer_load_dwordx4 v[28:31], v4, s[8:11], s30 offen offset:1024 sc1
    s_add_u32 s18, s18, 1
    s_cmp_lt_u32 s18, 524288
    s_cbranch_scc1 L_h2_25_r
    s_mov_b32 s17, 1
    s_waitcnt vmcnt(0)
    s_mov_b64 exec, -1
    s_branch L_h2_25_da
L_h2_25_db:
    ds_write_b128 v5, v[24:27] offset:16384
    ds_write_b128 v5, v[28:31] offset:17408
    s_branch L_h2_25_j
L_h2_25_da:
    s_nop 0
    ds_write_b128 v5, v[16:19] offset:16384
    ds_write_b128 v5, v[20:23] offset:17408
L_h2_25_j:
    s_waitcnt vmcnt(0)
    s_waitcnt lgkmcnt(0)
    s_add_u32 s16, s16, 1
    s_barrier
    ds_read_b64_tr_b16 v[16:17], v1 offset:16384
    ds_read_b64_tr_b16 v[18:19], v1 offset:16640
    ds_read_b64_tr_b16 v[20:21], v1 offset:17408
    ds_read_b64_tr_b16 v[22:23], v1 offset:17664
    ds_read_b64_tr_b16 v[24:25], v1 offset:18432
    ds_read_b64_tr_b16 v[26:27], v1 offset:18688
    ds_read_b64_tr_b16 v[28:29], v1 offset:19456
    ds_read_b64_tr_b16 v[30:31], v1 offset:19712
    ds_read_b64_tr_b16 v[32:33], v1 offset:20480
    ds_read_b64_tr_b16 v[34:35], v1 offset:20736
    ds_read_b64_tr_b16 v[36:37], v1 offset:21504
    ds_read_b64_tr_b16 v[38:39], v1 offset:21760
    ds_read_b64_tr_b16 v[40:41], v1 offset:22528
    ds_read_b64_tr_b16 v[42:43], v1 offset:22784
    ds_read_b64_tr_b16 v[44:45], v1 offset:23552
    ds_read_b64_tr_b16 v[46:47], v1 offset:23808
    v_readfirstlane_b32 s41, v13
    s_nop 3
    s_cmp_eq_u32 s41, 1
    s_cbranch_scc1 L_kvok_27
    s_mov_b32 s18, 0
L_pw_kv_28:
    s_cmp_eq_u32 s17, 1
    s_cbranch_scc1 L_pw_kv_28_d
    buffer_load_dword v13, off, s[8:11], s37 sc1
    s_waitcnt vmcnt(0)
    v_readfirstlane_b32 s41, v13
    s_nop 3
    s_cmp_eq_u32 s41, 1
    s_cbranch_scc1 L_pw_kv_28_d
    s_sleep 2
    s_add_u32 s18, s18, 1
    s_cmp_lt_u32 s18, 524288
    s_cbranch_scc1 L_pw_kv_28
    s_mov_b32 s17, 1
L_pw_kv_28_d:
L_kvok_27:
    s_waitcnt lgkmcnt(14)
    s_nop 0
    v_smfmac_f32_16x16x64_bf16 v[104:107], v[16:19], v[48:55], v0
    ds_read_b128 v[48:51], v2 offset:51200
    v_smfmac_f32_16x16x64_bf16 v[112:115], v[16:19], a[0:7], v0
    ds_read_b128 v[52:55], v2 offset:52224
    v_smfmac_f32_16x16x64_bf16 v[108:111], v[16:19], v[56:63], v0
    ds_read_b128 v[56:59], v3 offset:0
    v_smfmac_f32_16x16x64_bf16 v[116:119], v[16:19], a[64:71], v0
    ds_read_b128 v[60:63], v3 offset:1024
    s_waitcnt lgkmcnt(15)
    s_nop 0
    v_smfmac_f32_16x16x64_bf16 v[104:107], v[20:23], v[64:71], v0
    ds_read_b128 v[64:67], v3 offset:2048
    v_smfmac_f32_16x16x64_bf16 v[112:115], v[20:23], a[8:15], v0
    ds_read_b128 v[68:71], v3 offset:3072
    v_smfmac_f32_16x16x64_bf16 v[108:111], v[20:23], v[72:79], v0
    ds_read_b128 v[72:75], v3 offset:16384
    v_smfmac_f32_16x16x64_bf16 v[116:119], v[20:23], a[72:79], v0
    ds_read_b128 v[76:79], v3 offset:17408
    s_waitcnt lgkmcnt(8)
    s_barrier
    v_smfmac_f32_16x16x64_bf16 v[104:107], v[24:27], v[80:87], v0
    ds_read_b128 v[80:83], v3 offset:18432
    s_and_b32 s42, s5, 1
    s_lshl_b32 s42, s42, 12
    s_add_u32 m0, s42, 147456
    s_nop 0
    s_nop 0
    buffer_load_dwordx4 v4, s[8:11], s36 offen offset:0  lds
    v_smfmac_f32_16x16x64_bf16 v[112:115], v[24:27], a[16:23], v0
    ds_read_b128 v[84:87], v3 offset:19456
    v_smfmac_f32_16x16x64_bf16 v[108:111], v[24:27], v[88:95], v0
    ds_read_b128 v[88:91], v3 offset:32768
    v_smfmac_f32_16x16x64_bf16 v[116:119], v[24:27], a[80:87], v0
    ds_read_b128 v[92:95], v3 offset:33792
    v_smfmac_f32_16x16x64_bf16 v[104:107], v[28:31], v[96:103], v0
    ds_read_b128 v[96:99], v3 offset:34816
    buffer_load_dwordx4 v4, s[8:11], s36 offen offset:1024  lds
    v_smfmac_f32_16x16x64_bf16 v[112:115], v[28:31], a[24:31], v0
    ds_read_b128 v[100:103], v3 offset:35840
    s_waitcnt lgkmcnt(12)
    s_nop 0
    v_smfmac_f32_16x16x64_bf16 v[108:111], v[28:31], v[48:55], v0
    ds_read_b128 v[48:51], v3 offset:49152
    v_smfmac_f32_16x16x64_bf16 v[116:119], v[28:31], a[88:95], v0
    ds_read_b128 v[52:55], v3 offset:50176
    s_waitcnt lgkmcnt(12)
    s_nop 0
    v_smfmac_f32_16x16x64_bf16 v[104:107], v[32:35], v[56:63], v0
    ds_read_b128 v[56:59], v3 offset:51200
    buffer_load_dwordx4 v4, s[8:11], s36 offen offset:2048  lds
    v_smfmac_f32_16x16x64_bf16 v[112:115], v[32:35], a[32:39], v0
    ds_read_b128 v[60:63], v3 offset:52224
    s_waitcnt lgkmcnt(12)
    s_nop 0
    v_smfmac_f32_16x16x64_bf16 v[108:111], v[32:35], v[64:71], v0
    ds_read_b128 v[64:67], v4 offset:0
    v_smfmac_f32_16x16x64_bf16 v[116:119], v[32:35], a[96:103], v0
    ds_read_b128 v[68:71], v4 offset:4096
    s_waitcnt lgkmcnt(12)
    s_nop 0
    v_smfmac_f32_16x16x64_bf16 v[104:107], v[36:39], v[72:79], v0
    ds_read_b128 v[72:75], v4 offset:1024
    buffer_load_dwordx4 v4, s[8:11], s36 offen offset:3072  lds
    v_smfmac_f32_16x16x64_bf16 v[112:115], v[36:39], a[40:47], v0
    ds_read_b128 v[76:79], v4 offset:5120
    s_waitcnt lgkmcnt(12)
    s_nop 0
    v_smfmac_f32_16x16x64_bf16 v[108:111], v[36:39], v[80:87], v0
    ds_read_b128 v[80:83], v4 offset:2048
    v_smfmac_f32_16x16x64_bf16 v[116:119], v[36:39], a[104:111], v0
    ds_read_b128 v[84:87], v4 offset:6144
    s_waitcnt lgkmcnt(12)
    s_nop 0
    v_smfmac_f32_16x16x64_bf16 v[104:107], v[40:43], v[88:95], v0
    ds_read_b128 v[88:91], v4 offset:3072
    s_add_u32 s36, s36, 262144
    v_smfmac_f32_16x16x64_bf16 v[112:115], v[40:43], a[48:55], v0
    ds_read_b128 v[92:95], v4 offset:7168
    s_waitcnt lgkmcnt(12)
    s_nop 0
    v_smfmac_f32_16x16x64_bf16 v[108:111], v[40:43], v[96:103], v0
    v_smfmac_f32_16x16x64_bf16 v[116:119], v[40:43], a[112:119], v0
    s_waitcnt lgkmcnt(10)
    v_smfmac_f32_16x16x64_bf16 v[104:107], v[44:47], v[48:55], v0
    s_waitcnt lgkmcnt(8)
    v_smfmac_f32_16x16x64_bf16 v[108:111], v[44:47], v[56:63], v0
    v_smfmac_f32_16x16x64_bf16 v[112:115], v[44:47], a[56:63], v0
    v_smfmac_f32_16x16x64_bf16 v[116:119], v[44:47], a[120:127], v0
    v_add_f32 v104, v104, v105
    v_add_f32 v106, v106, v107
    v_add_f32 v108, v108, v109
    v_add_f32 v110, v110, v111
    v_cvt_pk_bf16_f32 v105, v104, v106
    v_cvt_pk_bf16_f32 v109, v108, v110
    ds_write_b32 v6, v105 offset:24576
    ds_write_b32 v6, v109 offset:24832
    v_add_f32 v112, v112, v113
    v_add_f32 v114, v114, v115
    v_add_f32 v116, v116, v117
    v_add_f32 v118, v118, v119
    v_cvt_pk_bf16_f32 v56, v112, v114
    v_cvt_pk_bf16_f32 v57, v116, v118
    ds_write_b32 v7, v56 offset:28672
    ds_write_b32 v7, v57 offset:29184
    v_smfmac_f32_16x16x64_bf16 v[120:123], v[16:19], a[128:135], v0
    v_smfmac_f32_16x16x64_bf16 v[124:127], v[16:19], a[192:199], v0
    v_smfmac_f32_16x16x64_bf16 v[120:123], v[20:23], a[136:143], v0
    v_smfmac_f32_16x16x64_bf16 v[124:127], v[20:23], a[200:207], v0
    s_waitcnt lgkmcnt(0)
    s_barrier
    ds_read_b64_tr_b16 v[96:97], v8 offset:24576
    ds_read_b64_tr_b16 v[98:99], v8 offset:24832
    ds_read_b64_tr_b16 v[60:61], v9 offset:28672
    ds_read_b64_tr_b16 v[62:63], v9 offset:29184
    ds_read_b64_tr_b16 v[100:101], v8 offset:25088
    ds_read_b64_tr_b16 v[102:103], v8 offset:25344
    ds_read_b64_tr_b16 v[116:117], v9 offset:29696
    ds_read_b64_tr_b16 v[118:119], v9 offset:30208
    ds_read_b64_tr_b16 v[48:49], v8 offset:25600
    ds_read_b64_tr_b16 v[50:51], v8 offset:25856
    ds_read_b64_tr_b16 v[52:53], v8 offset:26112
    ds_read_b64_tr_b16 v[54:55], v8 offset:26368
    v_smfmac_f32_16x16x64_bf16 v[120:123], v[24:27], a[144:151], v0
    s_and_b32 s42, s5, 1
    s_lshl_b32 s42, s42, 12
    s_add_u32 m0, s42, 131072
    s_nop 0
    s_nop 0
    buffer_load_dwordx4 v4, s[8:11], s35 offen offset:0  lds
    v_smfmac_f32_16x16x64_bf16 v[124:127], v[24:27], a[208:215], v0
    buffer_load_dwordx4 v4, s[8:11], s35 offen offset:1024  lds
    v_smfmac_f32_16x16x64_bf16 v[120:123], v[28:31], a[152:159], v0
    buffer_load_dwordx4 v4, s[8:11], s35 offen offset:2048  lds
    v_smfmac_f32_16x16x64_bf16 v[124:127], v[28:31], a[216:223], v0
    buffer_load_dwordx4 v4, s[8:11], s35 offen offset:3072  lds
    s_waitcnt lgkmcnt(10)
    s_nop 0
    v_mfma_f32_16x16x32_bf16 v[104:107], v[64:67], v[96:99], 0
    v_mfma_f32_16x16x32_bf16 v[108:111], v[68:71], v[96:99], 0
    ds_read_b64_tr_b16 v[64:65], v9 offset:30720
    ds_read_b64_tr_b16 v[66:67], v9 offset:31232
    s_add_u32 s35, s35, 262144
    s_min_u32 s41, s16, 61
    s_add_u32 s41, s41, 2
    s_lshl_b32 s41, s41, 7
    s_add_u32 s37, s41, s19
    buffer_load_dword v13, off, s[8:11], s37 sc1
    s_waitcnt lgkmcnt(10)
    v_mfma_f32_16x16x32_bf16 v[112:115], v[60:63], v[96:99], 0
    s_waitcnt lgkmcnt(8)
    v_mfma_f32_16x16x32_bf16 v[104:107], v[72:75], v[100:103], v[104:107]
    v_mfma_f32_16x16x32_bf16 v[108:111], v[76:79], v[100:103], v[108:111]
    ds_read_b64_tr_b16 v[72:73], v9 offset:31744
    ds_read_b64_tr_b16 v[74:75], v9 offset:32256
    s_waitcnt lgkmcnt(8)
    v_mfma_f32_16x16x32_bf16 v[112:115], v[116:119], v[100:103], v[112:115]
    s_waitcnt lgkmcnt(6)
    v_mfma_f32_16x16x32_bf16 v[104:107], v[80:83], v[48:51], v[104:107]
    v_mfma_f32_16x16x32_bf16 v[108:111], v[84:87], v[48:51], v[108:111]
    s_waitcnt lgkmcnt(4)
    s_nop 0
    v_mfma_f32_16x16x32_bf16 v[104:107], v[88:91], v[52:55], v[104:107]
    v_mfma_f32_16x16x32_bf16 v[108:111], v[92:95], v[52:55], v[108:111]
    s_waitcnt lgkmcnt(2)
    v_mfma_f32_16x16x32_bf16 v[112:115], v[64:67], v[48:51], v[112:115]
    s_waitcnt lgkmcnt(0)
    v_mfma_f32_16x16x32_bf16 v[112:115], v[72:75], v[52:55], v[112:115]
    ds_read_b128 v[76:79], v5 offset:8192
    ds_read_b128 v[84:87], v5 offset:9216
    v_smfmac_f32_16x16x64_bf16 v[120:123], v[32:35], a[160:167], v0
    v_smfmac_f32_16x16x64_bf16 v[124:127], v[32:35], a[224:231], v0
    v_max3_f32 v68, v104, v105, v106
    v_max3_f32 v69, v107, v108, v109
    v_max3_f32 v68, v68, v110, v111
    v_max3_f32 v69, v69, v112, v113
    v_max_f32 v70, v68, v69
    v_max_f32 v68, v68, v69
    v_smfmac_f32_16x16x64_bf16 v[120:123], v[36:39], a[168:175], v0
    s_nop 0
    v_permlane32_swap_b32 v68, v70
    v_max_f32 v69, v68, v70
    v_max_f32 v68, v68, v70
    v_smfmac_f32_16x16x64_bf16 v[124:127], v[36:39], a[232:239], v0
    s_nop 0
    v_permlane16_swap_b32 v68, v69
    v_max_f32 v68, v68, v69
    v_mul_f32 v68, s20, v68
    v_fma_f32 v104, v104, s20, -v68
    v_fma_f32 v105, v105, s20, -v68
    v_fma_f32 v106, v106, s20, -v68
    v_fma_f32 v107, v107, s20, -v68
    v_fma_f32 v108, v108, s20, -v68
    v_fma_f32 v109, v109, s20, -v68
    v_fma_f32 v110, v110, s20, -v68
    v_fma_f32 v111, v111, s20, -v68
    v_fma_f32 v112, v112, s20, -v68
    v_fma_f32 v113, v113, s20, -v68
    v_exp_f32 v104, v104
    v_exp_f32 v105, v105
    v_smfmac_f32_16x16x64_bf16 v[120:123], v[40:43], a[176:183], v0
    v_exp_f32 v106, v106
    v_exp_f32 v107, v107
    v_smfmac_f32_16x16x64_bf16 v[124:127], v[40:43], a[240:247], v0
    v_exp_f32 v108, v108
    v_exp_f32 v109, v109
    v_smfmac_f32_16x16x64_bf16 v[120:123], v[44:47], a[184:191], v0
    v_exp_f32 v110, v110
    v_exp_f32 v111, v111
    v_smfmac_f32_16x16x64_bf16 v[124:127], v[44:47], a[248:255], v0
    v_exp_f32 v112, v112
    v_exp_f32 v113, v113
    v_cvt_pk_bf16_f32 v72, v104, v105
    v_cvt_pk_bf16_f32 v73, v106, v107
    v_cvt_pk_bf16_f32 v74, v108, v109
    v_cvt_pk_bf16_f32 v75, v110, v111
    v_cvt_pk_bf16_f32 v114, v112, v113
    v_cvt_pk_bf16_f32 v65, v112, v113
    s_waitcnt lgkmcnt(0)
    v_mfma_f32_16x16x32_bf16 v[96:99], v[76:79], v[72:75], 0
    v_mov_b32 v115, 0
    v_mov_b32_e64 v64, 0
    v_mfma_f32_16x16x32_bf16 v[100:103], v[84:87], v[72:75], 0
    v_add_f32 v120, v120, v121
    v_add_f32 v122, v122, v123
    v_add_f32 v124, v124, v125
    v_add_f32 v126, v126, v127
    v_cvt_pk_bf16_f32 v58, v120, v122
    v_cvt_pk_bf16_f32 v59, v124, v126
    v_add_f32 v104, v104, v105
    v_add_f32 v106, v106, v107
    v_mfma_f32_16x16x16_bf16 v[96:99], v[58:59], v[114:115], v[96:99]
    v_add_f32 v108, v108, v109
    v_add_f32 v110, v110, v111
    v_mfma_f32_16x16x16_bf16 v[100:103], v[58:59], v[64:65], v[100:103]
    v_add_f32 v112, v112, v113
    v_add_f32 v104, v104, v106
    v_mfma_f32_32x32x1_2b_f32 v[16:47], v14, v14, 0
    buffer_store_dwordx4 v[56:59], v4, s[8:11], s34 offen sc1
    s_cmp_eq_u32 s16, 63
    s_cbranch_scc1 L_rec_fin
    v_add_f32 v108, v108, v110
    v_add_f32 v104, v104, v112
    v_add_f32 v70, v104, v108
    v_add_f32 v71, v104, v108
    s_add_u32 s34, s34, 131072
    s_nop 0
    v_permlane32_swap_b32 v70, v71
    v_add_f32 v68, v70, v71
    v_add_f32 v70, v70, v71
    s_nop 1
    v_permlane16_swap_b32 v70, v68
    v_add_f32 v70, v70, v68
    v_rcp_f32 v70, v70
    v_cndmask_b32 v96, v96, v100, s[22:23]
    v_cndmask_b32 v97, v97, v101, s[22:23]
    v_cndmask_b32 v98, v98, v102, s[22:23]
    v_cndmask_b32 v99, v99, v103, s[22:23]
    v_mul_f32 v96, v96, v70
    v_mul_f32 v97, v97, v70
    v_mul_f32 v98, v98, v70
    v_mul_f32 v99, v99, v70
    v_cvt_pk_bf16_f32 v96, v96, v97
    v_cvt_pk_bf16_f32 v97, v98, v99
    ds_write_b64 v10, v[96:97]
    s_waitcnt lgkmcnt(0)
    s_barrier
    ds_read_b128 v[48:51], v4 offset:26624
    ds_read_b128 v[52:55], v4 offset:27648
    s_waitcnt lgkmcnt(0)
    s_nop 0
    v_smfmac_f32_16x16x64_bf16 v[16:19], v[48:51], v[128:135], v0
    v_smfmac_f32_16x16x64_bf16 v[16:19], v[52:55], v[136:143], v0
    v_smfmac_f32_16x16x64_bf16 v[20:23], v[48:51], v[144:151], v0
    v_smfmac_f32_16x16x64_bf16 v[20:23], v[52:55], v[152:159], v0
    v_add_f32_e64 v16, v16, v17
    v_smfmac_f32_16x16x64_bf16 v[24:27], v[48:51], v[160:167], v0
    v_add_f32_e64 v18, v18, v19
    v_cvt_pk_bf16_f32 v104, v16, v18
    v_smfmac_f32_16x16x64_bf16 v[24:27], v[52:55], v[168:175], v0
    v_or_b32_e64 v104, 1, v104
    v_smfmac_f32_16x16x64_bf16 v[28:31], v[48:51], v[176:183], v0
    v_add_f32 v20, v20, v21
    v_add_f32 v22, v22, v23
    v_smfmac_f32_16x16x64_bf16 v[28:31], v[52:55], v[184:191], v0
    v_cvt_pk_bf16_f32 v105, v20, v22
    v_smfmac_f32_16x16x64_bf16 v[32:35], v[48:51], v[192:199], v0
    v_add_f32 v24, v24, v25
    v_add_f32 v26, v26, v27
    v_smfmac_f32_16x16x64_bf16 v[32:35], v[52:55], v[200:207], v0
    v_cvt_pk_bf16_f32 v106, v24, v26
    v_smfmac_f32_16x16x64_bf16 v[36:39], v[48:51], v[208:215], v0
    v_add_f32 v28, v28, v29
    v_add_f32 v30, v30, v31
    v_smfmac_f32_16x16x64_bf16 v[36:39], v[52:55], v[216:223], v0
    v_cvt_pk_bf16_f32 v107, v28, v30
    buffer_store_dwordx4 v[104:107], v11, s[8:11], s24 offen
    v_smfmac_f32_16x16x64_bf16 v[40:43], v[48:51], v[224:231], v0
    v_add_f32 v32, v32, v33
    v_add_f32 v34, v34, v35
    v_smfmac_f32_16x16x64_bf16 v[40:43], v[52:55], v[232:239], v0
    v_cvt_pk_bf16_f32 v108, v32, v34
    v_smfmac_f32_16x16x64_bf16 v[44:47], v[48:51], v[240:247], v0
    v_or_b32 v108, 1, v108
    v_add_f32 v36, v36, v37
    v_smfmac_f32_16x16x64_bf16 v[44:47], v[52:55], v[248:255], v0
    v_add_f32_e64 v38, v38, v39
    v_cvt_pk_bf16_f32 v109, v36, v38
    v_add_f32 v40, v40, v41
    v_add_f32 v42, v42, v43
    v_cvt_pk_bf16_f32 v110, v40, v42
    s_nop 3
    v_add_f32 v44, v44, v45
    v_add_f32_e64 v46, v46, v47
    v_cvt_pk_bf16_f32 v111, v44, v46
    buffer_store_dwordx4 v[108:111], v11, s[8:11], s25 offen
L_stepend_26:
    ds_read_b128 v[48:51], v2 offset:0
    ds_read_b128 v[52:55], v2 offset:1024
    ds_read_b128 v[56:59], v2 offset:2048
    ds_read_b128 v[60:63], v2 offset:3072
    ds_read_b128 v[64:67], v2 offset:16384
    ds_read_b128 v[68:71], v2 offset:17408
    ds_read_b128 v[72:75], v2 offset:18432
    ds_read_b128 v[76:79], v2 offset:19456
    ds_read_b128 v[80:83], v2 offset:32768
    ds_read_b128 v[84:87], v2 offset:33792
    ds_read_b128 v[88:91], v2 offset:34816
    ds_read_b128 v[92:95], v2 offset:35840
    ds_read_b128 v[96:99], v2 offset:49152
    ds_read_b128 v[100:103], v2 offset:50176
    s_barrier
    s_nop 15
    s_mov_b32 s18, 0
    s_nop 0
    buffer_load_dwordx4 v[16:19], v4, s[8:11], s31 offen offset:0 sc1
    buffer_load_dwordx4 v[20:23], v4, s[8:11], s31 offen offset:1024 sc1
    v_mov_b64 v[104:105], 0
    v_mov_b64 v[106:107], 0
    v_mov_b64 v[108:109], 0
    v_mov_b64 v[110:111], 0
    v_mov_b64 v[112:113], 0
    v_mov_b64 v[114:115], 0
    v_mov_b64 v[116:117], 0
    v_mov_b64 v[118:119], 0
    v_mov_b64 v[120:121], 0
    v_mov_b64 v[122:123], 0
    v_mov_b64 v[124:125], 0
    v_mov_b64 v[126:127], 0
    s_nop 15
    s_nop 7
    buffer_load_dwordx4 v[24:27], v4, s[8:11], s31 offen offset:0 sc1
    buffer_load_dwordx4 v[28:31], v4, s[8:11], s31 offen offset:1024 sc1
L_h2_29_r:
    s_waitcnt vmcnt(2)
    s_mov_b64 exec, -1
    v_max3_u32 v40, v16, v17, v18
    v_max3_u32 v41, v19, v20, v21
    v_max3_u32 v40, v40, v22, v23
    v_max_u32 v40, v40, v41
    v_cmp_eq_u32 vcc, -1, v40
    s_cbranch_vccz L_h2_29_da
    s_cmp_eq_u32 s17, 1
    s_cbranch_scc1 L_h2_29_da
    s_mov_b64 exec, vcc
    buffer_load_dwordx4 v[16:19], v4, s[8:11], s31 offen offset:0 sc1
    buffer_load_dwordx4 v[20:23], v4, s[8:11], s31 offen offset:1024 sc1
    s_waitcnt vmcnt(2)
    s_mov_b64 exec, -1
    v_max3_u32 v40, v24, v25, v26
    v_max3_u32 v41, v27, v28, v29
    v_max3_u32 v40, v40, v30, v31
    v_max_u32 v40, v40, v41
    v_cmp_eq_u32 vcc, -1, v40
    s_cbranch_vccz L_h2_29_db
    s_mov_b64 exec, vcc
    buffer_load_dwordx4 v[24:27], v4, s[8:11], s31 offen offset:0 sc1
    buffer_load_dwordx4 v[28:31], v4, s[8:11], s31 offen offset:1024 sc1
    s_add_u32 s18, s18, 1
    s_cmp_lt_u32 s18, 524288
    s_cbranch_scc1 L_h2_29_r
    s_mov_b32 s17, 1
    s_waitcnt vmcnt(0)
    s_mov_b64 exec, -1
    s_branch L_h2_29_da
L_h2_29_db:
    ds_write_b128 v5, v[24:27] offset:8192
    ds_write_b128 v5, v[28:31] offset:9216
    s_branch L_h2_29_j
L_h2_29_da:
    s_nop 0
    ds_write_b128 v5, v[16:19] offset:8192
    ds_write_b128 v5, v[20:23] offset:9216
L_h2_29_j:
    s_waitcnt vmcnt(0)
    s_waitcnt lgkmcnt(0)
    s_add_u32 s16, s16, 1
    s_barrier
    s_branch L_recF_loop
L_rec_fin:
    s_waitcnt vmcnt(0) lgkmcnt(0)
    s_barrier
    s_cmp_eq_u32 s5, 0
    s_cbranch_scc0 L_fin_30
    v_mov_b32 v16, 1
    buffer_store_dword v16, off, s[8:11], s38 sc1
    s_waitcnt vmcnt(0)
L_fin_30:
    s_branch L_fin_all
L_worker:
    s_mov_b32 s19, 0
    s_sub_u32 s40, s6, 1
    s_lshl_b32 s16, s40, 5
    s_add_u32 s16, s16, s4
    s_mul_i32 s17, s16, 21846
    s_lshr_b32 s17, s17, 16
    s_mul_i32 s24, s17, 3
    s_sub_u32 s18, s16, s24
    v_and_b32 v100, 63, v0
    s_cmp_eq_u32 s5, 0
    s_cbranch_scc0 L_fz_31
    v_mov_b32 v20, 0
    v_mov_b32 v21, 0
    v_mov_b32 v22, 0
    v_mov_b32 v23, 0
    v_lshlrev_b32_e64 v24, 4, v100
    v_mov_b32 v25, 0x7ff00000
    v_cmp_gt_u32 vcc, 8, v100
    s_nop 1
    v_cndmask_b32 v24, v25, v24, vcc
    s_lshl_b32 s24, s16, 7
    s_add_u32 s24, s24, 61407232
    buffer_store_dwordx4 v[20:23], v24, s[8:11], s24 offen sc1
L_fz_31:
    s_load_dwordx2 s[56:57], s[0:1], 0
    s_waitcnt lgkmcnt(0)
    s_mov_b32 s28, s56
    s_and_b32 s29, s57, 0xffff
    s_mov_b32 s30, 2097152
    s_mov_b32 s31, 0x20000
    s_lshl_b32 s24, s16, 2
    s_add_u32 s24, s24, s5
    v_lshlrev_b32 v24, 4, v100
    s_add_u32 s25, s24, 0
    s_min_u32 s25, s25, 2047
    s_lshl_b32 s25, s25, 10
    s_nop 0
    buffer_load_dwordx4 v[32:35], v24, s[28:31], s25 offen
    s_add_u32 s25, s24, 896
    s_min_u32 s25, s25, 2047
    s_lshl_b32 s25, s25, 10
    s_nop 0
    buffer_load_dwordx4 v[36:39], v24, s[28:31], s25 offen
    s_add_u32 s25, s24, 1792
    s_min_u32 s25, s25, 2047
    s_lshl_b32 s25, s25, 10
    buffer_load_dwordx4 v[40:43], v24, s[28:31], s25 offen
    s_waitcnt vmcnt(0)
    v_lshlrev_b32_e64 v48, 16, v32
    v_and_b32 v49, 0xffff0000, v32
    v_lshlrev_b32_e64 v50, 16, v33
    v_and_b32 v51, 0xffff0000, v33
    v_lshlrev_b32_e64 v52, 16, v34
    v_and_b32 v53, 0xffff0000, v34
    v_lshlrev_b32_e64 v54, 16, v35
    v_and_b32 v55, 0xffff0000, v35
    v_add_f32 v80, v48, v49
    v_add_f32 v80, v80, v50
    v_add_f32 v80, v80, v51
    v_add_f32 v80, v80, v52
    v_add_f32 v80, v80, v53
    v_add_f32 v80, v80, v54
    v_add_f32 v80, v80, v55
    v_lshlrev_b32 v56, 16, v36
    v_and_b32 v57, 0xffff0000, v36
    v_lshlrev_b32_e64 v58, 16, v37
    v_and_b32 v59, 0xffff0000, v37
    v_lshlrev_b32_e64 v60, 16, v38
    v_and_b32 v61, 0xffff0000, v38
    v_lshlrev_b32_e64 v62, 16, v39
    v_and_b32 v63, 0xffff0000, v39
    v_add_f32 v81, v56, v57
    v_add_f32 v81, v81, v58
    v_add_f32 v81, v81, v59
    v_add_f32 v81, v81, v60
    v_add_f32 v81, v81, v61
    v_add_f32 v81, v81, v62
    v_add_f32 v81, v81, v63
    v_lshlrev_b32 v64, 16, v40
    v_and_b32 v65, 0xffff0000, v40
    v_lshlrev_b32_e64 v66, 16, v41
    v_and_b32 v67, 0xffff0000, v41
    v_lshlrev_b32_e64 v68, 16, v42
    v_and_b32 v69, 0xffff0000, v42
    v_lshlrev_b32_e64 v70, 16, v43
    v_and_b32 v71, 0xffff0000, v43
    v_add_f32 v82, v64, v65
    v_add_f32 v82, v82, v66
    v_add_f32 v82, v82, v67
    v_add_f32 v82, v82, v68
    v_add_f32 v82, v82, v69
    v_add_f32 v82, v82, v70
    v_add_f32 v82, v82, v71
    s_nop 1
    v_add_f32_dpp v80, v80, v80 row_ror:1 row_mask:0xf bank_mask:0xf
    v_add_f32_dpp v81, v81, v81 row_ror:1 row_mask:0xf bank_mask:0xf
    v_add_f32_dpp v82, v82, v82 row_ror:1 row_mask:0xf bank_mask:0xf
    s_nop 1
    s_nop 0
    v_add_f32_dpp v80, v80, v80 row_ror:2 row_mask:0xf bank_mask:0xf
    v_add_f32_dpp v81, v81, v81 row_ror:2 row_mask:0xf bank_mask:0xf
    v_add_f32_dpp v82, v82, v82 row_ror:2 row_mask:0xf bank_mask:0xf
    s_nop 1
    s_nop 0
    v_add_f32_dpp v80, v80, v80 row_ror:4 row_mask:0xf bank_mask:0xf
    v_add_f32_dpp v81, v81, v81 row_ror:4 row_mask:0xf bank_mask:0xf
    v_add_f32_dpp v82, v82, v82 row_ror:4 row_mask:0xf bank_mask:0xf
    s_nop 1
    s_nop 0
    v_add_f32_dpp v80, v80, v80 row_ror:8 row_mask:0xf bank_mask:0xf
    v_add_f32_dpp v81, v81, v81 row_ror:8 row_mask:0xf bank_mask:0xf
    v_add_f32_dpp v82, v82, v82 row_ror:8 row_mask:0xf bank_mask:0xf
    v_mov_b32 v84, v80
    v_mov_b32 v85, v81
    v_mov_b32 v86, v82
    s_nop 1
    v_permlane16_swap_b32 v80, v84
    v_permlane16_swap_b32 v81, v85
    v_permlane16_swap_b32 v82, v86
    v_add_f32 v80, v80, v84
    v_add_f32 v81, v81, v85
    v_add_f32 v82, v82, v86
    v_mov_b32 v84, v80
    v_mov_b32 v85, v81
    v_mov_b32 v86, v82
    s_nop 1
    v_permlane32_swap_b32 v80, v84
    v_permlane32_swap_b32 v81, v85
    v_permlane32_swap_b32 v82, v86
    v_add_f32 v80, v80, v84
    v_add_f32 v81, v81, v85
    v_add_f32 v82, v82, v86
    v_mul_f32 v88, 0x3b000000, v80
    v_sub_f32 v84, v48, v88
    v_mul_f32 v92, v84, v84
    v_sub_f32 v84, v49, v88
    v_fmac_f32 v92, v84, v84
    v_sub_f32 v84, v50, v88
    v_fmac_f32 v92, v84, v84
    v_sub_f32 v84, v51, v88
    v_fmac_f32 v92, v84, v84
    v_sub_f32 v84, v52, v88
    v_fmac_f32 v92, v84, v84
    v_sub_f32 v84, v53, v88
    v_fmac_f32 v92, v84, v84
    v_sub_f32 v84, v54, v88
    v_fmac_f32 v92, v84, v84
    v_sub_f32 v84, v55, v88
    v_fmac_f32 v92, v84, v84
    v_mul_f32 v89, 0x3b000000, v81
    v_sub_f32 v84, v56, v89
    v_mul_f32 v93, v84, v84
    v_sub_f32 v84, v57, v89
    v_fmac_f32 v93, v84, v84
    v_sub_f32 v84, v58, v89
    v_fmac_f32 v93, v84, v84
    v_sub_f32 v84, v59, v89
    v_fmac_f32 v93, v84, v84
    v_sub_f32 v84, v60, v89
    v_fmac_f32 v93, v84, v84
    v_sub_f32 v84, v61, v89
    v_fmac_f32 v93, v84, v84
    v_sub_f32 v84, v62, v89
    v_fmac_f32 v93, v84, v84
    v_sub_f32 v84, v63, v89
    v_fmac_f32 v93, v84, v84
    v_mul_f32 v90, 0x3b000000, v82
    v_sub_f32 v84, v64, v90
    v_mul_f32 v94, v84, v84
    v_sub_f32 v84, v65, v90
    v_fmac_f32 v94, v84, v84
    v_sub_f32 v84, v66, v90
    v_fmac_f32 v94, v84, v84
    v_sub_f32 v84, v67, v90
    v_fmac_f32 v94, v84, v84
    v_sub_f32 v84, v68, v90
    v_fmac_f32 v94, v84, v84
    v_sub_f32 v84, v69, v90
    v_fmac_f32 v94, v84, v84
    v_sub_f32 v84, v70, v90
    v_fmac_f32 v94, v84, v84
    v_sub_f32_e64 v84, v71, v90
    v_fmac_f32 v94, v84, v84
    s_nop 1
    v_add_f32_dpp v92, v92, v92 row_ror:1 row_mask:0xf bank_mask:0xf
    v_add_f32_dpp v93, v93, v93 row_ror:1 row_mask:0xf bank_mask:0xf
    v_add_f32_dpp v94, v94, v94 row_ror:1 row_mask:0xf bank_mask:0xf
    s_nop 1
    s_nop 0
    v_add_f32_dpp v92, v92, v92 row_ror:2 row_mask:0xf bank_mask:0xf
    v_add_f32_dpp v93, v93, v93 row_ror:2 row_mask:0xf bank_mask:0xf
    v_add_f32_dpp v94, v94, v94 row_ror:2 row_mask:0xf bank_mask:0xf
    s_nop 1
    s_nop 0
    v_add_f32_dpp v92, v92, v92 row_ror:4 row_mask:0xf bank_mask:0xf
    v_add_f32_dpp v93, v93, v93 row_ror:4 row_mask:0xf bank_mask:0xf
    v_add_f32_dpp v94, v94, v94 row_ror:4 row_mask:0xf bank_mask:0xf
    s_nop 1
    s_nop 0
    v_add_f32_dpp v92, v92, v92 row_ror:8 row_mask:0xf bank_mask:0xf
    v_add_f32_dpp v93, v93, v93 row_ror:8 row_mask:0xf bank_mask:0xf
    v_add_f32_dpp v94, v94, v94 row_ror:8 row_mask:0xf bank_mask:0xf
    v_mov_b32 v84, v92
    v_mov_b32 v85, v93
    v_mov_b32 v86, v94
    s_nop 1
    v_permlane16_swap_b32 v92, v84
    v_permlane16_swap_b32 v93, v85
    v_permlane16_swap_b32 v94, v86
    v_add_f32 v92, v92, v84
    v_add_f32 v93, v93, v85
    v_add_f32 v94, v94, v86
    v_mov_b32 v84, v92
    v_mov_b32 v85, v93
    v_mov_b32 v86, v94
    s_nop 1
    v_permlane32_swap_b32 v92, v84
    v_permlane32_swap_b32 v93, v85
    v_permlane32_swap_b32 v94, v86
    v_add_f32 v92, v92, v84
    v_add_f32 v93, v93, v85
    v_add_f32 v94, v94, v86
    v_mul_f32 v92, 0x3b000000, v92
    v_cvt_pk_bf16_f32 v92, v92, v92
    v_lshlrev_b32_e64 v92, 16, v92
    v_add_f32 v92, 0x3727c5ac, v92
    v_cvt_pk_bf16_f32 v92, v92, v92
    v_lshlrev_b32 v92, 16, v92
    v_sqrt_f32_e64 v92, v92
    s_nop 0
    v_cvt_pk_bf16_f32 v92, v92, v92
    v_lshlrev_b32 v92, 16, v92
    v_rcp_f32 v96, v92
    v_cvt_pk_bf16_f32 v88, v88, v88
    v_lshlrev_b32 v88, 16, v88
    v_sub_f32 v48, v48, v88
    v_sub_f32 v49, v49, v88
    v_sub_f32 v50, v50, v88
    v_sub_f32 v51, v51, v88
    v_sub_f32 v52, v52, v88
    v_sub_f32 v53, v53, v88
    v_sub_f32 v54, v54, v88
    v_sub_f32_e64 v55, v55, v88
    v_cvt_pk_bf16_f32 v84, v48, v49
    v_lshlrev_b32_e64 v48, 16, v84
    v_and_b32 v49, 0xffff0000, v84
    v_cvt_pk_bf16_f32 v84, v50, v51
    v_lshlrev_b32_e64 v50, 16, v84
    v_and_b32 v51, 0xffff0000, v84
    v_cvt_pk_bf16_f32 v84, v52, v53
    v_lshlrev_b32_e64 v52, 16, v84
    v_and_b32 v53, 0xffff0000, v84
    v_cvt_pk_bf16_f32 v84, v54, v55
    v_lshlrev_b32_e64 v54, 16, v84
    v_and_b32 v55, 0xffff0000, v84
    v_mul_f32_e64 v84, v48, v96
    v_fma_f32 v85, -v84, v92, v48
    v_fma_f32 v48, v85, v96, v84
    v_mul_f32_e64 v84, v49, v96
    v_fma_f32 v85, -v84, v92, v49
    v_fma_f32 v49, v85, v96, v84
    v_mul_f32_e64 v84, v50, v96
    v_fma_f32 v85, -v84, v92, v50
    v_fma_f32 v50, v85, v96, v84
    v_mul_f32_e64 v84, v51, v96
    v_fma_f32 v85, -v84, v92, v51
    v_fma_f32 v51, v85, v96, v84
    v_mul_f32_e64 v84, v52, v96
    v_fma_f32 v85, -v84, v92, v52
    v_fma_f32 v52, v85, v96, v84
    v_mul_f32_e64 v84, v53, v96
    v_fma_f32 v85, -v84, v92, v53
    v_fma_f32 v53, v85, v96, v84
    v_mul_f32_e64 v84, v54, v96
    v_fma_f32 v85, -v84, v92, v54
    v_fma_f32 v54, v85, v96, v84
    v_mul_f32_e64 v84, v55, v96
    v_fma_f32 v85, -v84, v92, v55
    v_fma_f32 v55, v85, v96, v84
    v_cvt_pk_bf16_f32 v32, v48, v49
    v_cvt_pk_bf16_f32 v33, v50, v51
    v_cvt_pk_bf16_f32 v34, v52, v53
    v_cvt_pk_bf16_f32 v35, v54, v55
    s_add_u32 s25, s24, 0
    s_cmp_ge_u32 s25, 2048
    s_cbranch_scc1 L_lnrow_32
    s_lshl_b32 s25, s25, 10
    s_add_u32 s25, s25, 0
    buffer_store_dwordx4 v[32:35], v24, s[8:11], s25 offen sc1
L_lnrow_32:
    v_mul_f32 v93, 0x3b000000, v93
    v_cvt_pk_bf16_f32 v93, v93, v93
    v_lshlrev_b32_e64 v93, 16, v93
    v_add_f32 v93, 0x3727c5ac, v93
    v_cvt_pk_bf16_f32 v93, v93, v93
    v_lshlrev_b32 v93, 16, v93
    v_sqrt_f32_e64 v93, v93
    s_nop 0
    v_cvt_pk_bf16_f32 v93, v93, v93
    v_lshlrev_b32 v93, 16, v93
    v_rcp_f32 v97, v93
    v_cvt_pk_bf16_f32 v89, v89, v89
    v_lshlrev_b32 v89, 16, v89
    v_sub_f32 v56, v56, v89
    v_sub_f32 v57, v57, v89
    v_sub_f32 v58, v58, v89
    v_sub_f32 v59, v59, v89
    v_sub_f32 v60, v60, v89
    v_sub_f32 v61, v61, v89
    v_sub_f32 v62, v62, v89
    v_sub_f32_e64 v63, v63, v89
    v_cvt_pk_bf16_f32 v84, v56, v57
    v_lshlrev_b32_e64 v56, 16, v84
    v_and_b32 v57, 0xffff0000, v84
    v_cvt_pk_bf16_f32 v84, v58, v59
    v_lshlrev_b32_e64 v58, 16, v84
    v_and_b32 v59, 0xffff0000, v84
    v_cvt_pk_bf16_f32 v84, v60, v61
    v_lshlrev_b32_e64 v60, 16, v84
    v_and_b32 v61, 0xffff0000, v84
    v_cvt_pk_bf16_f32 v84, v62, v63
    v_lshlrev_b32_e64 v62, 16, v84
    v_and_b32 v63, 0xffff0000, v84
    v_mul_f32_e64 v84, v56, v97
    v_fma_f32 v85, -v84, v93, v56
    v_fma_f32 v56, v85, v97, v84
    v_mul_f32_e64 v84, v57, v97
    v_fma_f32 v85, -v84, v93, v57
    v_fma_f32 v57, v85, v97, v84
    v_mul_f32_e64 v84, v58, v97
    v_fma_f32 v85, -v84, v93, v58
    v_fma_f32 v58, v85, v97, v84
    v_mul_f32_e64 v84, v59, v97
    v_fma_f32 v85, -v84, v93, v59
    v_fma_f32 v59, v85, v97, v84
    v_mul_f32_e64 v84, v60, v97
    v_fma_f32 v85, -v84, v93, v60
    v_fma_f32 v60, v85, v97, v84
    v_mul_f32_e64 v84, v61, v97
    v_fma_f32 v85, -v84, v93, v61
    v_fma_f32 v61, v85, v97, v84
    v_mul_f32_e64 v84, v62, v97
    v_fma_f32 v85, -v84, v93, v62
    v_fma_f32 v62, v85, v97, v84
    v_mul_f32_e64 v84, v63, v97
    v_fma_f32 v85, -v84, v93, v63
    v_fma_f32 v63, v85, v97, v84
    v_cvt_pk_bf16_f32 v36, v56, v57
    v_cvt_pk_bf16_f32 v37, v58, v59
    v_cvt_pk_bf16_f32 v38, v60, v61
    v_cvt_pk_bf16_f32 v39, v62, v63
    s_add_u32 s25, s24, 896
    s_cmp_ge_u32 s25, 2048
    s_cbranch_scc1 L_lnrow_33
    s_lshl_b32 s25, s25, 10
    s_add_u32 s25, s25, 0
    s_nop 0
    buffer_store_dwordx4 v[36:39], v24, s[8:11], s25 offen sc1
L_lnrow_33:
    v_mul_f32 v94, 0x3b000000, v94
    v_cvt_pk_bf16_f32 v94, v94, v94
    v_lshlrev_b32_e64 v94, 16, v94
    v_add_f32 v94, 0x3727c5ac, v94
    v_cvt_pk_bf16_f32 v94, v94, v94
    v_lshlrev_b32 v94, 16, v94
    v_sqrt_f32_e64 v94, v94
    s_nop 0
    v_cvt_pk_bf16_f32 v94, v94, v94
    v_lshlrev_b32 v94, 16, v94
    v_rcp_f32 v98, v94
    v_cvt_pk_bf16_f32 v90, v90, v90
    v_lshlrev_b32 v90, 16, v90
    v_sub_f32 v64, v64, v90
    v_sub_f32 v65, v65, v90
    v_sub_f32 v66, v66, v90
    v_sub_f32 v67, v67, v90
    v_sub_f32 v68, v68, v90
    v_sub_f32 v69, v69, v90
    v_sub_f32 v70, v70, v90
    v_sub_f32_e64 v71, v71, v90
    v_cvt_pk_bf16_f32 v84, v64, v65
    v_lshlrev_b32_e64 v64, 16, v84
    v_and_b32 v65, 0xffff0000, v84
    v_cvt_pk_bf16_f32 v84, v66, v67
    v_lshlrev_b32_e64 v66, 16, v84
    v_and_b32 v67, 0xffff0000, v84
    v_cvt_pk_bf16_f32 v84, v68, v69
    v_lshlrev_b32_e64 v68, 16, v84
    v_and_b32 v69, 0xffff0000, v84
    v_cvt_pk_bf16_f32 v84, v70, v71
    v_lshlrev_b32_e64 v70, 16, v84
    v_and_b32 v71, 0xffff0000, v84
    v_mul_f32_e64 v84, v64, v98
    v_fma_f32 v85, -v84, v94, v64
    v_fma_f32 v64, v85, v98, v84
    v_mul_f32_e64 v84, v65, v98
    v_fma_f32 v85, -v84, v94, v65
    v_fma_f32 v65, v85, v98, v84
    v_mul_f32_e64 v84, v66, v98
    v_fma_f32 v85, -v84, v94, v66
    v_fma_f32 v66, v85, v98, v84
    v_mul_f32_e64 v84, v67, v98
    v_fma_f32 v85, -v84, v94, v67
    v_fma_f32 v67, v85, v98, v84
    v_mul_f32_e64 v84, v68, v98
    v_fma_f32 v85, -v84, v94, v68
    v_fma_f32 v68, v85, v98, v84
    v_mul_f32_e64 v84, v69, v98
    v_fma_f32 v85, -v84, v94, v69
    v_fma_f32 v69, v85, v98, v84
    v_mul_f32_e64 v84, v70, v98
    v_fma_f32 v85, -v84, v94, v70
    v_fma_f32 v70, v85, v98, v84
    v_mul_f32_e64 v84, v71, v98
    v_fma_f32 v85, -v84, v94, v71
    v_fma_f32 v71, v85, v98, v84
    v_cvt_pk_bf16_f32 v40, v64, v65
    v_cvt_pk_bf16_f32 v41, v66, v67
    v_cvt_pk_bf16_f32 v42, v68, v69
    v_cvt_pk_bf16_f32 v43, v70, v71
    s_add_u32 s25, s24, 1792
    s_cmp_ge_u32 s25, 2048
    s_cbranch_scc1 L_lnrow_34
    s_lshl_b32 s25, s25, 10
    s_add_u32 s25, s25, 0
    buffer_store_dwordx4 v[40:43], v24, s[8:11], s25 offen sc1
L_lnrow_34:
    s_waitcnt vmcnt(0)
    s_barrier
    s_cmp_eq_u32 s5, 0
    s_cbranch_scc0 L_c0_35
    v_mov_b32 v20, 1
    s_mov_b64 exec, 1
    s_mov_b32 s24, 32
    buffer_atomic_add v20, off, s[52:55], s24 sc1
    s_mov_b64 exec, -1
L_c0_35:
    s_cmp_ge_u32 s6, 4
    s_cbranch_scc1 L_w2
    v_and_b32 v100, 63, v0
    v_and_b32 v101, 15, v100
    v_lshrrev_b32 v102, 4, v100
    s_load_dwordx2 s[56:57], s[0:1], 24
    s_waitcnt lgkmcnt(0)
    s_mov_b32 s28, s56
    s_and_b32 s29, s57, 0xffff
    s_mov_b32 s30, 4194304
    s_mov_b32 s31, 0x20000
    s_load_dwordx2 s[56:57], s[0:1], 32
    s_waitcnt lgkmcnt(0)
    s_mov_b32 s32, s56
    s_and_b32 s33, s57, 0xffff
    s_mov_b32 s34, 4194304
    s_mov_b32 s35, 0x20000
    s_load_dwordx2 s[56:57], s[0:1], 16
    s_waitcnt lgkmcnt(0)
    s_mov_b32 s36, s56
    s_and_b32 s37, s57, 0xffff
    s_mov_b32 s38, 4194304
    s_mov_b32 s39, 0x20000
    v_and_b32 v103, 3, v102
    v_lshlrev_b32 v103, 1, v103
    v_xor_b32 v103, v103, v101
    s_lshl_b32 s26, s5, 4
    s_mov_b32 s27, 8192
    v_xor_b32 v104, 0, v103
    v_lshlrev_b32 v104, 4, v104
    v_add_u32 v105, s26, v102
    v_add_u32 v105, 0, v105
    v_mul_lo_u32 v24, s27, v105
    v_add_u32 v24, v24, v104
    v_xor_b32 v104, 0, v103
    v_lshlrev_b32 v104, 4, v104
    v_add_u32 v105, s26, v102
    v_add_u32_e64 v105, 4, v105
    v_mul_lo_u32 v25, s27, v105
    v_add_u32 v25, v25, v104
    v_xor_b32 v104, 8, v103
    v_lshlrev_b32 v104, 4, v104
    v_add_u32 v105, s26, v102
    v_add_u32_e64 v105, 8, v105
    v_mul_lo_u32 v26, s27, v105
    v_add_u32 v26, v26, v104
    v_xor_b32 v104, 8, v103
    v_lshlrev_b32 v104, 4, v104
    v_add_u32 v105, s26, v102
    v_add_u32_e64 v105, 12, v105
    v_mul_lo_u32 v27, s27, v105
    v_add_u32 v27, v27, v104
    s_lshl_b32 s26, s17, 8
    v_add_u32 v24, s26, v24
    v_add_u32 v25, s26, v25
    v_add_u32 v26, s26, v26
    v_add_u32 v27, s26, v27
    v_lshrrev_b32 v103, 2, v101
    v_and_b32 v104, 3, v101
    v_lshl_add_u32 v105, v102, 3, v103
    v_lshlrev_b32_e64 v32, 8, v105
    v_lshl_add_u32 v32, v104, 3, v32
    v_and_b32 v105, 1, v102
    v_lshlrev_b32 v105, 2, v105
    v_add_u32 v105, v105, v103
    v_lshlrev_b32 v33, 5, v105
    s_lshl_b32 s24, s5, 6
    s_add_u32 s24, s24, 0
    v_xor_b32 v34, s24, v33
    v_add_u32 v34, v34, v32
    s_lshl_b32 s24, s5, 6
    s_add_u32 s24, s24, 32
    v_xor_b32 v35, s24, v33
    v_add_u32_e64 v35, v35, v32
    s_lshl_b32 s24, s5, 12
    s_add_u32 m0, s24, 0
    s_mov_b32 s25, 0
    buffer_load_dwordx4 v24, s[28:31], s25 offen lds
    s_lshl_b32 s24, s5, 12
    s_add_u32 m0, s24, 1024
    s_mov_b32 s25, 0
    buffer_load_dwordx4 v25, s[28:31], s25 offen lds
    s_lshl_b32 s24, s5, 12
    s_add_u32 m0, s24, 2048
    s_mov_b32 s25, 0
    buffer_load_dwordx4 v26, s[28:31], s25 offen lds
    s_lshl_b32 s24, s5, 12
    s_add_u32 m0, s24, 3072
    s_mov_b32 s25, 0
    buffer_load_dwordx4 v27, s[28:31], s25 offen lds
    s_lshl_b32 s24, s5, 12
    s_nop 0
    s_add_u32 m0, s24, 16384
    s_mov_b32 s25, 524288
    buffer_load_dwordx4 v24, s[28:31], s25 offen lds
    s_lshl_b32 s24, s5, 12
    s_nop 0
    s_add_u32 m0, s24, 17408
    s_mov_b32 s25, 524288
    buffer_load_dwordx4 v25, s[28:31], s25 offen lds
    s_lshl_b32 s24, s5, 12
    s_nop 0
    s_add_u32 m0, s24, 18432
    s_mov_b32 s25, 524288
    buffer_load_dwordx4 v26, s[28:31], s25 offen lds
    s_lshl_b32 s24, s5, 12
    s_nop 0
    s_add_u32 m0, s24, 19456
    s_mov_b32 s25, 524288
    buffer_load_dwordx4 v27, s[28:31], s25 offen lds
    s_lshl_b32 s24, s5, 12
    s_nop 0
    s_add_u32 m0, s24, 32768
    s_mov_b32 s25, 1048576
    buffer_load_dwordx4 v24, s[28:31], s25 offen lds
    s_lshl_b32 s24, s5, 12
    s_nop 0
    s_add_u32 m0, s24, 33792
    s_mov_b32 s25, 1048576
    buffer_load_dwordx4 v25, s[28:31], s25 offen lds
    s_lshl_b32 s24, s5, 12
    s_nop 0
    s_add_u32 m0, s24, 34816
    s_mov_b32 s25, 1048576
    buffer_load_dwordx4 v26, s[28:31], s25 offen lds
    s_lshl_b32 s24, s5, 12
    s_nop 0
    s_add_u32 m0, s24, 35840
    s_mov_b32 s25, 1048576
    buffer_load_dwordx4 v27, s[28:31], s25 offen lds
    s_lshl_b32 s24, s5, 12
    s_nop 0
    s_add_u32 m0, s24, 49152
    s_mov_b32 s25, 1572864
    buffer_load_dwordx4 v24, s[28:31], s25 offen lds
    s_lshl_b32 s24, s5, 12
    s_nop 0
    s_add_u32 m0, s24, 50176
    s_mov_b32 s25, 1572864
    buffer_load_dwordx4 v25, s[28:31], s25 offen lds
    s_lshl_b32 s24, s5, 12
    s_nop 0
    s_add_u32 m0, s24, 51200
    s_mov_b32 s25, 1572864
    buffer_load_dwordx4 v26, s[28:31], s25 offen lds
    s_lshl_b32 s24, s5, 12
    s_nop 0
    s_add_u32 m0, s24, 52224
    s_mov_b32 s25, 1572864
    buffer_load_dwordx4 v27, s[28:31], s25 offen lds
    s_lshl_b32 s24, s5, 12
    s_nop 0
    s_add_u32 m0, s24, 65536
    s_mov_b32 s25, 2097152
    buffer_load_dwordx4 v24, s[28:31], s25 offen lds
    s_lshl_b32 s24, s5, 12
    s_nop 0
    s_add_u32 m0, s24, 66560
    s_mov_b32 s25, 2097152
    buffer_load_dwordx4 v25, s[28:31], s25 offen lds
    s_lshl_b32 s24, s5, 12
    s_nop 0
    s_add_u32 m0, s24, 67584
    s_mov_b32 s25, 2097152
    buffer_load_dwordx4 v26, s[28:31], s25 offen lds
    s_lshl_b32 s24, s5, 12
    s_nop 0
    s_add_u32 m0, s24, 68608
    s_mov_b32 s25, 2097152
    buffer_load_dwordx4 v27, s[28:31], s25 offen lds
    s_lshl_b32 s24, s5, 12
    s_nop 0
    s_add_u32 m0, s24, 81920
    s_mov_b32 s25, 2621440
    buffer_load_dwordx4 v24, s[28:31], s25 offen lds
    s_lshl_b32 s24, s5, 12
    s_nop 0
    s_add_u32 m0, s24, 82944
    s_mov_b32 s25, 2621440
    buffer_load_dwordx4 v25, s[28:31], s25 offen lds
    s_lshl_b32 s24, s5, 12
    s_nop 0
    s_add_u32 m0, s24, 83968
    s_mov_b32 s25, 2621440
    buffer_load_dwordx4 v26, s[28:31], s25 offen lds
    s_lshl_b32 s24, s5, 12
    s_nop 0
    s_add_u32 m0, s24, 84992
    s_mov_b32 s25, 2621440
    buffer_load_dwordx4 v27, s[28:31], s25 offen lds
    s_lshl_b32 s24, s5, 12
    s_nop 0
    s_add_u32 m0, s24, 98304
    s_mov_b32 s25, 3145728
    buffer_load_dwordx4 v24, s[28:31], s25 offen lds
    s_lshl_b32 s24, s5, 12
    s_nop 0
    s_add_u32 m0, s24, 99328
    s_mov_b32 s25, 3145728
    buffer_load_dwordx4 v25, s[28:31], s25 offen lds
    s_lshl_b32 s24, s5, 12
    s_nop 0
    s_add_u32 m0, s24, 100352
    s_mov_b32 s25, 3145728
    buffer_load_dwordx4 v26, s[28:31], s25 offen lds
    s_lshl_b32 s24, s5, 12
    s_nop 0
    s_add_u32 m0, s24, 101376
    s_mov_b32 s25, 3145728
    buffer_load_dwordx4 v27, s[28:31], s25 offen lds
    s_lshl_b32 s24, s5, 12
    s_nop 0
    s_add_u32 m0, s24, 114688
    s_mov_b32 s25, 3670016
    buffer_load_dwordx4 v24, s[28:31], s25 offen lds
    s_lshl_b32 s24, s5, 12
    s_nop 0
    s_add_u32 m0, s24, 115712
    s_mov_b32 s25, 3670016
    buffer_load_dwordx4 v25, s[28:31], s25 offen lds
    s_lshl_b32 s24, s5, 12
    s_nop 0
    s_add_u32 m0, s24, 116736
    s_mov_b32 s25, 3670016
    buffer_load_dwordx4 v26, s[28:31], s25 offen lds
    s_lshl_b32 s24, s5, 12
    s_nop 0
    s_add_u32 m0, s24, 117760
    s_mov_b32 s25, 3670016
    buffer_load_dwordx4 v27, s[28:31], s25 offen lds
    s_waitcnt vmcnt(28)
    s_barrier
    v_add_u32 v36, 0, v34
    v_add_u32 v37, 0, v35
    ds_read_b64_tr_b16 a[128:129], v36 offset:0
    ds_read_b64_tr_b16 a[130:131], v36 offset:1024
    ds_read_b64_tr_b16 a[132:133], v36 offset:8192
    ds_read_b64_tr_b16 a[134:135], v36 offset:9216
    ds_read_b64_tr_b16 a[192:193], v37 offset:0
    ds_read_b64_tr_b16 a[194:195], v37 offset:1024
    ds_read_b64_tr_b16 a[196:197], v37 offset:8192
    ds_read_b64_tr_b16 a[198:199], v37 offset:9216
    s_waitcnt lgkmcnt(0)
    s_barrier
    s_lshl_b32 s24, s5, 12
    s_add_u32 m0, s24, 0
    s_mov_b32 s25, 0
    buffer_load_dwordx4 v24, s[32:35], s25 offen lds
    s_lshl_b32 s24, s5, 12
    s_add_u32 m0, s24, 1024
    s_mov_b32 s25, 0
    buffer_load_dwordx4 v25, s[32:35], s25 offen lds
    s_lshl_b32 s24, s5, 12
    s_add_u32 m0, s24, 2048
    s_mov_b32 s25, 0
    buffer_load_dwordx4 v26, s[32:35], s25 offen lds
    s_lshl_b32 s24, s5, 12
    s_add_u32 m0, s24, 3072
    s_mov_b32 s25, 0
    buffer_load_dwordx4 v27, s[32:35], s25 offen lds
    s_waitcnt vmcnt(28)
    s_barrier
    s_nop 0
    v_add_u32 v36, 16384, v34
    v_add_u32 v37, 16384, v35
    ds_read_b64_tr_b16 a[136:137], v36 offset:0
    ds_read_b64_tr_b16 a[138:139], v36 offset:1024
    ds_read_b64_tr_b16 a[140:141], v36 offset:8192
    ds_read_b64_tr_b16 a[142:143], v36 offset:9216
    ds_read_b64_tr_b16 a[200:201], v37 offset:0
    ds_read_b64_tr_b16 a[202:203], v37 offset:1024
    ds_read_b64_tr_b16 a[204:205], v37 offset:8192
    ds_read_b64_tr_b16 a[206:207], v37 offset:9216
    s_waitcnt lgkmcnt(0)
    s_barrier
    s_lshl_b32 s24, s5, 12
    s_nop 0
    s_add_u32 m0, s24, 16384
    s_mov_b32 s25, 524288
    buffer_load_dwordx4 v24, s[32:35], s25 offen lds
    s_lshl_b32 s24, s5, 12
    s_nop 0
    s_add_u32 m0, s24, 17408
    s_mov_b32 s25, 524288
    buffer_load_dwordx4 v25, s[32:35], s25 offen lds
    s_lshl_b32 s24, s5, 12
    s_nop 0
    s_add_u32 m0, s24, 18432
    s_mov_b32 s25, 524288
    buffer_load_dwordx4 v26, s[32:35], s25 offen lds
    s_lshl_b32 s24, s5, 12
    s_nop 0
    s_add_u32 m0, s24, 19456
    s_mov_b32 s25, 524288
    buffer_load_dwordx4 v27, s[32:35], s25 offen lds
    s_waitcnt vmcnt(28)
    s_barrier
    v_add_u32 v36, 32768, v34
    v_add_u32 v37, 32768, v35
    ds_read_b64_tr_b16 a[144:145], v36 offset:0
    ds_read_b64_tr_b16 a[146:147], v36 offset:1024
    ds_read_b64_tr_b16 a[148:149], v36 offset:8192
    ds_read_b64_tr_b16 a[150:151], v36 offset:9216
    ds_read_b64_tr_b16 a[208:209], v37 offset:0
    ds_read_b64_tr_b16 a[210:211], v37 offset:1024
    ds_read_b64_tr_b16 a[212:213], v37 offset:8192
    ds_read_b64_tr_b16 a[214:215], v37 offset:9216
    s_waitcnt lgkmcnt(0)
    s_barrier
    s_lshl_b32 s24, s5, 12
    s_nop 0
    s_add_u32 m0, s24, 32768
    s_mov_b32 s25, 1048576
    buffer_load_dwordx4 v24, s[32:35], s25 offen lds
    s_lshl_b32 s24, s5, 12
    s_nop 0
    s_add_u32 m0, s24, 33792
    s_mov_b32 s25, 1048576
    buffer_load_dwordx4 v25, s[32:35], s25 offen lds
    s_lshl_b32 s24, s5, 12
    s_nop 0
    s_add_u32 m0, s24, 34816
    s_mov_b32 s25, 1048576
    buffer_load_dwordx4 v26, s[32:35], s25 offen lds
    s_lshl_b32 s24, s5, 12
    s_nop 0
    s_add_u32 m0, s24, 35840
    s_mov_b32 s25, 1048576
    buffer_load_dwordx4 v27, s[32:35], s25 offen lds
    s_waitcnt vmcnt(28)
    s_barrier
    v_add_u32 v36, 49152, v34
    v_add_u32 v37, 49152, v35
    ds_read_b64_tr_b16 a[152:153], v36 offset:0
    ds_read_b64_tr_b16 a[154:155], v36 offset:1024
    ds_read_b64_tr_b16 a[156:157], v36 offset:8192
    ds_read_b64_tr_b16 a[158:159], v36 offset:9216
    ds_read_b64_tr_b16 a[216:217], v37 offset:0
    ds_read_b64_tr_b16 a[218:219], v37 offset:1024
    ds_read_b64_tr_b16 a[220:221], v37 offset:8192
    ds_read_b64_tr_b16 a[222:223], v37 offset:9216
    s_waitcnt lgkmcnt(0)
    s_barrier
    s_lshl_b32 s24, s5, 12
    s_nop 0
    s_add_u32 m0, s24, 49152
    s_mov_b32 s25, 1572864
    buffer_load_dwordx4 v24, s[32:35], s25 offen lds
    s_lshl_b32 s24, s5, 12
    s_nop 0
    s_add_u32 m0, s24, 50176
    s_mov_b32 s25, 1572864
    buffer_load_dwordx4 v25, s[32:35], s25 offen lds
    s_lshl_b32 s24, s5, 12
    s_nop 0
    s_add_u32 m0, s24, 51200
    s_mov_b32 s25, 1572864
    buffer_load_dwordx4 v26, s[32:35], s25 offen lds
    s_lshl_b32 s24, s5, 12
    s_nop 0
    s_add_u32 m0, s24, 52224
    s_mov_b32 s25, 1572864
    buffer_load_dwordx4 v27, s[32:35], s25 offen lds
    s_waitcnt vmcnt(28)
    s_barrier
    v_add_u32 v36, 65536, v34
    v_add_u32 v37, 65536, v35
    ds_read_b64_tr_b16 a[160:161], v36 offset:0
    ds_read_b64_tr_b16 a[162:163], v36 offset:1024
    ds_read_b64_tr_b16 a[164:165], v36 offset:8192
    ds_read_b64_tr_b16 a[166:167], v36 offset:9216
    ds_read_b64_tr_b16 a[224:225], v37 offset:0
    ds_read_b64_tr_b16 a[226:227], v37 offset:1024
    ds_read_b64_tr_b16 a[228:229], v37 offset:8192
    ds_read_b64_tr_b16 a[230:231], v37 offset:9216
    s_waitcnt lgkmcnt(0)
    s_barrier
    s_lshl_b32 s24, s5, 12
    s_nop 0
    s_add_u32 m0, s24, 65536
    s_mov_b32 s25, 2097152
    buffer_load_dwordx4 v24, s[32:35], s25 offen lds
    s_lshl_b32 s24, s5, 12
    s_nop 0
    s_add_u32 m0, s24, 66560
    s_mov_b32 s25, 2097152
    buffer_load_dwordx4 v25, s[32:35], s25 offen lds
    s_lshl_b32 s24, s5, 12
    s_nop 0
    s_add_u32 m0, s24, 67584
    s_mov_b32 s25, 2097152
    buffer_load_dwordx4 v26, s[32:35], s25 offen lds
    s_lshl_b32 s24, s5, 12
    s_nop 0
    s_add_u32 m0, s24, 68608
    s_mov_b32 s25, 2097152
    buffer_load_dwordx4 v27, s[32:35], s25 offen lds
    s_waitcnt vmcnt(28)
    s_barrier
    v_add_u32 v36, 81920, v34
    v_add_u32 v37, 81920, v35
    ds_read_b64_tr_b16 a[168:169], v36 offset:0
    ds_read_b64_tr_b16 a[170:171], v36 offset:1024
    ds_read_b64_tr_b16 a[172:173], v36 offset:8192
    ds_read_b64_tr_b16 a[174:175], v36 offset:9216
    ds_read_b64_tr_b16 a[232:233], v37 offset:0
    ds_read_b64_tr_b16 a[234:235], v37 offset:1024
    ds_read_b64_tr_b16 a[236:237], v37 offset:8192
    ds_read_b64_tr_b16 a[238:239], v37 offset:9216
    s_waitcnt lgkmcnt(0)
    s_barrier
    s_lshl_b32 s24, s5, 12
    s_nop 0
    s_add_u32 m0, s24, 81920
    s_mov_b32 s25, 2621440
    buffer_load_dwordx4 v24, s[32:35], s25 offen lds
    s_lshl_b32 s24, s5, 12
    s_nop 0
    s_add_u32 m0, s24, 82944
    s_mov_b32 s25, 2621440
    buffer_load_dwordx4 v25, s[32:35], s25 offen lds
    s_lshl_b32 s24, s5, 12
    s_nop 0
    s_add_u32 m0, s24, 83968
    s_mov_b32 s25, 2621440
    buffer_load_dwordx4 v26, s[32:35], s25 offen lds
    s_lshl_b32 s24, s5, 12
    s_nop 0
    s_add_u32 m0, s24, 84992
    s_mov_b32 s25, 2621440
    buffer_load_dwordx4 v27, s[32:35], s25 offen lds
    s_waitcnt vmcnt(28)
    s_barrier
    v_add_u32 v36, 98304, v34
    v_add_u32 v37, 98304, v35
    ds_read_b64_tr_b16 a[176:177], v36 offset:0
    ds_read_b64_tr_b16 a[178:179], v36 offset:1024
    ds_read_b64_tr_b16 a[180:181], v36 offset:8192
    ds_read_b64_tr_b16 a[182:183], v36 offset:9216
    ds_read_b64_tr_b16 a[240:241], v37 offset:0
    ds_read_b64_tr_b16 a[242:243], v37 offset:1024
    ds_read_b64_tr_b16 a[244:245], v37 offset:8192
    ds_read_b64_tr_b16 a[246:247], v37 offset:9216
    s_waitcnt lgkmcnt(0)
    s_barrier
    s_lshl_b32 s24, s5, 12
    s_nop 0
    s_add_u32 m0, s24, 98304
    s_mov_b32 s25, 3145728
    buffer_load_dwordx4 v24, s[32:35], s25 offen lds
    s_lshl_b32 s24, s5, 12
    s_nop 0
    s_add_u32 m0, s24, 99328
    s_mov_b32 s25, 3145728
    buffer_load_dwordx4 v25, s[32:35], s25 offen lds
    s_lshl_b32 s24, s5, 12
    s_nop 0
    s_add_u32 m0, s24, 100352
    s_mov_b32 s25, 3145728
    buffer_load_dwordx4 v26, s[32:35], s25 offen lds
    s_lshl_b32 s24, s5, 12
    s_nop 0
    s_add_u32 m0, s24, 101376
    s_mov_b32 s25, 3145728
    buffer_load_dwordx4 v27, s[32:35], s25 offen lds
    s_waitcnt vmcnt(28)
    s_barrier
    v_add_u32 v36, 114688, v34
    v_add_u32 v37, 114688, v35
    ds_read_b64_tr_b16 a[184:185], v36 offset:0
    ds_read_b64_tr_b16 a[186:187], v36 offset:1024
    ds_read_b64_tr_b16 a[188:189], v36 offset:8192
    ds_read_b64_tr_b16 a[190:191], v36 offset:9216
    ds_read_b64_tr_b16 a[248:249], v37 offset:0
    ds_read_b64_tr_b16 a[250:251], v37 offset:1024
    ds_read_b64_tr_b16 a[252:253], v37 offset:8192
    ds_read_b64_tr_b16 a[254:255], v37 offset:9216
    s_waitcnt lgkmcnt(0)
    s_barrier
    s_lshl_b32 s24, s5, 12
    s_nop 0
    s_add_u32 m0, s24, 114688
    s_mov_b32 s25, 3670016
    buffer_load_dwordx4 v24, s[32:35], s25 offen lds
    s_lshl_b32 s24, s5, 12
    s_nop 0
    s_add_u32 m0, s24, 115712
    s_mov_b32 s25, 3670016
    buffer_load_dwordx4 v25, s[32:35], s25 offen lds
    s_lshl_b32 s24, s5, 12
    s_nop 0
    s_add_u32 m0, s24, 116736
    s_mov_b32 s25, 3670016
    buffer_load_dwordx4 v26, s[32:35], s25 offen lds
    s_lshl_b32 s24, s5, 12
    s_nop 0
    s_add_u32 m0, s24, 117760
    s_mov_b32 s25, 3670016
    buffer_load_dwordx4 v27, s[32:35], s25 offen lds
    s_waitcnt vmcnt(28)
    s_barrier
    v_add_u32 v36, 0, v34
    v_add_u32 v37, 0, v35
    ds_read_b64_tr_b16 v[128:129], v36 offset:0
    ds_read_b64_tr_b16 v[130:131], v36 offset:1024
    ds_read_b64_tr_b16 v[132:133], v36 offset:8192
    ds_read_b64_tr_b16 v[134:135], v36 offset:9216
    ds_read_b64_tr_b16 v[192:193], v37 offset:0
    ds_read_b64_tr_b16 v[194:195], v37 offset:1024
    ds_read_b64_tr_b16 v[196:197], v37 offset:8192
    ds_read_b64_tr_b16 v[198:199], v37 offset:9216
    s_waitcnt lgkmcnt(0)
    s_barrier
    s_lshl_b32 s24, s5, 12
    s_add_u32 m0, s24, 0
    s_mov_b32 s25, 0
    buffer_load_dwordx4 v24, s[36:39], s25 offen lds
    s_lshl_b32 s24, s5, 12
    s_add_u32 m0, s24, 1024
    s_mov_b32 s25, 0
    buffer_load_dwordx4 v25, s[36:39], s25 offen lds
    s_lshl_b32 s24, s5, 12
    s_add_u32 m0, s24, 2048
    s_mov_b32 s25, 0
    buffer_load_dwordx4 v26, s[36:39], s25 offen lds
    s_lshl_b32 s24, s5, 12
    s_add_u32 m0, s24, 3072
    s_mov_b32 s25, 0
    buffer_load_dwordx4 v27, s[36:39], s25 offen lds
    s_waitcnt vmcnt(28)
    s_barrier
    s_nop 0
    v_add_u32 v36, 16384, v34
    v_add_u32 v37, 16384, v35
    ds_read_b64_tr_b16 v[136:137], v36 offset:0
    ds_read_b64_tr_b16 v[138:139], v36 offset:1024
    ds_read_b64_tr_b16 v[140:141], v36 offset:8192
    ds_read_b64_tr_b16 v[142:143], v36 offset:9216
    ds_read_b64_tr_b16 v[200:201], v37 offset:0
    ds_read_b64_tr_b16 v[202:203], v37 offset:1024
    ds_read_b64_tr_b16 v[204:205], v37 offset:8192
    ds_read_b64_tr_b16 v[206:207], v37 offset:9216
    s_waitcnt lgkmcnt(0)
    s_barrier
    s_lshl_b32 s24, s5, 12
    s_nop 0
    s_add_u32 m0, s24, 16384
    s_mov_b32 s25, 524288
    buffer_load_dwordx4 v24, s[36:39], s25 offen lds
    s_lshl_b32 s24, s5, 12
    s_nop 0
    s_add_u32 m0, s24, 17408
    s_mov_b32 s25, 524288
    buffer_load_dwordx4 v25, s[36:39], s25 offen lds
    s_lshl_b32 s24, s5, 12
    s_nop 0
    s_add_u32 m0, s24, 18432
    s_mov_b32 s25, 524288
    buffer_load_dwordx4 v26, s[36:39], s25 offen lds
    s_lshl_b32 s24, s5, 12
    s_nop 0
    s_add_u32 m0, s24, 19456
    s_mov_b32 s25, 524288
    buffer_load_dwordx4 v27, s[36:39], s25 offen lds
    s_waitcnt vmcnt(28)
    s_barrier
    v_add_u32 v36, 32768, v34
    v_add_u32 v37, 32768, v35
    ds_read_b64_tr_b16 v[144:145], v36 offset:0
    ds_read_b64_tr_b16 v[146:147], v36 offset:1024
    ds_read_b64_tr_b16 v[148:149], v36 offset:8192
    ds_read_b64_tr_b16 v[150:151], v36 offset:9216
    ds_read_b64_tr_b16 v[208:209], v37 offset:0
    ds_read_b64_tr_b16 v[210:211], v37 offset:1024
    ds_read_b64_tr_b16 v[212:213], v37 offset:8192
    ds_read_b64_tr_b16 v[214:215], v37 offset:9216
    s_waitcnt lgkmcnt(0)
    s_barrier
    s_lshl_b32 s24, s5, 12
    s_nop 0
    s_add_u32 m0, s24, 32768
    s_mov_b32 s25, 1048576
    buffer_load_dwordx4 v24, s[36:39], s25 offen lds
    s_lshl_b32 s24, s5, 12
    s_nop 0
    s_add_u32 m0, s24, 33792
    s_mov_b32 s25, 1048576
    buffer_load_dwordx4 v25, s[36:39], s25 offen lds
    s_lshl_b32 s24, s5, 12
    s_nop 0
    s_add_u32 m0, s24, 34816
    s_mov_b32 s25, 1048576
    buffer_load_dwordx4 v26, s[36:39], s25 offen lds
    s_lshl_b32 s24, s5, 12
    s_nop 0
    s_add_u32 m0, s24, 35840
    s_mov_b32 s25, 1048576
    buffer_load_dwordx4 v27, s[36:39], s25 offen lds
    s_waitcnt vmcnt(28)
    s_barrier
    v_add_u32 v36, 49152, v34
    v_add_u32 v37, 49152, v35
    ds_read_b64_tr_b16 v[152:153], v36 offset:0
    ds_read_b64_tr_b16 v[154:155], v36 offset:1024
    ds_read_b64_tr_b16 v[156:157], v36 offset:8192
    ds_read_b64_tr_b16 v[158:159], v36 offset:9216
    ds_read_b64_tr_b16 v[216:217], v37 offset:0
    ds_read_b64_tr_b16 v[218:219], v37 offset:1024
    ds_read_b64_tr_b16 v[220:221], v37 offset:8192
    ds_read_b64_tr_b16 v[222:223], v37 offset:9216
    s_waitcnt lgkmcnt(0)
    s_barrier
    s_lshl_b32 s24, s5, 12
    s_nop 0
    s_add_u32 m0, s24, 49152
    s_mov_b32 s25, 1572864
    buffer_load_dwordx4 v24, s[36:39], s25 offen lds
    s_lshl_b32 s24, s5, 12
    s_nop 0
    s_add_u32 m0, s24, 50176
    s_mov_b32 s25, 1572864
    buffer_load_dwordx4 v25, s[36:39], s25 offen lds
    s_lshl_b32 s24, s5, 12
    s_nop 0
    s_add_u32 m0, s24, 51200
    s_mov_b32 s25, 1572864
    buffer_load_dwordx4 v26, s[36:39], s25 offen lds
    s_lshl_b32 s24, s5, 12
    s_nop 0
    s_add_u32 m0, s24, 52224
    s_mov_b32 s25, 1572864
    buffer_load_dwordx4 v27, s[36:39], s25 offen lds
    s_waitcnt vmcnt(28)
    s_barrier
    v_add_u32 v36, 65536, v34
    v_add_u32 v37, 65536, v35
    ds_read_b64_tr_b16 v[160:161], v36 offset:0
    ds_read_b64_tr_b16 v[162:163], v36 offset:1024
    ds_read_b64_tr_b16 v[164:165], v36 offset:8192
    ds_read_b64_tr_b16 v[166:167], v36 offset:9216
    ds_read_b64_tr_b16 v[224:225], v37 offset:0
    ds_read_b64_tr_b16 v[226:227], v37 offset:1024
    ds_read_b64_tr_b16 v[228:229], v37 offset:8192
    ds_read_b64_tr_b16 v[230:231], v37 offset:9216
    s_waitcnt lgkmcnt(0)
    s_barrier
    s_lshl_b32 s24, s5, 12
    s_nop 0
    s_add_u32 m0, s24, 65536
    s_mov_b32 s25, 2097152
    buffer_load_dwordx4 v24, s[36:39], s25 offen lds
    s_lshl_b32 s24, s5, 12
    s_nop 0
    s_add_u32 m0, s24, 66560
    s_mov_b32 s25, 2097152
    buffer_load_dwordx4 v25, s[36:39], s25 offen lds
    s_lshl_b32 s24, s5, 12
    s_nop 0
    s_add_u32 m0, s24, 67584
    s_mov_b32 s25, 2097152
    buffer_load_dwordx4 v26, s[36:39], s25 offen lds
    s_lshl_b32 s24, s5, 12
    s_nop 0
    s_add_u32 m0, s24, 68608
    s_mov_b32 s25, 2097152
    buffer_load_dwordx4 v27, s[36:39], s25 offen lds
    s_waitcnt vmcnt(28)
    s_barrier
    v_add_u32 v36, 81920, v34
    v_add_u32 v37, 81920, v35
    ds_read_b64_tr_b16 v[168:169], v36 offset:0
    ds_read_b64_tr_b16 v[170:171], v36 offset:1024
    ds_read_b64_tr_b16 v[172:173], v36 offset:8192
    ds_read_b64_tr_b16 v[174:175], v36 offset:9216
    ds_read_b64_tr_b16 v[232:233], v37 offset:0
    ds_read_b64_tr_b16 v[234:235], v37 offset:1024
    ds_read_b64_tr_b16 v[236:237], v37 offset:8192
    ds_read_b64_tr_b16 v[238:239], v37 offset:9216
    s_waitcnt lgkmcnt(0)
    s_barrier
    s_lshl_b32 s24, s5, 12
    s_nop 0
    s_add_u32 m0, s24, 81920
    s_mov_b32 s25, 2621440
    buffer_load_dwordx4 v24, s[36:39], s25 offen lds
    s_lshl_b32 s24, s5, 12
    s_nop 0
    s_add_u32 m0, s24, 82944
    s_mov_b32 s25, 2621440
    buffer_load_dwordx4 v25, s[36:39], s25 offen lds
    s_lshl_b32 s24, s5, 12
    s_nop 0
    s_add_u32 m0, s24, 83968
    s_mov_b32 s25, 2621440
    buffer_load_dwordx4 v26, s[36:39], s25 offen lds
    s_lshl_b32 s24, s5, 12
    s_nop 0
    s_add_u32 m0, s24, 84992
    s_mov_b32 s25, 2621440
    buffer_load_dwordx4 v27, s[36:39], s25 offen lds
    s_waitcnt vmcnt(28)
    s_barrier
    v_add_u32 v36, 98304, v34
    v_add_u32 v37, 98304, v35
    ds_read_b64_tr_b16 v[176:177], v36 offset:0
    ds_read_b64_tr_b16 v[178:179], v36 offset:1024
    ds_read_b64_tr_b16 v[180:181], v36 offset:8192
    ds_read_b64_tr_b16 v[182:183], v36 offset:9216
    ds_read_b64_tr_b16 v[240:241], v37 offset:0
    ds_read_b64_tr_b16 v[242:243], v37 offset:1024
    ds_read_b64_tr_b16 v[244:245], v37 offset:8192
    ds_read_b64_tr_b16 v[246:247], v37 offset:9216
    s_waitcnt lgkmcnt(0)
    s_barrier
    s_lshl_b32 s24, s5, 12
    s_nop 0
    s_add_u32 m0, s24, 98304
    s_mov_b32 s25, 3145728
    buffer_load_dwordx4 v24, s[36:39], s25 offen lds
    s_lshl_b32 s24, s5, 12
    s_nop 0
    s_add_u32 m0, s24, 99328
    s_mov_b32 s25, 3145728
    buffer_load_dwordx4 v25, s[36:39], s25 offen lds
    s_lshl_b32 s24, s5, 12
    s_nop 0
    s_add_u32 m0, s24, 100352
    s_mov_b32 s25, 3145728
    buffer_load_dwordx4 v26, s[36:39], s25 offen lds
    s_lshl_b32 s24, s5, 12
    s_nop 0
    s_add_u32 m0, s24, 101376
    s_mov_b32 s25, 3145728
    buffer_load_dwordx4 v27, s[36:39], s25 offen lds
    s_waitcnt vmcnt(28)
    s_barrier
    v_add_u32 v36, 114688, v34
    v_add_u32 v37, 114688, v35
    ds_read_b64_tr_b16 v[184:185], v36 offset:0
    ds_read_b64_tr_b16 v[186:187], v36 offset:1024
    ds_read_b64_tr_b16 v[188:189], v36 offset:8192
    ds_read_b64_tr_b16 v[190:191], v36 offset:9216
    ds_read_b64_tr_b16 v[248:249], v37 offset:0
    ds_read_b64_tr_b16 v[250:251], v37 offset:1024
    ds_read_b64_tr_b16 v[252:253], v37 offset:8192
    ds_read_b64_tr_b16 v[254:255], v37 offset:9216
    s_waitcnt lgkmcnt(0)
    s_barrier
    s_lshl_b32 s24, s5, 12
    s_nop 0
    s_add_u32 m0, s24, 114688
    s_mov_b32 s25, 3670016
    buffer_load_dwordx4 v24, s[36:39], s25 offen lds
    s_lshl_b32 s24, s5, 12
    s_nop 0
    s_add_u32 m0, s24, 115712
    s_mov_b32 s25, 3670016
    buffer_load_dwordx4 v25, s[36:39], s25 offen lds
    s_lshl_b32 s24, s5, 12
    s_nop 0
    s_add_u32 m0, s24, 116736
    s_mov_b32 s25, 3670016
    buffer_load_dwordx4 v26, s[36:39], s25 offen lds
    s_lshl_b32 s24, s5, 12
    s_nop 0
    s_add_u32 m0, s24, 117760
    s_mov_b32 s25, 3670016
    buffer_load_dwordx4 v27, s[36:39], s25 offen lds
    s_waitcnt vmcnt(28)
    s_barrier
    v_add_u32 v36, 0, v34
    v_add_u32 v37, 0, v35
    ds_read_b64_tr_b16 a[0:1], v36 offset:0
    ds_read_b64_tr_b16 a[2:3], v36 offset:1024
    ds_read_b64_tr_b16 a[4:5], v36 offset:8192
    ds_read_b64_tr_b16 a[6:7], v36 offset:9216
    ds_read_b64_tr_b16 a[64:65], v37 offset:0
    ds_read_b64_tr_b16 a[66:67], v37 offset:1024
    ds_read_b64_tr_b16 a[68:69], v37 offset:8192
    ds_read_b64_tr_b16 a[70:71], v37 offset:9216
    s_waitcnt lgkmcnt(0)
    s_barrier
    s_waitcnt vmcnt(24)
    s_barrier
    v_add_u32 v36, 16384, v34
    v_add_u32 v37, 16384, v35
    ds_read_b64_tr_b16 a[8:9], v36 offset:0
    ds_read_b64_tr_b16 a[10:11], v36 offset:1024
    ds_read_b64_tr_b16 a[12:13], v36 offset:8192
    ds_read_b64_tr_b16 a[14:15], v36 offset:9216
    ds_read_b64_tr_b16 a[72:73], v37 offset:0
    ds_read_b64_tr_b16 a[74:75], v37 offset:1024
    ds_read_b64_tr_b16 a[76:77], v37 offset:8192
    ds_read_b64_tr_b16 a[78:79], v37 offset:9216
    s_waitcnt lgkmcnt(0)
    s_barrier
    s_waitcnt vmcnt(20)
    s_barrier
    v_add_u32 v36, 32768, v34
    v_add_u32 v37, 32768, v35
    ds_read_b64_tr_b16 a[16:17], v36 offset:0
    ds_read_b64_tr_b16 a[18:19], v36 offset:1024
    ds_read_b64_tr_b16 a[20:21], v36 offset:8192
    ds_read_b64_tr_b16 a[22:23], v36 offset:9216
    ds_read_b64_tr_b16 a[80:81], v37 offset:0
    ds_read_b64_tr_b16 a[82:83], v37 offset:1024
    ds_read_b64_tr_b16 a[84:85], v37 offset:8192
    ds_read_b64_tr_b16 a[86:87], v37 offset:9216
    s_waitcnt lgkmcnt(0)
    s_barrier
    s_waitcnt vmcnt(16)
    s_barrier
    v_add_u32 v36, 49152, v34
    v_add_u32 v37, 49152, v35
    ds_read_b64_tr_b16 a[24:25], v36 offset:0
    ds_read_b64_tr_b16 a[26:27], v36 offset:1024
    ds_read_b64_tr_b16 a[28:29], v36 offset:8192
    ds_read_b64_tr_b16 a[30:31], v36 offset:9216
    ds_read_b64_tr_b16 a[88:89], v37 offset:0
    ds_read_b64_tr_b16 a[90:91], v37 offset:1024
    ds_read_b64_tr_b16 a[92:93], v37 offset:8192
    ds_read_b64_tr_b16 a[94:95], v37 offset:9216
    s_waitcnt lgkmcnt(0)
    s_barrier
    s_waitcnt vmcnt(12)
    s_barrier
    v_add_u32 v36, 65536, v34
    v_add_u32 v37, 65536, v35
    ds_read_b64_tr_b16 a[32:33], v36 offset:0
    ds_read_b64_tr_b16 a[34:35], v36 offset:1024
    ds_read_b64_tr_b16 a[36:37], v36 offset:8192
    ds_read_b64_tr_b16 a[38:39], v36 offset:9216
    ds_read_b64_tr_b16 a[96:97], v37 offset:0
    ds_read_b64_tr_b16 a[98:99], v37 offset:1024
    ds_read_b64_tr_b16 a[100:101], v37 offset:8192
    ds_read_b64_tr_b16 a[102:103], v37 offset:9216
    s_waitcnt lgkmcnt(0)
    s_barrier
    s_waitcnt vmcnt(8)
    s_barrier
    v_add_u32 v36, 81920, v34
    v_add_u32 v37, 81920, v35
    ds_read_b64_tr_b16 a[40:41], v36 offset:0
    ds_read_b64_tr_b16 a[42:43], v36 offset:1024
    ds_read_b64_tr_b16 a[44:45], v36 offset:8192
    ds_read_b64_tr_b16 a[46:47], v36 offset:9216
    ds_read_b64_tr_b16 a[104:105], v37 offset:0
    ds_read_b64_tr_b16 a[106:107], v37 offset:1024
    ds_read_b64_tr_b16 a[108:109], v37 offset:8192
    ds_read_b64_tr_b16 a[110:111], v37 offset:9216
    s_waitcnt lgkmcnt(0)
    s_barrier
    s_waitcnt vmcnt(4)
    s_barrier
    v_add_u32 v36, 98304, v34
    v_add_u32 v37, 98304, v35
    ds_read_b64_tr_b16 a[48:49], v36 offset:0
    ds_read_b64_tr_b16 a[50:51], v36 offset:1024
    ds_read_b64_tr_b16 a[52:53], v36 offset:8192
    ds_read_b64_tr_b16 a[54:55], v36 offset:9216
    ds_read_b64_tr_b16 a[112:113], v37 offset:0
    ds_read_b64_tr_b16 a[114:115], v37 offset:1024
    ds_read_b64_tr_b16 a[116:117], v37 offset:8192
    ds_read_b64_tr_b16 a[118:119], v37 offset:9216
    s_waitcnt lgkmcnt(0)
    s_barrier
    s_waitcnt vmcnt(0)
    s_barrier
    v_add_u32 v36, 114688, v34
    v_add_u32 v37, 114688, v35
    ds_read_b64_tr_b16 a[56:57], v36 offset:0
    ds_read_b64_tr_b16 a[58:59], v36 offset:1024
    ds_read_b64_tr_b16 a[60:61], v36 offset:8192
    ds_read_b64_tr_b16 a[62:63], v36 offset:9216
    ds_read_b64_tr_b16 a[120:121], v37 offset:0
    ds_read_b64_tr_b16 a[122:123], v37 offset:1024
    ds_read_b64_tr_b16 a[124:125], v37 offset:8192
    ds_read_b64_tr_b16 a[126:127], v37 offset:9216
    s_waitcnt lgkmcnt(0)
    s_barrier
    s_mov_b32 s20, 0
L_wpw_c0_36:
    s_cmp_eq_u32 s19, 1
    s_cbranch_scc1 L_wpw_c0_36_d
    buffer_load_dword v103, off, s[52:55], 32 sc1
    s_waitcnt vmcnt(0)
    v_readfirstlane_b32 s24, v103
    s_nop 3
    s_cmp_ge_u32 s24, 224
    s_cbranch_scc1 L_wpw_c0_36_d
    s_sleep 4
    s_add_u32 s20, s20, 1
    s_cmp_lt_u32 s20, 524288
    s_cbranch_scc1 L_wpw_c0_36
    s_mov_b32 s19, 1
L_wpw_c0_36_d:
    v_lshlrev_b32 v24, 10, v101
    v_lshl_add_u32 v24, v102, 4, v24
    v_lshlrev_b32_e64 v25, 4, v100
    s_mov_b32 s22, s18
    s_mov_b32 s21, 0
    s_mov_b32 s42, 64
    s_lshl_b32 s25, s22, 15
    s_lshr_b32 s26, s5, 1
    s_lshl_b32 s26, s26, 14
    s_add_u32 s25, s25, s26
    s_and_b32 s26, s5, 1
    s_lshl_b32 s26, s26, 9
    s_add_u32 s25, s25, s26
    s_add_u32 s25, s25, 0
    s_lshl_b32 s24, s5, 13
    s_add_u32 m0, s24, 0
    s_nop 0
    buffer_load_dwordx4 v24, s[8:11], s25 offen lds
    s_add_u32 m0, m0, 1024
    s_add_u32 s25, s25, 64
    s_nop 0
    buffer_load_dwordx4 v24, s[8:11], s25 offen lds
    s_add_u32 m0, m0, 1024
    s_add_u32 s25, s25, 64
    s_nop 0
    buffer_load_dwordx4 v24, s[8:11], s25 offen lds
    s_add_u32 m0, m0, 1024
    s_add_u32 s25, s25, 64
    s_nop 0
    buffer_load_dwordx4 v24, s[8:11], s25 offen lds
    s_add_u32 m0, m0, 1024
    s_add_u32 s25, s25, 64
    s_nop 0
    buffer_load_dwordx4 v24, s[8:11], s25 offen lds
    s_add_u32 m0, m0, 1024
    s_add_u32 s25, s25, 64
    s_nop 0
    buffer_load_dwordx4 v24, s[8:11], s25 offen lds
    s_add_u32 m0, m0, 1024
    s_add_u32 s25, s25, 64
    s_nop 0
    buffer_load_dwordx4 v24, s[8:11], s25 offen lds
    s_add_u32 m0, m0, 1024
    s_add_u32 s25, s25, 64
    s_nop 0
    buffer_load_dwordx4 v24, s[8:11], s25 offen lds
    s_waitcnt vmcnt(0)
L_w1_loop:
    s_waitcnt vmcnt(0)
    s_barrier
    s_cmp_ge_u32 s42, 64
    s_cbranch_scc1 L_w1_noflag_37
    s_cmp_eq_u32 s5, 0
    s_cbranch_scc0 L_w1_noflag_37
    s_lshl_b32 s24, s42, 5
    s_add_u32 s24, s24, s17
    s_lshl_b32 s24, s24, 2
    s_add_u32 s24, s24, 61407232
    v_mov_b32_e64 v26, 1
    buffer_store_dword v26, off, s[8:11], s24 sc1
L_w1_noflag_37:
    s_add_u32 s43, s22, 3
    s_min_u32 s27, s43, 63
    s_mov_b32 s44, s27
    s_lshl_b32 s25, s44, 15
    s_lshr_b32 s26, s5, 1
    s_lshl_b32 s26, s26, 14
    s_add_u32 s25, s25, s26
    s_and_b32 s26, s5, 1
    s_lshl_b32 s26, s26, 9
    s_add_u32 s25, s25, s26
    s_add_u32 s25, s25, 0
    s_lshl_b32 s24, s5, 13
    s_add_u32 m0, s24, 32768
    s_nop 0
    s_nop 0
    buffer_load_dwordx4 v24, s[8:11], s25 offen lds
    s_add_u32 m0, m0, 1024
    s_add_u32 s25, s25, 64
    s_nop 0
    buffer_load_dwordx4 v24, s[8:11], s25 offen lds
    s_add_u32 m0, m0, 1024
    s_add_u32 s25, s25, 64
    s_nop 0
    buffer_load_dwordx4 v24, s[8:11], s25 offen lds
    s_add_u32 m0, m0, 1024
    s_add_u32 s25, s25, 64
    s_nop 0
    buffer_load_dwordx4 v24, s[8:11], s25 offen lds
    s_add_u32 m0, m0, 1024
    s_add_u32 s25, s25, 64
    s_nop 0
    buffer_load_dwordx4 v24, s[8:11], s25 offen lds
    s_add_u32 m0, m0, 1024
    s_add_u32 s25, s25, 64
    s_nop 0
    buffer_load_dwordx4 v24, s[8:11], s25 offen lds
    s_add_u32 m0, m0, 1024
    s_add_u32 s25, s25, 64
    s_nop 0
    buffer_load_dwordx4 v24, s[8:11], s25 offen lds
    s_add_u32 m0, m0, 1024
    s_add_u32 s25, s25, 64
    s_nop 0
    buffer_load_dwordx4 v24, s[8:11], s25 offen lds
    v_mov_b64 v[32:33], 0
    v_mov_b64 v[34:35], 0
    v_mov_b64 v[36:37], 0
    v_mov_b64 v[38:39], 0
    v_mov_b64 v[40:41], 0
    v_mov_b64 v[42:43], 0
    v_mov_b64 v[44:45], 0
    v_mov_b64 v[46:47], 0
    v_mov_b64 v[48:49], 0
    v_mov_b64 v[50:51], 0
    v_mov_b64 v[52:53], 0
    v_mov_b64 v[54:55], 0
    v_mov_b64 v[56:57], 0
    v_mov_b64 v[58:59], 0
    v_mov_b64 v[60:61], 0
    v_mov_b64 v[62:63], 0
    v_mov_b64 v[64:65], 0
    v_mov_b64 v[66:67], 0
    v_mov_b64 v[68:69], 0
    v_mov_b64 v[70:71], 0
    v_mov_b64 v[72:73], 0
    v_mov_b64 v[74:75], 0
    v_mov_b64 v[76:77], 0
    v_mov_b64 v[78:79], 0
    ds_read_b128 v[80:83], v25 offset:0
    ds_read_b128 v[84:87], v25 offset:16384
    ds_read_b128 v[88:91], v25 offset:1024
    ds_read_b128 v[92:95], v25 offset:17408
    s_waitcnt lgkmcnt(2)
    s_nop 0
    v_mfma_f32_16x16x32_bf16 v[32:35], a[0:3], v[80:83], v[32:35]
    v_mfma_f32_16x16x32_bf16 v[36:39], a[0:3], v[84:87], v[36:39]
    v_mfma_f32_16x16x32_bf16 v[40:43], a[64:67], v[80:83], v[40:43]
    v_mfma_f32_16x16x32_bf16 v[44:47], a[64:67], v[84:87], v[44:47]
    v_mfma_f32_16x16x32_bf16 v[48:51], a[128:131], v[80:83], v[48:51]
    v_mfma_f32_16x16x32_bf16 v[52:55], a[128:131], v[84:87], v[52:55]
    v_mfma_f32_16x16x32_bf16 v[56:59], a[192:195], v[80:83], v[56:59]
    v_mfma_f32_16x16x32_bf16 v[60:63], a[192:195], v[84:87], v[60:63]
    v_mfma_f32_16x16x32_bf16 v[64:67], v[80:83], v[128:131], v[64:67]
    v_mfma_f32_16x16x32_bf16 v[68:71], v[84:87], v[128:131], v[68:71]
    v_mfma_f32_16x16x32_bf16 v[72:75], v[80:83], v[192:195], v[72:75]
    v_mfma_f32_16x16x32_bf16 v[76:79], v[84:87], v[192:195], v[76:79]
    ds_read_b128 v[80:83], v25 offset:2048
    ds_read_b128 v[84:87], v25 offset:18432
    s_waitcnt lgkmcnt(2)
    s_nop 0
    v_mfma_f32_16x16x32_bf16 v[32:35], a[4:7], v[88:91], v[32:35]
    v_mfma_f32_16x16x32_bf16 v[36:39], a[4:7], v[92:95], v[36:39]
    v_mfma_f32_16x16x32_bf16 v[40:43], a[68:71], v[88:91], v[40:43]
    v_mfma_f32_16x16x32_bf16 v[44:47], a[68:71], v[92:95], v[44:47]
    v_mfma_f32_16x16x32_bf16 v[48:51], a[132:135], v[88:91], v[48:51]
    v_mfma_f32_16x16x32_bf16 v[52:55], a[132:135], v[92:95], v[52:55]
    v_mfma_f32_16x16x32_bf16 v[56:59], a[196:199], v[88:91], v[56:59]
    v_mfma_f32_16x16x32_bf16 v[60:63], a[196:199], v[92:95], v[60:63]
    v_mfma_f32_16x16x32_bf16 v[64:67], v[88:91], v[132:135], v[64:67]
    v_mfma_f32_16x16x32_bf16 v[68:71], v[92:95], v[132:135], v[68:71]
    v_mfma_f32_16x16x32_bf16 v[72:75], v[88:91], v[196:199], v[72:75]
    v_mfma_f32_16x16x32_bf16 v[76:79], v[92:95], v[196:199], v[76:79]
    ds_read_b128 v[88:91], v25 offset:3072
    ds_read_b128 v[92:95], v25 offset:19456
    s_waitcnt lgkmcnt(2)
    s_nop 0
    v_mfma_f32_16x16x32_bf16 v[32:35], a[8:11], v[80:83], v[32:35]
    v_mfma_f32_16x16x32_bf16 v[36:39], a[8:11], v[84:87], v[36:39]
    v_mfma_f32_16x16x32_bf16 v[40:43], a[72:75], v[80:83], v[40:43]
    v_mfma_f32_16x16x32_bf16 v[44:47], a[72:75], v[84:87], v[44:47]
    v_mfma_f32_16x16x32_bf16 v[48:51], a[136:139], v[80:83], v[48:51]
    v_mfma_f32_16x16x32_bf16 v[52:55], a[136:139], v[84:87], v[52:55]
    v_mfma_f32_16x16x32_bf16 v[56:59], a[200:203], v[80:83], v[56:59]
    v_mfma_f32_16x16x32_bf16 v[60:63], a[200:203], v[84:87], v[60:63]
    v_mfma_f32_16x16x32_bf16 v[64:67], v[80:83], v[136:139], v[64:67]
    v_mfma_f32_16x16x32_bf16 v[68:71], v[84:87], v[136:139], v[68:71]
    v_mfma_f32_16x16x32_bf16 v[72:75], v[80:83], v[200:203], v[72:75]
    v_mfma_f32_16x16x32_bf16 v[76:79], v[84:87], v[200:203], v[76:79]
    ds_read_b128 v[80:83], v25 offset:4096
    ds_read_b128 v[84:87], v25 offset:20480
    s_waitcnt lgkmcnt(2)
    s_nop 0
    v_mfma_f32_16x16x32_bf16 v[32:35], a[12:15], v[88:91], v[32:35]
    v_mfma_f32_16x16x32_bf16 v[36:39], a[12:15], v[92:95], v[36:39]
    v_mfma_f32_16x16x32_bf16 v[40:43], a[76:79], v[88:91], v[40:43]
    v_mfma_f32_16x16x32_bf16 v[44:47], a[76:79], v[92:95], v[44:47]
    v_mfma_f32_16x16x32_bf16 v[48:51], a[140:143], v[88:91], v[48:51]
    v_mfma_f32_16x16x32_bf16 v[52:55], a[140:143], v[92:95], v[52:55]
    v_mfma_f32_16x16x32_bf16 v[56:59], a[204:207], v[88:91], v[56:59]
    v_mfma_f32_16x16x32_bf16 v[60:63], a[204:207], v[92:95], v[60:63]
    v_mfma_f32_16x16x32_bf16 v[64:67], v[88:91], v[140:143], v[64:67]
    v_mfma_f32_16x16x32_bf16 v[68:71], v[92:95], v[140:143], v[68:71]
    v_mfma_f32_16x16x32_bf16 v[72:75], v[88:91], v[204:207], v[72:75]
    v_mfma_f32_16x16x32_bf16 v[76:79], v[92:95], v[204:207], v[76:79]
    ds_read_b128 v[88:91], v25 offset:5120
    ds_read_b128 v[92:95], v25 offset:21504
    s_waitcnt lgkmcnt(2)
    s_nop 0
    v_mfma_f32_16x16x32_bf16 v[32:35], a[16:19], v[80:83], v[32:35]
    v_mfma_f32_16x16x32_bf16 v[36:39], a[16:19], v[84:87], v[36:39]
    v_mfma_f32_16x16x32_bf16 v[40:43], a[80:83], v[80:83], v[40:43]
    v_mfma_f32_16x16x32_bf16 v[44:47], a[80:83], v[84:87], v[44:47]
    v_mfma_f32_16x16x32_bf16 v[48:51], a[144:147], v[80:83], v[48:51]
    v_mfma_f32_16x16x32_bf16 v[52:55], a[144:147], v[84:87], v[52:55]
    v_mfma_f32_16x16x32_bf16 v[56:59], a[208:211], v[80:83], v[56:59]
    v_mfma_f32_16x16x32_bf16 v[60:63], a[208:211], v[84:87], v[60:63]
    v_mfma_f32_16x16x32_bf16 v[64:67], v[80:83], v[144:147], v[64:67]
    v_mfma_f32_16x16x32_bf16 v[68:71], v[84:87], v[144:147], v[68:71]
    v_mfma_f32_16x16x32_bf16 v[72:75], v[80:83], v[208:211], v[72:75]
    v_mfma_f32_16x16x32_bf16 v[76:79], v[84:87], v[208:211], v[76:79]
    ds_read_b128 v[80:83], v25 offset:6144
    ds_read_b128 v[84:87], v25 offset:22528
    s_waitcnt lgkmcnt(2)
    s_nop 0
    v_mfma_f32_16x16x32_bf16 v[32:35], a[20:23], v[88:91], v[32:35]
    v_mfma_f32_16x16x32_bf16 v[36:39], a[20:23], v[92:95], v[36:39]
    v_mfma_f32_16x16x32_bf16 v[40:43], a[84:87], v[88:91], v[40:43]
    v_mfma_f32_16x16x32_bf16 v[44:47], a[84:87], v[92:95], v[44:47]
    v_mfma_f32_16x16x32_bf16 v[48:51], a[148:151], v[88:91], v[48:51]
    v_mfma_f32_16x16x32_bf16 v[52:55], a[148:151], v[92:95], v[52:55]
    v_mfma_f32_16x16x32_bf16 v[56:59], a[212:215], v[88:91], v[56:59]
    v_mfma_f32_16x16x32_bf16 v[60:63], a[212:215], v[92:95], v[60:63]
    v_mfma_f32_16x16x32_bf16 v[64:67], v[88:91], v[148:151], v[64:67]
    v_mfma_f32_16x16x32_bf16 v[68:71], v[92:95], v[148:151], v[68:71]
    v_mfma_f32_16x16x32_bf16 v[72:75], v[88:91], v[212:215], v[72:75]
    v_mfma_f32_16x16x32_bf16 v[76:79], v[92:95], v[212:215], v[76:79]
    ds_read_b128 v[88:91], v25 offset:7168
    ds_read_b128 v[92:95], v25 offset:23552
    s_waitcnt lgkmcnt(2)
    s_nop 0
    v_mfma_f32_16x16x32_bf16 v[32:35], a[24:27], v[80:83], v[32:35]
    v_mfma_f32_16x16x32_bf16 v[36:39], a[24:27], v[84:87], v[36:39]
    v_mfma_f32_16x16x32_bf16 v[40:43], a[88:91], v[80:83], v[40:43]
    v_mfma_f32_16x16x32_bf16 v[44:47], a[88:91], v[84:87], v[44:47]
    v_mfma_f32_16x16x32_bf16 v[48:51], a[152:155], v[80:83], v[48:51]
    v_mfma_f32_16x16x32_bf16 v[52:55], a[152:155], v[84:87], v[52:55]
    v_mfma_f32_16x16x32_bf16 v[56:59], a[216:219], v[80:83], v[56:59]
    v_mfma_f32_16x16x32_bf16 v[60:63], a[216:219], v[84:87], v[60:63]
    v_mfma_f32_16x16x32_bf16 v[64:67], v[80:83], v[152:155], v[64:67]
    v_mfma_f32_16x16x32_bf16 v[68:71], v[84:87], v[152:155], v[68:71]
    v_mfma_f32_16x16x32_bf16 v[72:75], v[80:83], v[216:219], v[72:75]
    v_mfma_f32_16x16x32_bf16 v[76:79], v[84:87], v[216:219], v[76:79]
    ds_read_b128 v[80:83], v25 offset:8192
    ds_read_b128 v[84:87], v25 offset:24576
    s_waitcnt lgkmcnt(2)
    s_nop 0
    v_mfma_f32_16x16x32_bf16 v[32:35], a[28:31], v[88:91], v[32:35]
    v_mfma_f32_16x16x32_bf16 v[36:39], a[28:31], v[92:95], v[36:39]
    v_mfma_f32_16x16x32_bf16 v[40:43], a[92:95], v[88:91], v[40:43]
    v_mfma_f32_16x16x32_bf16 v[44:47], a[92:95], v[92:95], v[44:47]
    v_mfma_f32_16x16x32_bf16 v[48:51], a[156:159], v[88:91], v[48:51]
    v_mfma_f32_16x16x32_bf16 v[52:55], a[156:159], v[92:95], v[52:55]
    v_mfma_f32_16x16x32_bf16 v[56:59], a[220:223], v[88:91], v[56:59]
    v_mfma_f32_16x16x32_bf16 v[60:63], a[220:223], v[92:95], v[60:63]
    v_mfma_f32_16x16x32_bf16 v[64:67], v[88:91], v[156:159], v[64:67]
    v_mfma_f32_16x16x32_bf16 v[68:71], v[92:95], v[156:159], v[68:71]
    v_mfma_f32_16x16x32_bf16 v[72:75], v[88:91], v[220:223], v[72:75]
    v_mfma_f32_16x16x32_bf16 v[76:79], v[92:95], v[220:223], v[76:79]
    ds_read_b128 v[88:91], v25 offset:9216
    ds_read_b128 v[92:95], v25 offset:25600
    s_waitcnt lgkmcnt(2)
    s_nop 0
    v_mfma_f32_16x16x32_bf16 v[32:35], a[32:35], v[80:83], v[32:35]
    v_mfma_f32_16x16x32_bf16 v[36:39], a[32:35], v[84:87], v[36:39]
    v_mfma_f32_16x16x32_bf16 v[40:43], a[96:99], v[80:83], v[40:43]
    v_mfma_f32_16x16x32_bf16 v[44:47], a[96:99], v[84:87], v[44:47]
    v_mfma_f32_16x16x32_bf16 v[48:51], a[160:163], v[80:83], v[48:51]
    v_mfma_f32_16x16x32_bf16 v[52:55], a[160:163], v[84:87], v[52:55]
    v_mfma_f32_16x16x32_bf16 v[56:59], a[224:227], v[80:83], v[56:59]
    v_mfma_f32_16x16x32_bf16 v[60:63], a[224:227], v[84:87], v[60:63]
    v_mfma_f32_16x16x32_bf16 v[64:67], v[80:83], v[160:163], v[64:67]
    v_mfma_f32_16x16x32_bf16 v[68:71], v[84:87], v[160:163], v[68:71]
    v_mfma_f32_16x16x32_bf16 v[72:75], v[80:83], v[224:227], v[72:75]
    v_mfma_f32_16x16x32_bf16 v[76:79], v[84:87], v[224:227], v[76:79]
    ds_read_b128 v[80:83], v25 offset:10240
    ds_read_b128 v[84:87], v25 offset:26624
    s_waitcnt lgkmcnt(2)
    s_nop 0
    v_mfma_f32_16x16x32_bf16 v[32:35], a[36:39], v[88:91], v[32:35]
    v_mfma_f32_16x16x32_bf16 v[36:39], a[36:39], v[92:95], v[36:39]
    v_mfma_f32_16x16x32_bf16 v[40:43], a[100:103], v[88:91], v[40:43]
    v_mfma_f32_16x16x32_bf16 v[44:47], a[100:103], v[92:95], v[44:47]
    v_mfma_f32_16x16x32_bf16 v[48:51], a[164:167], v[88:91], v[48:51]
    v_mfma_f32_16x16x32_bf16 v[52:55], a[164:167], v[92:95], v[52:55]
    v_mfma_f32_16x16x32_bf16 v[56:59], a[228:231], v[88:91], v[56:59]
    v_mfma_f32_16x16x32_bf16 v[60:63], a[228:231], v[92:95], v[60:63]
    v_mfma_f32_16x16x32_bf16 v[64:67], v[88:91], v[164:167], v[64:67]
    v_mfma_f32_16x16x32_bf16 v[68:71], v[92:95], v[164:167], v[68:71]
    v_mfma_f32_16x16x32_bf16 v[72:75], v[88:91], v[228:231], v[72:75]
    v_mfma_f32_16x16x32_bf16 v[76:79], v[92:95], v[228:231], v[76:79]
    ds_read_b128 v[88:91], v25 offset:11264
    ds_read_b128 v[92:95], v25 offset:27648
    s_waitcnt lgkmcnt(2)
    s_nop 0
    v_mfma_f32_16x16x32_bf16 v[32:35], a[40:43], v[80:83], v[32:35]
    v_mfma_f32_16x16x32_bf16 v[36:39], a[40:43], v[84:87], v[36:39]
    v_mfma_f32_16x16x32_bf16 v[40:43], a[104:107], v[80:83], v[40:43]
    v_mfma_f32_16x16x32_bf16 v[44:47], a[104:107], v[84:87], v[44:47]
    v_mfma_f32_16x16x32_bf16 v[48:51], a[168:171], v[80:83], v[48:51]
    v_mfma_f32_16x16x32_bf16 v[52:55], a[168:171], v[84:87], v[52:55]
    v_mfma_f32_16x16x32_bf16 v[56:59], a[232:235], v[80:83], v[56:59]
    v_mfma_f32_16x16x32_bf16 v[60:63], a[232:235], v[84:87], v[60:63]
    v_mfma_f32_16x16x32_bf16 v[64:67], v[80:83], v[168:171], v[64:67]
    v_mfma_f32_16x16x32_bf16 v[68:71], v[84:87], v[168:171], v[68:71]
    v_mfma_f32_16x16x32_bf16 v[72:75], v[80:83], v[232:235], v[72:75]
    v_mfma_f32_16x16x32_bf16 v[76:79], v[84:87], v[232:235], v[76:79]
    ds_read_b128 v[80:83], v25 offset:12288
    ds_read_b128 v[84:87], v25 offset:28672
    s_waitcnt lgkmcnt(2)
    s_nop 0
    v_mfma_f32_16x16x32_bf16 v[32:35], a[44:47], v[88:91], v[32:35]
    v_mfma_f32_16x16x32_bf16 v[36:39], a[44:47], v[92:95], v[36:39]
    v_mfma_f32_16x16x32_bf16 v[40:43], a[108:111], v[88:91], v[40:43]
    v_mfma_f32_16x16x32_bf16 v[44:47], a[108:111], v[92:95], v[44:47]
    v_mfma_f32_16x16x32_bf16 v[48:51], a[172:175], v[88:91], v[48:51]
    v_mfma_f32_16x16x32_bf16 v[52:55], a[172:175], v[92:95], v[52:55]
    v_mfma_f32_16x16x32_bf16 v[56:59], a[236:239], v[88:91], v[56:59]
    v_mfma_f32_16x16x32_bf16 v[60:63], a[236:239], v[92:95], v[60:63]
    v_mfma_f32_16x16x32_bf16 v[64:67], v[88:91], v[172:175], v[64:67]
    v_mfma_f32_16x16x32_bf16 v[68:71], v[92:95], v[172:175], v[68:71]
    v_mfma_f32_16x16x32_bf16 v[72:75], v[88:91], v[236:239], v[72:75]
    v_mfma_f32_16x16x32_bf16 v[76:79], v[92:95], v[236:239], v[76:79]
    ds_read_b128 v[88:91], v25 offset:13312
    ds_read_b128 v[92:95], v25 offset:29696
    s_waitcnt lgkmcnt(2)
    s_nop 0
    v_mfma_f32_16x16x32_bf16 v[32:35], a[48:51], v[80:83], v[32:35]
    v_mfma_f32_16x16x32_bf16 v[36:39], a[48:51], v[84:87], v[36:39]
    v_mfma_f32_16x16x32_bf16 v[40:43], a[112:115], v[80:83], v[40:43]
    v_mfma_f32_16x16x32_bf16 v[44:47], a[112:115], v[84:87], v[44:47]
    v_mfma_f32_16x16x32_bf16 v[48:51], a[176:179], v[80:83], v[48:51]
    v_mfma_f32_16x16x32_bf16 v[52:55], a[176:179], v[84:87], v[52:55]
    v_mfma_f32_16x16x32_bf16 v[56:59], a[240:243], v[80:83], v[56:59]
    v_mfma_f32_16x16x32_bf16 v[60:63], a[240:243], v[84:87], v[60:63]
    v_mfma_f32_16x16x32_bf16 v[64:67], v[80:83], v[176:179], v[64:67]
    v_mfma_f32_16x16x32_bf16 v[68:71], v[84:87], v[176:179], v[68:71]
    v_mfma_f32_16x16x32_bf16 v[72:75], v[80:83], v[240:243], v[72:75]
    v_mfma_f32_16x16x32_bf16 v[76:79], v[84:87], v[240:243], v[76:79]
    ds_read_b128 v[80:83], v25 offset:14336
    ds_read_b128 v[84:87], v25 offset:30720
    s_waitcnt lgkmcnt(2)
    s_nop 0
    v_mfma_f32_16x16x32_bf16 v[32:35], a[52:55], v[88:91], v[32:35]
    v_mfma_f32_16x16x32_bf16 v[36:39], a[52:55], v[92:95], v[36:39]
    v_mfma_f32_16x16x32_bf16 v[40:43], a[116:119], v[88:91], v[40:43]
    v_mfma_f32_16x16x32_bf16 v[44:47], a[116:119], v[92:95], v[44:47]
    v_mfma_f32_16x16x32_bf16 v[48:51], a[180:183], v[88:91], v[48:51]
    v_mfma_f32_16x16x32_bf16 v[52:55], a[180:183], v[92:95], v[52:55]
    v_mfma_f32_16x16x32_bf16 v[56:59], a[244:247], v[88:91], v[56:59]
    v_mfma_f32_16x16x32_bf16 v[60:63], a[244:247], v[92:95], v[60:63]
    v_mfma_f32_16x16x32_bf16 v[64:67], v[88:91], v[180:183], v[64:67]
    v_mfma_f32_16x16x32_bf16 v[68:71], v[92:95], v[180:183], v[68:71]
    v_mfma_f32_16x16x32_bf16 v[72:75], v[88:91], v[244:247], v[72:75]
    v_mfma_f32_16x16x32_bf16 v[76:79], v[92:95], v[244:247], v[76:79]
    ds_read_b128 v[88:91], v25 offset:15360
    ds_read_b128 v[92:95], v25 offset:31744
    s_waitcnt lgkmcnt(2)
    s_nop 0
    v_mfma_f32_16x16x32_bf16 v[32:35], a[56:59], v[80:83], v[32:35]
    v_mfma_f32_16x16x32_bf16 v[36:39], a[56:59], v[84:87], v[36:39]
    v_mfma_f32_16x16x32_bf16 v[40:43], a[120:123], v[80:83], v[40:43]
    v_mfma_f32_16x16x32_bf16 v[44:47], a[120:123], v[84:87], v[44:47]
    v_mfma_f32_16x16x32_bf16 v[48:51], a[184:187], v[80:83], v[48:51]
    v_mfma_f32_16x16x32_bf16 v[52:55], a[184:187], v[84:87], v[52:55]
    v_mfma_f32_16x16x32_bf16 v[56:59], a[248:251], v[80:83], v[56:59]
    v_mfma_f32_16x16x32_bf16 v[60:63], a[248:251], v[84:87], v[60:63]
    v_mfma_f32_16x16x32_bf16 v[64:67], v[80:83], v[184:187], v[64:67]
    v_mfma_f32_16x16x32_bf16 v[68:71], v[84:87], v[184:187], v[68:71]
    v_mfma_f32_16x16x32_bf16 v[72:75], v[80:83], v[248:251], v[72:75]
    v_mfma_f32_16x16x32_bf16 v[76:79], v[84:87], v[248:251], v[76:79]
    s_waitcnt lgkmcnt(0)
    s_nop 0
    v_mfma_f32_16x16x32_bf16 v[32:35], a[60:63], v[88:91], v[32:35]
    v_mfma_f32_16x16x32_bf16 v[36:39], a[60:63], v[92:95], v[36:39]
    v_mfma_f32_16x16x32_bf16 v[40:43], a[124:127], v[88:91], v[40:43]
    v_mfma_f32_16x16x32_bf16 v[44:47], a[124:127], v[92:95], v[44:47]
    v_mfma_f32_16x16x32_bf16 v[48:51], a[188:191], v[88:91], v[48:51]
    v_mfma_f32_16x16x32_bf16 v[52:55], a[188:191], v[92:95], v[52:55]
    v_mfma_f32_16x16x32_bf16 v[56:59], a[252:255], v[88:91], v[56:59]
    v_mfma_f32_16x16x32_bf16 v[60:63], a[252:255], v[92:95], v[60:63]
    v_mfma_f32_16x16x32_bf16 v[64:67], v[88:91], v[188:191], v[64:67]
    v_mfma_f32_16x16x32_bf16 v[68:71], v[92:95], v[188:191], v[68:71]
    v_mfma_f32_16x16x32_bf16 v[72:75], v[88:91], v[252:255], v[72:75]
    v_mfma_f32_16x16x32_bf16 v[76:79], v[92:95], v[252:255], v[76:79]
    s_nop 7
    s_nop 0
    v_cvt_pk_bf16_f32 v96, v32, v33
    v_cvt_pk_bf16_f32 v97, v34, v35
    v_cvt_pk_bf16_f32 v98, v40, v41
    v_cvt_pk_bf16_f32 v99, v42, v43
    v_cvt_pk_bf16_f32 v100, v36, v37
    v_cvt_pk_bf16_f32 v101, v38, v39
    v_cvt_pk_bf16_f32 v102, v44, v45
    v_cvt_pk_bf16_f32 v103, v46, v47
    v_cvt_pk_bf16_f32 v104, v48, v49
    v_cvt_pk_bf16_f32 v105, v50, v51
    v_cvt_pk_bf16_f32 v106, v56, v57
    v_cvt_pk_bf16_f32 v107, v58, v59
    v_cvt_pk_bf16_f32 v108, v52, v53
    v_cvt_pk_bf16_f32 v109, v54, v55
    v_cvt_pk_bf16_f32 v110, v60, v61
    v_cvt_pk_bf16_f32 v111, v62, v63
    v_cvt_pk_bf16_f32 v112, v64, v65
    v_cvt_pk_bf16_f32 v113, v66, v67
    v_cvt_pk_bf16_f32 v114, v68, v69
    v_cvt_pk_bf16_f32 v115, v70, v71
    v_cvt_pk_bf16_f32 v116, v72, v73
    v_cvt_pk_bf16_f32 v117, v74, v75
    v_cvt_pk_bf16_f32 v118, v76, v77
    v_cvt_pk_bf16_f32 v119, v78, v79
    s_lshl_b32 s24, s22, 5
    s_add_u32 s24, s24, s17
    s_lshl_b32 s24, s24, 13
    s_lshl_b32 s25, s5, 10
    s_add_u32 s25, s25, s24
    s_nop 0
    s_add_u32 s26, s25, 2097152
    buffer_store_dwordx4 v[96:99], v25, s[8:11], s26 offen sc1
    s_add_u32 s26, s25, 2101248
    buffer_store_dwordx4 v[100:103], v25, s[8:11], s26 offen sc1
    s_add_u32 s26, s25, 18874368
    buffer_store_dwordx4 v[104:107], v25, s[8:11], s26 offen sc1
    s_add_u32 s26, s25, 18878464
    buffer_store_dwordx4 v[108:111], v25, s[8:11], s26 offen sc1
    s_lshl_b32 s25, s5, 11
    s_add_u32 s25, s25, s24
    s_add_u32 s26, s25, 35651584
    buffer_store_dwordx4 v[112:115], v25, s[8:11], s26 offen sc1
    s_add_u32 s26, s25, 35652608
    buffer_store_dwordx4 v[116:119], v25, s[8:11], s26 offen sc1
    s_mov_b32 s42, s22
    s_mov_b32 s22, s43
    s_cmp_ge_u32 s22, 64
    s_cbranch_scc1 L_w1_done
    s_waitcnt vmcnt(0)
    s_barrier
    s_cmp_ge_u32 s42, 64
    s_cbranch_scc1 L_w1_noflag_39
    s_cmp_eq_u32 s5, 0
    s_cbranch_scc0 L_w1_noflag_39
    s_lshl_b32 s24, s42, 5
    s_add_u32 s24, s24, s17
    s_lshl_b32 s24, s24, 2
    s_add_u32 s24, s24, 61407232
    v_mov_b32 v26, 1
    buffer_store_dword v26, off, s[8:11], s24 sc1
L_w1_noflag_39:
    s_add_u32 s43, s22, 3
    s_min_u32 s27, s43, 63
    s_mov_b32 s44, s27
    s_lshl_b32 s25, s44, 15
    s_lshr_b32 s26, s5, 1
    s_lshl_b32 s26, s26, 14
    s_add_u32 s25, s25, s26
    s_and_b32 s26, s5, 1
    s_lshl_b32 s26, s26, 9
    s_add_u32 s25, s25, s26
    s_add_u32 s25, s25, 0
    s_lshl_b32 s24, s5, 13
    s_add_u32 m0, s24, 0
    s_nop 0
    buffer_load_dwordx4 v24, s[8:11], s25 offen lds
    s_add_u32 m0, m0, 1024
    s_add_u32 s25, s25, 64
    s_nop 0
    buffer_load_dwordx4 v24, s[8:11], s25 offen lds
    s_add_u32 m0, m0, 1024
    s_add_u32 s25, s25, 64
    s_nop 0
    buffer_load_dwordx4 v24, s[8:11], s25 offen lds
    s_add_u32 m0, m0, 1024
    s_add_u32 s25, s25, 64
    s_nop 0
    buffer_load_dwordx4 v24, s[8:11], s25 offen lds
    s_add_u32 m0, m0, 1024
    s_add_u32 s25, s25, 64
    s_nop 0
    buffer_load_dwordx4 v24, s[8:11], s25 offen lds
    s_add_u32 m0, m0, 1024
    s_add_u32 s25, s25, 64
    s_nop 0
    buffer_load_dwordx4 v24, s[8:11], s25 offen lds
    s_add_u32 m0, m0, 1024
    s_add_u32 s25, s25, 64
    s_nop 0
    buffer_load_dwordx4 v24, s[8:11], s25 offen lds
    s_add_u32 m0, m0, 1024
    s_add_u32 s25, s25, 64
    s_nop 0
    buffer_load_dwordx4 v24, s[8:11], s25 offen lds
    v_mov_b64 v[32:33], 0
    v_mov_b64 v[34:35], 0
    v_mov_b64 v[36:37], 0
    v_mov_b64 v[38:39], 0
    v_mov_b64 v[40:41], 0
    v_mov_b64 v[42:43], 0
    v_mov_b64 v[44:45], 0
    v_mov_b64 v[46:47], 0
    v_mov_b64 v[48:49], 0
    v_mov_b64 v[50:51], 0
    v_mov_b64 v[52:53], 0
    v_mov_b64 v[54:55], 0
    v_mov_b64 v[56:57], 0
    v_mov_b64 v[58:59], 0
    v_mov_b64 v[60:61], 0
    v_mov_b64 v[62:63], 0
    v_mov_b64 v[64:65], 0
    v_mov_b64 v[66:67], 0
    v_mov_b64 v[68:69], 0
    v_mov_b64 v[70:71], 0
    v_mov_b64 v[72:73], 0
    v_mov_b64 v[74:75], 0
    v_mov_b64 v[76:77], 0
    v_mov_b64 v[78:79], 0
    ds_read_b128 v[80:83], v25 offset:32768
    ds_read_b128 v[84:87], v25 offset:49152
    ds_read_b128 v[88:91], v25 offset:33792
    ds_read_b128 v[92:95], v25 offset:50176
    s_waitcnt lgkmcnt(2)
    s_nop 0
    v_mfma_f32_16x16x32_bf16 v[32:35], a[0:3], v[80:83], v[32:35]
    v_mfma_f32_16x16x32_bf16 v[36:39], a[0:3], v[84:87], v[36:39]
    v_mfma_f32_16x16x32_bf16 v[40:43], a[64:67], v[80:83], v[40:43]
    v_mfma_f32_16x16x32_bf16 v[44:47], a[64:67], v[84:87], v[44:47]
    v_mfma_f32_16x16x32_bf16 v[48:51], a[128:131], v[80:83], v[48:51]
    v_mfma_f32_16x16x32_bf16 v[52:55], a[128:131], v[84:87], v[52:55]
    v_mfma_f32_16x16x32_bf16 v[56:59], a[192:195], v[80:83], v[56:59]
    v_mfma_f32_16x16x32_bf16 v[60:63], a[192:195], v[84:87], v[60:63]
    v_mfma_f32_16x16x32_bf16 v[64:67], v[80:83], v[128:131], v[64:67]
    v_mfma_f32_16x16x32_bf16 v[68:71], v[84:87], v[128:131], v[68:71]
    v_mfma_f32_16x16x32_bf16 v[72:75], v[80:83], v[192:195], v[72:75]
    v_mfma_f32_16x16x32_bf16 v[76:79], v[84:87], v[192:195], v[76:79]
    ds_read_b128 v[80:83], v25 offset:34816
    ds_read_b128 v[84:87], v25 offset:51200
    s_waitcnt lgkmcnt(2)
    s_nop 0
    v_mfma_f32_16x16x32_bf16 v[32:35], a[4:7], v[88:91], v[32:35]
    v_mfma_f32_16x16x32_bf16 v[36:39], a[4:7], v[92:95], v[36:39]
    v_mfma_f32_16x16x32_bf16 v[40:43], a[68:71], v[88:91], v[40:43]
    v_mfma_f32_16x16x32_bf16 v[44:47], a[68:71], v[92:95], v[44:47]
    v_mfma_f32_16x16x32_bf16 v[48:51], a[132:135], v[88:91], v[48:51]
    v_mfma_f32_16x16x32_bf16 v[52:55], a[132:135], v[92:95], v[52:55]
    v_mfma_f32_16x16x32_bf16 v[56:59], a[196:199], v[88:91], v[56:59]
    v_mfma_f32_16x16x32_bf16 v[60:63], a[196:199], v[92:95], v[60:63]
    v_mfma_f32_16x16x32_bf16 v[64:67], v[88:91], v[132:135], v[64:67]
    v_mfma_f32_16x16x32_bf16 v[68:71], v[92:95], v[132:135], v[68:71]
    v_mfma_f32_16x16x32_bf16 v[72:75], v[88:91], v[196:199], v[72:75]
    v_mfma_f32_16x16x32_bf16 v[76:79], v[92:95], v[196:199], v[76:79]
    ds_read_b128 v[88:91], v25 offset:35840
    ds_read_b128 v[92:95], v25 offset:52224
    s_waitcnt lgkmcnt(2)
    s_nop 0
    v_mfma_f32_16x16x32_bf16 v[32:35], a[8:11], v[80:83], v[32:35]
    v_mfma_f32_16x16x32_bf16 v[36:39], a[8:11], v[84:87], v[36:39]
    v_mfma_f32_16x16x32_bf16 v[40:43], a[72:75], v[80:83], v[40:43]
    v_mfma_f32_16x16x32_bf16 v[44:47], a[72:75], v[84:87], v[44:47]
    v_mfma_f32_16x16x32_bf16 v[48:51], a[136:139], v[80:83], v[48:51]
    v_mfma_f32_16x16x32_bf16 v[52:55], a[136:139], v[84:87], v[52:55]
    v_mfma_f32_16x16x32_bf16 v[56:59], a[200:203], v[80:83], v[56:59]
    v_mfma_f32_16x16x32_bf16 v[60:63], a[200:203], v[84:87], v[60:63]
    v_mfma_f32_16x16x32_bf16 v[64:67], v[80:83], v[136:139], v[64:67]
    v_mfma_f32_16x16x32_bf16 v[68:71], v[84:87], v[136:139], v[68:71]
    v_mfma_f32_16x16x32_bf16 v[72:75], v[80:83], v[200:203], v[72:75]
    v_mfma_f32_16x16x32_bf16 v[76:79], v[84:87], v[200:203], v[76:79]
    ds_read_b128 v[80:83], v25 offset:36864
    ds_read_b128 v[84:87], v25 offset:53248
    s_waitcnt lgkmcnt(2)
    s_nop 0
    v_mfma_f32_16x16x32_bf16 v[32:35], a[12:15], v[88:91], v[32:35]
    v_mfma_f32_16x16x32_bf16 v[36:39], a[12:15], v[92:95], v[36:39]
    v_mfma_f32_16x16x32_bf16 v[40:43], a[76:79], v[88:91], v[40:43]
    v_mfma_f32_16x16x32_bf16 v[44:47], a[76:79], v[92:95], v[44:47]
    v_mfma_f32_16x16x32_bf16 v[48:51], a[140:143], v[88:91], v[48:51]
    v_mfma_f32_16x16x32_bf16 v[52:55], a[140:143], v[92:95], v[52:55]
    v_mfma_f32_16x16x32_bf16 v[56:59], a[204:207], v[88:91], v[56:59]
    v_mfma_f32_16x16x32_bf16 v[60:63], a[204:207], v[92:95], v[60:63]
    v_mfma_f32_16x16x32_bf16 v[64:67], v[88:91], v[140:143], v[64:67]
    v_mfma_f32_16x16x32_bf16 v[68:71], v[92:95], v[140:143], v[68:71]
    v_mfma_f32_16x16x32_bf16 v[72:75], v[88:91], v[204:207], v[72:75]
    v_mfma_f32_16x16x32_bf16 v[76:79], v[92:95], v[204:207], v[76:79]
    ds_read_b128 v[88:91], v25 offset:37888
    ds_read_b128 v[92:95], v25 offset:54272
    s_waitcnt lgkmcnt(2)
    s_nop 0
    v_mfma_f32_16x16x32_bf16 v[32:35], a[16:19], v[80:83], v[32:35]
    v_mfma_f32_16x16x32_bf16 v[36:39], a[16:19], v[84:87], v[36:39]
    v_mfma_f32_16x16x32_bf16 v[40:43], a[80:83], v[80:83], v[40:43]
    v_mfma_f32_16x16x32_bf16 v[44:47], a[80:83], v[84:87], v[44:47]
    v_mfma_f32_16x16x32_bf16 v[48:51], a[144:147], v[80:83], v[48:51]
    v_mfma_f32_16x16x32_bf16 v[52:55], a[144:147], v[84:87], v[52:55]
    v_mfma_f32_16x16x32_bf16 v[56:59], a[208:211], v[80:83], v[56:59]
    v_mfma_f32_16x16x32_bf16 v[60:63], a[208:211], v[84:87], v[60:63]
    v_mfma_f32_16x16x32_bf16 v[64:67], v[80:83], v[144:147], v[64:67]
    v_mfma_f32_16x16x32_bf16 v[68:71], v[84:87], v[144:147], v[68:71]
    v_mfma_f32_16x16x32_bf16 v[72:75], v[80:83], v[208:211], v[72:75]
    v_mfma_f32_16x16x32_bf16 v[76:79], v[84:87], v[208:211], v[76:79]
    ds_read_b128 v[80:83], v25 offset:38912
    ds_read_b128 v[84:87], v25 offset:55296
    s_waitcnt lgkmcnt(2)
    s_nop 0
    v_mfma_f32_16x16x32_bf16 v[32:35], a[20:23], v[88:91], v[32:35]
    v_mfma_f32_16x16x32_bf16 v[36:39], a[20:23], v[92:95], v[36:39]
    v_mfma_f32_16x16x32_bf16 v[40:43], a[84:87], v[88:91], v[40:43]
    v_mfma_f32_16x16x32_bf16 v[44:47], a[84:87], v[92:95], v[44:47]
    v_mfma_f32_16x16x32_bf16 v[48:51], a[148:151], v[88:91], v[48:51]
    v_mfma_f32_16x16x32_bf16 v[52:55], a[148:151], v[92:95], v[52:55]
    v_mfma_f32_16x16x32_bf16 v[56:59], a[212:215], v[88:91], v[56:59]
    v_mfma_f32_16x16x32_bf16 v[60:63], a[212:215], v[92:95], v[60:63]
    v_mfma_f32_16x16x32_bf16 v[64:67], v[88:91], v[148:151], v[64:67]
    v_mfma_f32_16x16x32_bf16 v[68:71], v[92:95], v[148:151], v[68:71]
    v_mfma_f32_16x16x32_bf16 v[72:75], v[88:91], v[212:215], v[72:75]
    v_mfma_f32_16x16x32_bf16 v[76:79], v[92:95], v[212:215], v[76:79]
    ds_read_b128 v[88:91], v25 offset:39936
    ds_read_b128 v[92:95], v25 offset:56320
    s_waitcnt lgkmcnt(2)
    s_nop 0
    v_mfma_f32_16x16x32_bf16 v[32:35], a[24:27], v[80:83], v[32:35]
    v_mfma_f32_16x16x32_bf16 v[36:39], a[24:27], v[84:87], v[36:39]
    v_mfma_f32_16x16x32_bf16 v[40:43], a[88:91], v[80:83], v[40:43]
    v_mfma_f32_16x16x32_bf16 v[44:47], a[88:91], v[84:87], v[44:47]
    v_mfma_f32_16x16x32_bf16 v[48:51], a[152:155], v[80:83], v[48:51]
    v_mfma_f32_16x16x32_bf16 v[52:55], a[152:155], v[84:87], v[52:55]
    v_mfma_f32_16x16x32_bf16 v[56:59], a[216:219], v[80:83], v[56:59]
    v_mfma_f32_16x16x32_bf16 v[60:63], a[216:219], v[84:87], v[60:63]
    v_mfma_f32_16x16x32_bf16 v[64:67], v[80:83], v[152:155], v[64:67]
    v_mfma_f32_16x16x32_bf16 v[68:71], v[84:87], v[152:155], v[68:71]
    v_mfma_f32_16x16x32_bf16 v[72:75], v[80:83], v[216:219], v[72:75]
    v_mfma_f32_16x16x32_bf16 v[76:79], v[84:87], v[216:219], v[76:79]
    ds_read_b128 v[80:83], v25 offset:40960
    ds_read_b128 v[84:87], v25 offset:57344
    s_waitcnt lgkmcnt(2)
    s_nop 0
    v_mfma_f32_16x16x32_bf16 v[32:35], a[28:31], v[88:91], v[32:35]
    v_mfma_f32_16x16x32_bf16 v[36:39], a[28:31], v[92:95], v[36:39]
    v_mfma_f32_16x16x32_bf16 v[40:43], a[92:95], v[88:91], v[40:43]
    v_mfma_f32_16x16x32_bf16 v[44:47], a[92:95], v[92:95], v[44:47]
    v_mfma_f32_16x16x32_bf16 v[48:51], a[156:159], v[88:91], v[48:51]
    v_mfma_f32_16x16x32_bf16 v[52:55], a[156:159], v[92:95], v[52:55]
    v_mfma_f32_16x16x32_bf16 v[56:59], a[220:223], v[88:91], v[56:59]
    v_mfma_f32_16x16x32_bf16 v[60:63], a[220:223], v[92:95], v[60:63]
    v_mfma_f32_16x16x32_bf16 v[64:67], v[88:91], v[156:159], v[64:67]
    v_mfma_f32_16x16x32_bf16 v[68:71], v[92:95], v[156:159], v[68:71]
    v_mfma_f32_16x16x32_bf16 v[72:75], v[88:91], v[220:223], v[72:75]
    v_mfma_f32_16x16x32_bf16 v[76:79], v[92:95], v[220:223], v[76:79]
    ds_read_b128 v[88:91], v25 offset:41984
    ds_read_b128 v[92:95], v25 offset:58368
    s_waitcnt lgkmcnt(2)
    s_nop 0
    v_mfma_f32_16x16x32_bf16 v[32:35], a[32:35], v[80:83], v[32:35]
    v_mfma_f32_16x16x32_bf16 v[36:39], a[32:35], v[84:87], v[36:39]
    v_mfma_f32_16x16x32_bf16 v[40:43], a[96:99], v[80:83], v[40:43]
    v_mfma_f32_16x16x32_bf16 v[44:47], a[96:99], v[84:87], v[44:47]
    v_mfma_f32_16x16x32_bf16 v[48:51], a[160:163], v[80:83], v[48:51]
    v_mfma_f32_16x16x32_bf16 v[52:55], a[160:163], v[84:87], v[52:55]
    v_mfma_f32_16x16x32_bf16 v[56:59], a[224:227], v[80:83], v[56:59]
    v_mfma_f32_16x16x32_bf16 v[60:63], a[224:227], v[84:87], v[60:63]
    v_mfma_f32_16x16x32_bf16 v[64:67], v[80:83], v[160:163], v[64:67]
    v_mfma_f32_16x16x32_bf16 v[68:71], v[84:87], v[160:163], v[68:71]
    v_mfma_f32_16x16x32_bf16 v[72:75], v[80:83], v[224:227], v[72:75]
    v_mfma_f32_16x16x32_bf16 v[76:79], v[84:87], v[224:227], v[76:79]
    ds_read_b128 v[80:83], v25 offset:43008
    ds_read_b128 v[84:87], v25 offset:59392
    s_waitcnt lgkmcnt(2)
    s_nop 0
    v_mfma_f32_16x16x32_bf16 v[32:35], a[36:39], v[88:91], v[32:35]
    v_mfma_f32_16x16x32_bf16 v[36:39], a[36:39], v[92:95], v[36:39]
    v_mfma_f32_16x16x32_bf16 v[40:43], a[100:103], v[88:91], v[40:43]
    v_mfma_f32_16x16x32_bf16 v[44:47], a[100:103], v[92:95], v[44:47]
    v_mfma_f32_16x16x32_bf16 v[48:51], a[164:167], v[88:91], v[48:51]
    v_mfma_f32_16x16x32_bf16 v[52:55], a[164:167], v[92:95], v[52:55]
    v_mfma_f32_16x16x32_bf16 v[56:59], a[228:231], v[88:91], v[56:59]
    v_mfma_f32_16x16x32_bf16 v[60:63], a[228:231], v[92:95], v[60:63]
    v_mfma_f32_16x16x32_bf16 v[64:67], v[88:91], v[164:167], v[64:67]
    v_mfma_f32_16x16x32_bf16 v[68:71], v[92:95], v[164:167], v[68:71]
    v_mfma_f32_16x16x32_bf16 v[72:75], v[88:91], v[228:231], v[72:75]
    v_mfma_f32_16x16x32_bf16 v[76:79], v[92:95], v[228:231], v[76:79]
    ds_read_b128 v[88:91], v25 offset:44032
    ds_read_b128 v[92:95], v25 offset:60416
    s_waitcnt lgkmcnt(2)
    s_nop 0
    v_mfma_f32_16x16x32_bf16 v[32:35], a[40:43], v[80:83], v[32:35]
    v_mfma_f32_16x16x32_bf16 v[36:39], a[40:43], v[84:87], v[36:39]
    v_mfma_f32_16x16x32_bf16 v[40:43], a[104:107], v[80:83], v[40:43]
    v_mfma_f32_16x16x32_bf16 v[44:47], a[104:107], v[84:87], v[44:47]
    v_mfma_f32_16x16x32_bf16 v[48:51], a[168:171], v[80:83], v[48:51]
    v_mfma_f32_16x16x32_bf16 v[52:55], a[168:171], v[84:87], v[52:55]
    v_mfma_f32_16x16x32_bf16 v[56:59], a[232:235], v[80:83], v[56:59]
    v_mfma_f32_16x16x32_bf16 v[60:63], a[232:235], v[84:87], v[60:63]
    v_mfma_f32_16x16x32_bf16 v[64:67], v[80:83], v[168:171], v[64:67]
    v_mfma_f32_16x16x32_bf16 v[68:71], v[84:87], v[168:171], v[68:71]
    v_mfma_f32_16x16x32_bf16 v[72:75], v[80:83], v[232:235], v[72:75]
    v_mfma_f32_16x16x32_bf16 v[76:79], v[84:87], v[232:235], v[76:79]
    ds_read_b128 v[80:83], v25 offset:45056
    ds_read_b128 v[84:87], v25 offset:61440
    s_waitcnt lgkmcnt(2)
    s_nop 0
    v_mfma_f32_16x16x32_bf16 v[32:35], a[44:47], v[88:91], v[32:35]
    v_mfma_f32_16x16x32_bf16 v[36:39], a[44:47], v[92:95], v[36:39]
    v_mfma_f32_16x16x32_bf16 v[40:43], a[108:111], v[88:91], v[40:43]
    v_mfma_f32_16x16x32_bf16 v[44:47], a[108:111], v[92:95], v[44:47]
    v_mfma_f32_16x16x32_bf16 v[48:51], a[172:175], v[88:91], v[48:51]
    v_mfma_f32_16x16x32_bf16 v[52:55], a[172:175], v[92:95], v[52:55]
    v_mfma_f32_16x16x32_bf16 v[56:59], a[236:239], v[88:91], v[56:59]
    v_mfma_f32_16x16x32_bf16 v[60:63], a[236:239], v[92:95], v[60:63]
    v_mfma_f32_16x16x32_bf16 v[64:67], v[88:91], v[172:175], v[64:67]
    v_mfma_f32_16x16x32_bf16 v[68:71], v[92:95], v[172:175], v[68:71]
    v_mfma_f32_16x16x32_bf16 v[72:75], v[88:91], v[236:239], v[72:75]
    v_mfma_f32_16x16x32_bf16 v[76:79], v[92:95], v[236:239], v[76:79]
    ds_read_b128 v[88:91], v25 offset:46080
    ds_read_b128 v[92:95], v25 offset:62464
    s_waitcnt lgkmcnt(2)
    s_nop 0
    v_mfma_f32_16x16x32_bf16 v[32:35], a[48:51], v[80:83], v[32:35]
    v_mfma_f32_16x16x32_bf16 v[36:39], a[48:51], v[84:87], v[36:39]
    v_mfma_f32_16x16x32_bf16 v[40:43], a[112:115], v[80:83], v[40:43]
    v_mfma_f32_16x16x32_bf16 v[44:47], a[112:115], v[84:87], v[44:47]
    v_mfma_f32_16x16x32_bf16 v[48:51], a[176:179], v[80:83], v[48:51]
    v_mfma_f32_16x16x32_bf16 v[52:55], a[176:179], v[84:87], v[52:55]
    v_mfma_f32_16x16x32_bf16 v[56:59], a[240:243], v[80:83], v[56:59]
    v_mfma_f32_16x16x32_bf16 v[60:63], a[240:243], v[84:87], v[60:63]
    v_mfma_f32_16x16x32_bf16 v[64:67], v[80:83], v[176:179], v[64:67]
    v_mfma_f32_16x16x32_bf16 v[68:71], v[84:87], v[176:179], v[68:71]
    v_mfma_f32_16x16x32_bf16 v[72:75], v[80:83], v[240:243], v[72:75]
    v_mfma_f32_16x16x32_bf16 v[76:79], v[84:87], v[240:243], v[76:79]
    ds_read_b128 v[80:83], v25 offset:47104
    ds_read_b128 v[84:87], v25 offset:63488
    s_waitcnt lgkmcnt(2)
    s_nop 0
    v_mfma_f32_16x16x32_bf16 v[32:35], a[52:55], v[88:91], v[32:35]
    v_mfma_f32_16x16x32_bf16 v[36:39], a[52:55], v[92:95], v[36:39]
    v_mfma_f32_16x16x32_bf16 v[40:43], a[116:119], v[88:91], v[40:43]
    v_mfma_f32_16x16x32_bf16 v[44:47], a[116:119], v[92:95], v[44:47]
    v_mfma_f32_16x16x32_bf16 v[48:51], a[180:183], v[88:91], v[48:51]
    v_mfma_f32_16x16x32_bf16 v[52:55], a[180:183], v[92:95], v[52:55]
    v_mfma_f32_16x16x32_bf16 v[56:59], a[244:247], v[88:91], v[56:59]
    v_mfma_f32_16x16x32_bf16 v[60:63], a[244:247], v[92:95], v[60:63]
    v_mfma_f32_16x16x32_bf16 v[64:67], v[88:91], v[180:183], v[64:67]
    v_mfma_f32_16x16x32_bf16 v[68:71], v[92:95], v[180:183], v[68:71]
    v_mfma_f32_16x16x32_bf16 v[72:75], v[88:91], v[244:247], v[72:75]
    v_mfma_f32_16x16x32_bf16 v[76:79], v[92:95], v[244:247], v[76:79]
    ds_read_b128 v[88:91], v25 offset:48128
    ds_read_b128 v[92:95], v25 offset:64512
    s_waitcnt lgkmcnt(2)
    s_nop 0
    v_mfma_f32_16x16x32_bf16 v[32:35], a[56:59], v[80:83], v[32:35]
    v_mfma_f32_16x16x32_bf16 v[36:39], a[56:59], v[84:87], v[36:39]
    v_mfma_f32_16x16x32_bf16 v[40:43], a[120:123], v[80:83], v[40:43]
    v_mfma_f32_16x16x32_bf16 v[44:47], a[120:123], v[84:87], v[44:47]
    v_mfma_f32_16x16x32_bf16 v[48:51], a[184:187], v[80:83], v[48:51]
    v_mfma_f32_16x16x32_bf16 v[52:55], a[184:187], v[84:87], v[52:55]
    v_mfma_f32_16x16x32_bf16 v[56:59], a[248:251], v[80:83], v[56:59]
    v_mfma_f32_16x16x32_bf16 v[60:63], a[248:251], v[84:87], v[60:63]
    v_mfma_f32_16x16x32_bf16 v[64:67], v[80:83], v[184:187], v[64:67]
    v_mfma_f32_16x16x32_bf16 v[68:71], v[84:87], v[184:187], v[68:71]
    v_mfma_f32_16x16x32_bf16 v[72:75], v[80:83], v[248:251], v[72:75]
    v_mfma_f32_16x16x32_bf16 v[76:79], v[84:87], v[248:251], v[76:79]
    s_waitcnt lgkmcnt(0)
    s_nop 0
    v_mfma_f32_16x16x32_bf16 v[32:35], a[60:63], v[88:91], v[32:35]
    v_mfma_f32_16x16x32_bf16 v[36:39], a[60:63], v[92:95], v[36:39]
    v_mfma_f32_16x16x32_bf16 v[40:43], a[124:127], v[88:91], v[40:43]
    v_mfma_f32_16x16x32_bf16 v[44:47], a[124:127], v[92:95], v[44:47]
    v_mfma_f32_16x16x32_bf16 v[48:51], a[188:191], v[88:91], v[48:51]
    v_mfma_f32_16x16x32_bf16 v[52:55], a[188:191], v[92:95], v[52:55]
    v_mfma_f32_16x16x32_bf16 v[56:59], a[252:255], v[88:91], v[56:59]
    v_mfma_f32_16x16x32_bf16 v[60:63], a[252:255], v[92:95], v[60:63]
    v_mfma_f32_16x16x32_bf16 v[64:67], v[88:91], v[188:191], v[64:67]
    v_mfma_f32_16x16x32_bf16 v[68:71], v[92:95], v[188:191], v[68:71]
    v_mfma_f32_16x16x32_bf16 v[72:75], v[88:91], v[252:255], v[72:75]
    v_mfma_f32_16x16x32_bf16 v[76:79], v[92:95], v[252:255], v[76:79]
    s_nop 7
    s_nop 0
    v_cvt_pk_bf16_f32 v96, v32, v33
    v_cvt_pk_bf16_f32 v97, v34, v35
    v_cvt_pk_bf16_f32 v98, v40, v41
    v_cvt_pk_bf16_f32 v99, v42, v43
    v_cvt_pk_bf16_f32 v100, v36, v37
    v_cvt_pk_bf16_f32 v101, v38, v39
    v_cvt_pk_bf16_f32 v102, v44, v45
    v_cvt_pk_bf16_f32 v103, v46, v47
    v_cvt_pk_bf16_f32 v104, v48, v49
    v_cvt_pk_bf16_f32 v105, v50, v51
    v_cvt_pk_bf16_f32 v106, v56, v57
    v_cvt_pk_bf16_f32 v107, v58, v59
    v_cvt_pk_bf16_f32 v108, v52, v53
    v_cvt_pk_bf16_f32 v109, v54, v55
    v_cvt_pk_bf16_f32 v110, v60, v61
    v_cvt_pk_bf16_f32 v111, v62, v63
    v_cvt_pk_bf16_f32 v112, v64, v65
    v_cvt_pk_bf16_f32 v113, v66, v67
    v_cvt_pk_bf16_f32 v114, v68, v69
    v_cvt_pk_bf16_f32 v115, v70, v71
    v_cvt_pk_bf16_f32 v116, v72, v73
    v_cvt_pk_bf16_f32 v117, v74, v75
    v_cvt_pk_bf16_f32 v118, v76, v77
    v_cvt_pk_bf16_f32 v119, v78, v79
    s_lshl_b32 s24, s22, 5
    s_add_u32 s24, s24, s17
    s_lshl_b32 s24, s24, 13
    s_lshl_b32 s25, s5, 10
    s_add_u32 s25, s25, s24
    s_nop 0
    s_add_u32 s26, s25, 2097152
    buffer_store_dwordx4 v[96:99], v25, s[8:11], s26 offen sc1
    s_add_u32 s26, s25, 2101248
    buffer_store_dwordx4 v[100:103], v25, s[8:11], s26 offen sc1
    s_add_u32 s26, s25, 18874368
    buffer_store_dwordx4 v[104:107], v25, s[8:11], s26 offen sc1
    s_add_u32 s26, s25, 18878464
    buffer_store_dwordx4 v[108:111], v25, s[8:11], s26 offen sc1
    s_lshl_b32 s25, s5, 11
    s_add_u32 s25, s25, s24
    s_add_u32 s26, s25, 35651584
    buffer_store_dwordx4 v[112:115], v25, s[8:11], s26 offen sc1
    s_add_u32 s26, s25, 35652608
    buffer_store_dwordx4 v[116:119], v25, s[8:11], s26 offen sc1
    s_mov_b32 s42, s22
    s_mov_b32 s22, s43
    s_cmp_ge_u32 s22, 64
    s_cbranch_scc1 L_w1_done
    s_branch L_w1_loop
L_w1_done:
    s_waitcnt vmcnt(0)
    s_barrier
    s_cmp_ge_u32 s42, 64
    s_cbranch_scc1 L_w1_noflag_41
    s_cmp_eq_u32 s5, 0
    s_cbranch_scc0 L_w1_noflag_41
    s_lshl_b32 s24, s42, 5
    s_add_u32 s24, s24, s17
    s_lshl_b32 s24, s24, 2
    s_add_u32 s24, s24, 61407232
    v_mov_b32_e64 v26, 1
    buffer_store_dword v26, off, s[8:11], s24 sc1
L_w1_noflag_41:
    s_mov_b32 s94, s92
    s_branch L_fin_all
L_w2:
    v_and_b32 v100, 63, v0
    v_and_b32 v101, 15, v100
    v_lshrrev_b32 v102, 4, v100
    s_sub_u32 s40, s6, 4
    s_load_dwordx2 s[56:57], s[0:1], 40
    s_waitcnt lgkmcnt(0)
    s_mov_b32 s28, s56
    s_and_b32 s29, s57, 0xffff
    s_mov_b32 s30, 4194304
    s_mov_b32 s31, 0x20000
    s_load_dwordx2 s[56:57], s[0:1], 80
    s_waitcnt lgkmcnt(0)
    s_mov_b32 s32, s56
    s_and_b32 s33, s57, 0xffff
    s_mov_b32 s34, 1835008
    s_mov_b32 s35, 0x20000
    s_load_dwordx2 s[56:57], s[0:1], 64
    s_waitcnt lgkmcnt(0)
    s_mov_b32 s36, s56
    s_and_b32 s37, s57, 0xffff
    s_mov_b32 s38, 1835008
    s_mov_b32 s39, 0x20000
    v_and_b32 v103, 3, v102
    v_lshlrev_b32 v103, 1, v103
    v_xor_b32 v103, v103, v101
    s_lshl_b32 s26, s5, 4
    s_mov_b32 s27, 1024
    v_xor_b32 v104, 0, v103
    v_lshlrev_b32 v104, 4, v104
    v_add_u32 v105, s26, v102
    v_add_u32 v105, 0, v105
    v_mul_lo_u32 v24, s27, v105
    v_add_u32 v24, v24, v104
    v_xor_b32 v104, 8, v103
    v_lshlrev_b32 v104, 4, v104
    v_add_u32 v105, s26, v102
    v_add_u32_e64 v105, 4, v105
    v_mul_lo_u32 v25, s27, v105
    v_add_u32 v25, v25, v104
    v_xor_b32 v104, 0, v103
    v_lshlrev_b32 v104, 4, v104
    v_add_u32 v105, s26, v102
    v_add_u32_e64 v105, 8, v105
    v_mul_lo_u32 v26, s27, v105
    v_add_u32 v26, v26, v104
    v_xor_b32 v104, 8, v103
    v_lshlrev_b32 v104, 4, v104
    v_add_u32 v105, s26, v102
    v_add_u32_e64 v105, 12, v105
    v_mul_lo_u32 v27, s27, v105
    v_add_u32 v27, v27, v104
    v_and_b32 v103, 3, v102
    v_lshlrev_b32 v103, 1, v103
    v_xor_b32_e64 v103, v103, v101
    s_lshl_b32 s26, s5, 4
    s_mov_b32 s27, 3584
    v_xor_b32 v104, 0, v103
    v_lshlrev_b32 v104, 4, v104
    v_add_u32 v105, s26, v102
    v_add_u32 v105, 0, v105
    v_mul_lo_u32 v28, s27, v105
    v_add_u32 v28, v28, v104
    v_xor_b32 v104, 0, v103
    v_lshlrev_b32 v104, 4, v104
    v_add_u32 v105, s26, v102
    v_add_u32_e64 v105, 4, v105
    v_mul_lo_u32 v29, s27, v105
    v_add_u32 v29, v29, v104
    v_xor_b32 v104, 8, v103
    v_lshlrev_b32 v104, 4, v104
    v_add_u32 v105, s26, v102
    v_add_u32_e64 v105, 8, v105
    v_mul_lo_u32 v30, s27, v105
    v_add_u32 v30, v30, v104
    v_xor_b32 v104, 8, v103
    v_lshlrev_b32 v104, 4, v104
    v_add_u32 v105, s26, v102
    v_add_u32_e64 v105, 12, v105
    v_mul_lo_u32 v31, s27, v105
    v_add_u32 v31, v31, v104
    v_lshrrev_b32 v103, 2, v101
    v_and_b32_e64 v104, 3, v101
    v_lshl_add_u32 v105, v102, 2, v103
    v_lshlrev_b32_e64 v32, 8, v105
    v_lshl_add_u32 v32, v104, 3, v32
    v_and_b32 v105, 1, v102
    v_lshlrev_b32 v105, 2, v105
    v_add_u32 v105, v105, v103
    v_lshlrev_b32 v33, 5, v105
    v_lshrrev_b32 v103, 2, v101
    v_and_b32 v104, 3, v101
    v_lshl_add_u32 v105, v102, 3, v103
    v_lshlrev_b32_e64 v34, 8, v105
    v_lshl_add_u32 v34, v104, 3, v34
    v_and_b32 v105, 1, v102
    v_lshlrev_b32 v105, 2, v105
    v_add_u32 v105, v105, v103
    v_lshlrev_b32 v35, 5, v105
    s_lshl_b32 s24, s5, 5
    v_xor_b32 v36, s24, v35
    v_add_u32 v36, v36, v34
    s_cmp_lt_u32 s4, 28
    s_cselect_b32 s41, 1, 0
    s_min_u32 s42, s4, 27
    s_lshl_b32 s24, s5, 12
    s_add_u32 m0, s24, 0
    s_lshl_b32 s25, s4, 17
    s_add_u32 s25, s25, 0
    buffer_load_dwordx4 v24, s[28:31], s25 offen lds
    s_lshl_b32 s24, s5, 12
    s_add_u32 m0, s24, 1024
    s_lshl_b32 s25, s4, 17
    s_add_u32 s25, s25, 0
    buffer_load_dwordx4 v25, s[28:31], s25 offen lds
    s_lshl_b32 s24, s5, 12
    s_add_u32 m0, s24, 2048
    s_lshl_b32 s25, s4, 17
    s_add_u32 s25, s25, 0
    buffer_load_dwordx4 v26, s[28:31], s25 offen lds
    s_lshl_b32 s24, s5, 12
    s_add_u32 m0, s24, 3072
    s_lshl_b32 s25, s4, 17
    s_add_u32 s25, s25, 0
    buffer_load_dwordx4 v27, s[28:31], s25 offen lds
    s_lshl_b32 s24, s5, 12
    s_add_u32 m0, s24, 16384
    s_lshl_b32 s25, s4, 17
    s_nop 0
    s_add_u32 s25, s25, 256
    buffer_load_dwordx4 v24, s[28:31], s25 offen lds
    s_lshl_b32 s24, s5, 12
    s_add_u32 m0, s24, 17408
    s_lshl_b32 s25, s4, 17
    s_add_u32 s25, s25, 256
    buffer_load_dwordx4 v25, s[28:31], s25 offen lds
    s_lshl_b32 s24, s5, 12
    s_add_u32 m0, s24, 18432
    s_lshl_b32 s25, s4, 17
    s_add_u32 s25, s25, 256
    buffer_load_dwordx4 v26, s[28:31], s25 offen lds
    s_lshl_b32 s24, s5, 12
    s_add_u32 m0, s24, 19456
    s_lshl_b32 s25, s4, 17
    s_add_u32 s25, s25, 256
    buffer_load_dwordx4 v27, s[28:31], s25 offen lds
    s_lshl_b32 s24, s5, 12
    s_add_u32 m0, s24, 32768
    s_lshl_b32 s25, s4, 17
    s_add_u32 s25, s25, 512
    buffer_load_dwordx4 v24, s[28:31], s25 offen lds
    s_lshl_b32 s24, s5, 12
    s_add_u32 m0, s24, 33792
    s_lshl_b32 s25, s4, 17
    s_add_u32 s25, s25, 512
    buffer_load_dwordx4 v25, s[28:31], s25 offen lds
    s_lshl_b32 s24, s5, 12
    s_add_u32 m0, s24, 34816
    s_lshl_b32 s25, s4, 17
    s_add_u32 s25, s25, 512
    buffer_load_dwordx4 v26, s[28:31], s25 offen lds
    s_lshl_b32 s24, s5, 12
    s_add_u32 m0, s24, 35840
    s_lshl_b32 s25, s4, 17
    s_add_u32 s25, s25, 512
    buffer_load_dwordx4 v27, s[28:31], s25 offen lds
    s_lshl_b32 s24, s5, 12
    s_add_u32 m0, s24, 49152
    s_lshl_b32 s25, s4, 17
    s_add_u32 s25, s25, 768
    buffer_load_dwordx4 v24, s[28:31], s25 offen lds
    s_lshl_b32 s24, s5, 12
    s_add_u32 m0, s24, 50176
    s_lshl_b32 s25, s4, 17
    s_add_u32 s25, s25, 768
    buffer_load_dwordx4 v25, s[28:31], s25 offen lds
    s_lshl_b32 s24, s5, 12
    s_add_u32 m0, s24, 51200
    s_lshl_b32 s25, s4, 17
    s_add_u32 s25, s25, 768
    buffer_load_dwordx4 v26, s[28:31], s25 offen lds
    s_lshl_b32 s24, s5, 12
    s_add_u32 m0, s24, 52224
    s_lshl_b32 s25, s4, 17
    s_add_u32 s25, s25, 768
    buffer_load_dwordx4 v27, s[28:31], s25 offen lds
    s_lshl_b32 s24, s5, 12
    s_add_u32 m0, s24, 65536
    s_lshl_b32 s25, s4, 17
    s_add_u32 s25, s25, 65536
    buffer_load_dwordx4 v24, s[28:31], s25 offen lds
    s_lshl_b32 s24, s5, 12
    s_add_u32 m0, s24, 66560
    s_lshl_b32 s25, s4, 17
    s_add_u32 s25, s25, 65536
    buffer_load_dwordx4 v25, s[28:31], s25 offen lds
    s_lshl_b32 s24, s5, 12
    s_add_u32 m0, s24, 67584
    s_lshl_b32 s25, s4, 17
    s_add_u32 s25, s25, 65536
    buffer_load_dwordx4 v26, s[28:31], s25 offen lds
    s_lshl_b32 s24, s5, 12
    s_add_u32 m0, s24, 68608
    s_lshl_b32 s25, s4, 17
    s_add_u32 s25, s25, 65536
    buffer_load_dwordx4 v27, s[28:31], s25 offen lds
    s_lshl_b32 s24, s5, 12
    s_add_u32 m0, s24, 81920
    s_lshl_b32 s25, s4, 17
    s_add_u32 s25, s25, 65792
    buffer_load_dwordx4 v24, s[28:31], s25 offen lds
    s_lshl_b32 s24, s5, 12
    s_add_u32 m0, s24, 82944
    s_lshl_b32 s25, s4, 17
    s_add_u32 s25, s25, 65792
    buffer_load_dwordx4 v25, s[28:31], s25 offen lds
    s_lshl_b32 s24, s5, 12
    s_add_u32 m0, s24, 83968
    s_lshl_b32 s25, s4, 17
    s_add_u32 s25, s25, 65792
    buffer_load_dwordx4 v26, s[28:31], s25 offen lds
    s_lshl_b32 s24, s5, 12
    s_add_u32 m0, s24, 84992
    s_lshl_b32 s25, s4, 17
    s_add_u32 s25, s25, 65792
    buffer_load_dwordx4 v27, s[28:31], s25 offen lds
    s_lshl_b32 s24, s5, 12
    s_add_u32 m0, s24, 98304
    s_lshl_b32 s25, s4, 17
    s_add_u32 s25, s25, 66048
    buffer_load_dwordx4 v24, s[28:31], s25 offen lds
    s_lshl_b32 s24, s5, 12
    s_add_u32 m0, s24, 99328
    s_lshl_b32 s25, s4, 17
    s_add_u32 s25, s25, 66048
    buffer_load_dwordx4 v25, s[28:31], s25 offen lds
    s_lshl_b32 s24, s5, 12
    s_add_u32 m0, s24, 100352
    s_lshl_b32 s25, s4, 17
    s_add_u32 s25, s25, 66048
    buffer_load_dwordx4 v26, s[28:31], s25 offen lds
    s_lshl_b32 s24, s5, 12
    s_add_u32 m0, s24, 101376
    s_lshl_b32 s25, s4, 17
    s_add_u32 s25, s25, 66048
    buffer_load_dwordx4 v27, s[28:31], s25 offen lds
    s_lshl_b32 s24, s5, 12
    s_add_u32 m0, s24, 114688
    s_lshl_b32 s25, s4, 17
    s_add_u32 s25, s25, 66304
    buffer_load_dwordx4 v24, s[28:31], s25 offen lds
    s_lshl_b32 s24, s5, 12
    s_add_u32 m0, s24, 115712
    s_lshl_b32 s25, s4, 17
    s_add_u32 s25, s25, 66304
    buffer_load_dwordx4 v25, s[28:31], s25 offen lds
    s_lshl_b32 s24, s5, 12
    s_add_u32 m0, s24, 116736
    s_lshl_b32 s25, s4, 17
    s_add_u32 s25, s25, 66304
    buffer_load_dwordx4 v26, s[28:31], s25 offen lds
    s_lshl_b32 s24, s5, 12
    s_add_u32 m0, s24, 117760
    s_lshl_b32 s25, s4, 17
    s_add_u32 s25, s25, 66304
    buffer_load_dwordx4 v27, s[28:31], s25 offen lds
    s_waitcnt vmcnt(28)
    s_barrier
    s_cmp_eq_u32 s5, 0
    s_cbranch_scc0 L_own_42
    v_xor_b32 v37, 0, v33
    v_add_u32 v37, v37, v32
    v_add_u32_e64 v37, 0, v37
    ds_read_b64_tr_b16 a[0:1], v37 offset:0
    ds_read_b64_tr_b16 a[2:3], v37 offset:4096
    ds_read_b64_tr_b16 a[4:5], v37 offset:8192
    ds_read_b64_tr_b16 a[6:7], v37 offset:12288
    v_xor_b32 v37, 32, v33
    v_add_u32 v37, v37, v32
    v_add_u32_e64 v37, 0, v37
    ds_read_b64_tr_b16 a[16:17], v37 offset:0
    ds_read_b64_tr_b16 a[18:19], v37 offset:4096
    ds_read_b64_tr_b16 a[20:21], v37 offset:8192
    ds_read_b64_tr_b16 a[22:23], v37 offset:12288
    s_waitcnt lgkmcnt(0)
    v_xor_b32 v37, 64, v33
    v_add_u32 v37, v37, v32
    v_add_u32 v37, 0, v37
    ds_read_b64_tr_b16 a[32:33], v37 offset:0
    ds_read_b64_tr_b16 a[34:35], v37 offset:4096
    ds_read_b64_tr_b16 a[36:37], v37 offset:8192
    ds_read_b64_tr_b16 a[38:39], v37 offset:12288
    v_xor_b32 v37, 96, v33
    v_add_u32 v37, v37, v32
    v_add_u32 v37, 0, v37
    ds_read_b64_tr_b16 a[48:49], v37 offset:0
    ds_read_b64_tr_b16 a[50:51], v37 offset:4096
    ds_read_b64_tr_b16 a[52:53], v37 offset:8192
    ds_read_b64_tr_b16 a[54:55], v37 offset:12288
    s_waitcnt lgkmcnt(0)
    v_xor_b32 v37, 128, v33
    v_add_u32 v37, v37, v32
    v_add_u32_e64 v37, 0, v37
    ds_read_b64_tr_b16 a[64:65], v37 offset:0
    ds_read_b64_tr_b16 a[66:67], v37 offset:4096
    ds_read_b64_tr_b16 a[68:69], v37 offset:8192
    ds_read_b64_tr_b16 a[70:71], v37 offset:12288
    v_xor_b32 v37, 160, v33
    v_add_u32 v37, v37, v32
    v_add_u32 v37, 0, v37
    ds_read_b64_tr_b16 a[80:81], v37 offset:0
    ds_read_b64_tr_b16 a[82:83], v37 offset:4096
    ds_read_b64_tr_b16 a[84:85], v37 offset:8192
    ds_read_b64_tr_b16 a[86:87], v37 offset:12288
    s_waitcnt lgkmcnt(0)
    v_xor_b32 v37, 192, v33
    v_add_u32 v37, v37, v32
    v_add_u32_e64 v37, 0, v37
    ds_read_b64_tr_b16 a[96:97], v37 offset:0
    ds_read_b64_tr_b16 a[98:99], v37 offset:4096
    ds_read_b64_tr_b16 a[100:101], v37 offset:8192
    ds_read_b64_tr_b16 a[102:103], v37 offset:12288
    v_xor_b32 v37, 224, v33
    v_add_u32 v37, v37, v32
    v_add_u32 v37, 0, v37
    ds_read_b64_tr_b16 a[112:113], v37 offset:0
    ds_read_b64_tr_b16 a[114:115], v37 offset:4096
    ds_read_b64_tr_b16 a[116:117], v37 offset:8192
    ds_read_b64_tr_b16 a[118:119], v37 offset:12288
    s_waitcnt lgkmcnt(0)
L_own_42:
    s_waitcnt lgkmcnt(0)
    s_barrier
    s_lshl_b32 s24, s5, 12
    s_add_u32 m0, s24, 0
    s_lshl_b32 s25, s42, 16
    s_add_u32 s25, s25, 0
    buffer_load_dwordx4 v24, s[32:35], s25 offen lds
    s_lshl_b32 s24, s5, 12
    s_add_u32 m0, s24, 1024
    s_lshl_b32 s25, s42, 16
    s_add_u32 s25, s25, 0
    buffer_load_dwordx4 v25, s[32:35], s25 offen lds
    s_lshl_b32 s24, s5, 12
    s_add_u32 m0, s24, 2048
    s_lshl_b32 s25, s42, 16
    s_add_u32 s25, s25, 0
    buffer_load_dwordx4 v26, s[32:35], s25 offen lds
    s_lshl_b32 s24, s5, 12
    s_add_u32 m0, s24, 3072
    s_lshl_b32 s25, s42, 16
    s_add_u32 s25, s25, 0
    buffer_load_dwordx4 v27, s[32:35], s25 offen lds
    s_waitcnt vmcnt(28)
    s_barrier
    s_cmp_eq_u32 s5, 1
    s_cbranch_scc0 L_own_43
    v_xor_b32 v37, 0, v33
    v_add_u32 v37, v37, v32
    v_add_u32 v37, 16384, v37
    ds_read_b64_tr_b16 a[0:1], v37 offset:0
    ds_read_b64_tr_b16 a[2:3], v37 offset:4096
    ds_read_b64_tr_b16 a[4:5], v37 offset:8192
    ds_read_b64_tr_b16 a[6:7], v37 offset:12288
    v_xor_b32 v37, 32, v33
    v_add_u32 v37, v37, v32
    v_add_u32 v37, 16384, v37
    ds_read_b64_tr_b16 a[16:17], v37 offset:0
    ds_read_b64_tr_b16 a[18:19], v37 offset:4096
    ds_read_b64_tr_b16 a[20:21], v37 offset:8192
    ds_read_b64_tr_b16 a[22:23], v37 offset:12288
    s_waitcnt lgkmcnt(0)
    v_xor_b32 v37, 64, v33
    v_add_u32_e64 v37, v37, v32
    v_add_u32 v37, 16384, v37
    ds_read_b64_tr_b16 a[32:33], v37 offset:0
    ds_read_b64_tr_b16 a[34:35], v37 offset:4096
    ds_read_b64_tr_b16 a[36:37], v37 offset:8192
    ds_read_b64_tr_b16 a[38:39], v37 offset:12288
    v_xor_b32 v37, 96, v33
    v_add_u32_e64 v37, v37, v32
    v_add_u32 v37, 16384, v37
    ds_read_b64_tr_b16 a[48:49], v37 offset:0
    ds_read_b64_tr_b16 a[50:51], v37 offset:4096
    ds_read_b64_tr_b16 a[52:53], v37 offset:8192
    ds_read_b64_tr_b16 a[54:55], v37 offset:12288
    s_waitcnt lgkmcnt(0)
    v_xor_b32 v37, 128, v33
    v_add_u32 v37, v37, v32
    v_add_u32 v37, 16384, v37
    ds_read_b64_tr_b16 a[64:65], v37 offset:0
    ds_read_b64_tr_b16 a[66:67], v37 offset:4096
    ds_read_b64_tr_b16 a[68:69], v37 offset:8192
    ds_read_b64_tr_b16 a[70:71], v37 offset:12288
    v_xor_b32 v37, 160, v33
    v_add_u32_e64 v37, v37, v32
    v_add_u32 v37, 16384, v37
    ds_read_b64_tr_b16 a[80:81], v37 offset:0
    ds_read_b64_tr_b16 a[82:83], v37 offset:4096
    ds_read_b64_tr_b16 a[84:85], v37 offset:8192
    ds_read_b64_tr_b16 a[86:87], v37 offset:12288
    s_waitcnt lgkmcnt(0)
    v_xor_b32 v37, 192, v33
    v_add_u32 v37, v37, v32
    v_add_u32 v37, 16384, v37
    ds_read_b64_tr_b16 a[96:97], v37 offset:0
    ds_read_b64_tr_b16 a[98:99], v37 offset:4096
    ds_read_b64_tr_b16 a[100:101], v37 offset:8192
    ds_read_b64_tr_b16 a[102:103], v37 offset:12288
    v_xor_b32 v37, 224, v33
    v_add_u32_e64 v37, v37, v32
    v_add_u32 v37, 16384, v37
    ds_read_b64_tr_b16 a[112:113], v37 offset:0
    ds_read_b64_tr_b16 a[114:115], v37 offset:4096
    ds_read_b64_tr_b16 a[116:117], v37 offset:8192
    ds_read_b64_tr_b16 a[118:119], v37 offset:12288
    s_waitcnt lgkmcnt(0)
L_own_43:
    s_waitcnt lgkmcnt(0)
    s_barrier
    s_lshl_b32 s24, s5, 12
    s_add_u32 m0, s24, 16384
    s_lshl_b32 s25, s42, 16
    s_nop 0
    s_add_u32 s25, s25, 256
    buffer_load_dwordx4 v24, s[32:35], s25 offen lds
    s_lshl_b32 s24, s5, 12
    s_add_u32 m0, s24, 17408
    s_lshl_b32 s25, s42, 16
    s_add_u32 s25, s25, 256
    buffer_load_dwordx4 v25, s[32:35], s25 offen lds
    s_lshl_b32 s24, s5, 12
    s_add_u32 m0, s24, 18432
    s_lshl_b32 s25, s42, 16
    s_add_u32 s25, s25, 256
    buffer_load_dwordx4 v26, s[32:35], s25 offen lds
    s_lshl_b32 s24, s5, 12
    s_add_u32 m0, s24, 19456
    s_lshl_b32 s25, s42, 16
    s_add_u32 s25, s25, 256
    buffer_load_dwordx4 v27, s[32:35], s25 offen lds
    s_waitcnt vmcnt(28)
    s_barrier
    s_cmp_eq_u32 s5, 2
    s_cbranch_scc0 L_own_44
    v_xor_b32 v37, 0, v33
    v_add_u32 v37, v37, v32
    v_add_u32 v37, 32768, v37
    ds_read_b64_tr_b16 a[0:1], v37 offset:0
    ds_read_b64_tr_b16 a[2:3], v37 offset:4096
    ds_read_b64_tr_b16 a[4:5], v37 offset:8192
    ds_read_b64_tr_b16 a[6:7], v37 offset:12288
    v_xor_b32 v37, 32, v33
    v_add_u32 v37, v37, v32
    v_add_u32 v37, 32768, v37
    ds_read_b64_tr_b16 a[16:17], v37 offset:0
    ds_read_b64_tr_b16 a[18:19], v37 offset:4096
    ds_read_b64_tr_b16 a[20:21], v37 offset:8192
    ds_read_b64_tr_b16 a[22:23], v37 offset:12288
    s_waitcnt lgkmcnt(0)
    v_xor_b32 v37, 64, v33
    v_add_u32_e64 v37, v37, v32
    v_add_u32 v37, 32768, v37
    ds_read_b64_tr_b16 a[32:33], v37 offset:0
    ds_read_b64_tr_b16 a[34:35], v37 offset:4096
    ds_read_b64_tr_b16 a[36:37], v37 offset:8192
    ds_read_b64_tr_b16 a[38:39], v37 offset:12288
    v_xor_b32 v37, 96, v33
    v_add_u32_e64 v37, v37, v32
    v_add_u32 v37, 32768, v37
    ds_read_b64_tr_b16 a[48:49], v37 offset:0
    ds_read_b64_tr_b16 a[50:51], v37 offset:4096
    ds_read_b64_tr_b16 a[52:53], v37 offset:8192
    ds_read_b64_tr_b16 a[54:55], v37 offset:12288
    s_waitcnt lgkmcnt(0)
    v_xor_b32 v37, 128, v33
    v_add_u32 v37, v37, v32
    v_add_u32 v37, 32768, v37
    ds_read_b64_tr_b16 a[64:65], v37 offset:0
    ds_read_b64_tr_b16 a[66:67], v37 offset:4096
    ds_read_b64_tr_b16 a[68:69], v37 offset:8192
    ds_read_b64_tr_b16 a[70:71], v37 offset:12288
    v_xor_b32 v37, 160, v33
    v_add_u32_e64 v37, v37, v32
    v_add_u32 v37, 32768, v37
    ds_read_b64_tr_b16 a[80:81], v37 offset:0
    ds_read_b64_tr_b16 a[82:83], v37 offset:4096
    ds_read_b64_tr_b16 a[84:85], v37 offset:8192
    ds_read_b64_tr_b16 a[86:87], v37 offset:12288
    s_waitcnt lgkmcnt(0)
    v_xor_b32 v37, 192, v33
    v_add_u32 v37, v37, v32
    v_add_u32 v37, 32768, v37
    ds_read_b64_tr_b16 a[96:97], v37 offset:0
    ds_read_b64_tr_b16 a[98:99], v37 offset:4096
    ds_read_b64_tr_b16 a[100:101], v37 offset:8192
    ds_read_b64_tr_b16 a[102:103], v37 offset:12288
    v_xor_b32 v37, 224, v33
    v_add_u32_e64 v37, v37, v32
    v_add_u32 v37, 32768, v37
    ds_read_b64_tr_b16 a[112:113], v37 offset:0
    ds_read_b64_tr_b16 a[114:115], v37 offset:4096
    ds_read_b64_tr_b16 a[116:117], v37 offset:8192
    ds_read_b64_tr_b16 a[118:119], v37 offset:12288
    s_waitcnt lgkmcnt(0)
L_own_44:
    s_waitcnt lgkmcnt(0)
    s_barrier
    s_lshl_b32 s24, s5, 12
    s_add_u32 m0, s24, 32768
    s_lshl_b32 s25, s42, 16
    s_nop 0
    s_add_u32 s25, s25, 512
    buffer_load_dwordx4 v24, s[32:35], s25 offen lds
    s_lshl_b32 s24, s5, 12
    s_add_u32 m0, s24, 33792
    s_lshl_b32 s25, s42, 16
    s_add_u32 s25, s25, 512
    buffer_load_dwordx4 v25, s[32:35], s25 offen lds
    s_lshl_b32 s24, s5, 12
    s_add_u32 m0, s24, 34816
    s_lshl_b32 s25, s42, 16
    s_add_u32 s25, s25, 512
    buffer_load_dwordx4 v26, s[32:35], s25 offen lds
    s_lshl_b32 s24, s5, 12
    s_add_u32 m0, s24, 35840
    s_lshl_b32 s25, s42, 16
    s_add_u32 s25, s25, 512
    buffer_load_dwordx4 v27, s[32:35], s25 offen lds
    s_waitcnt vmcnt(28)
    s_barrier
    s_cmp_eq_u32 s5, 3
    s_cbranch_scc0 L_own_45
    v_xor_b32 v37, 0, v33
    v_add_u32 v37, v37, v32
    v_add_u32 v37, 49152, v37
    ds_read_b64_tr_b16 a[0:1], v37 offset:0
    ds_read_b64_tr_b16 a[2:3], v37 offset:4096
    ds_read_b64_tr_b16 a[4:5], v37 offset:8192
    ds_read_b64_tr_b16 a[6:7], v37 offset:12288
    v_xor_b32 v37, 32, v33
    v_add_u32 v37, v37, v32
    v_add_u32 v37, 49152, v37
    ds_read_b64_tr_b16 a[16:17], v37 offset:0
    ds_read_b64_tr_b16 a[18:19], v37 offset:4096
    ds_read_b64_tr_b16 a[20:21], v37 offset:8192
    ds_read_b64_tr_b16 a[22:23], v37 offset:12288
    s_waitcnt lgkmcnt(0)
    v_xor_b32 v37, 64, v33
    v_add_u32_e64 v37, v37, v32
    v_add_u32 v37, 49152, v37
    ds_read_b64_tr_b16 a[32:33], v37 offset:0
    ds_read_b64_tr_b16 a[34:35], v37 offset:4096
    ds_read_b64_tr_b16 a[36:37], v37 offset:8192
    ds_read_b64_tr_b16 a[38:39], v37 offset:12288
    v_xor_b32 v37, 96, v33
    v_add_u32_e64 v37, v37, v32
    v_add_u32 v37, 49152, v37
    ds_read_b64_tr_b16 a[48:49], v37 offset:0
    ds_read_b64_tr_b16 a[50:51], v37 offset:4096
    ds_read_b64_tr_b16 a[52:53], v37 offset:8192
    ds_read_b64_tr_b16 a[54:55], v37 offset:12288
    s_waitcnt lgkmcnt(0)
    v_xor_b32 v37, 128, v33
    v_add_u32 v37, v37, v32
    v_add_u32 v37, 49152, v37
    ds_read_b64_tr_b16 a[64:65], v37 offset:0
    ds_read_b64_tr_b16 a[66:67], v37 offset:4096
    ds_read_b64_tr_b16 a[68:69], v37 offset:8192
    ds_read_b64_tr_b16 a[70:71], v37 offset:12288
    v_xor_b32 v37, 160, v33
    v_add_u32_e64 v37, v37, v32
    v_add_u32 v37, 49152, v37
    ds_read_b64_tr_b16 a[80:81], v37 offset:0
    ds_read_b64_tr_b16 a[82:83], v37 offset:4096
    ds_read_b64_tr_b16 a[84:85], v37 offset:8192
    ds_read_b64_tr_b16 a[86:87], v37 offset:12288
    s_waitcnt lgkmcnt(0)
    v_xor_b32 v37, 192, v33
    v_add_u32 v37, v37, v32
    v_add_u32 v37, 49152, v37
    ds_read_b64_tr_b16 a[96:97], v37 offset:0
    ds_read_b64_tr_b16 a[98:99], v37 offset:4096
    ds_read_b64_tr_b16 a[100:101], v37 offset:8192
    ds_read_b64_tr_b16 a[102:103], v37 offset:12288
    v_xor_b32 v37, 224, v33
    v_add_u32_e64 v37, v37, v32
    v_add_u32 v37, 49152, v37
    ds_read_b64_tr_b16 a[112:113], v37 offset:0
    ds_read_b64_tr_b16 a[114:115], v37 offset:4096
    ds_read_b64_tr_b16 a[116:117], v37 offset:8192
    ds_read_b64_tr_b16 a[118:119], v37 offset:12288
    s_waitcnt lgkmcnt(0)
L_own_45:
    s_waitcnt lgkmcnt(0)
    s_barrier
    s_lshl_b32 s24, s5, 12
    s_add_u32 m0, s24, 49152
    s_lshl_b32 s25, s42, 16
    s_nop 0
    s_add_u32 s25, s25, 768
    buffer_load_dwordx4 v24, s[32:35], s25 offen lds
    s_lshl_b32 s24, s5, 12
    s_add_u32 m0, s24, 50176
    s_lshl_b32 s25, s42, 16
    s_add_u32 s25, s25, 768
    buffer_load_dwordx4 v25, s[32:35], s25 offen lds
    s_lshl_b32 s24, s5, 12
    s_add_u32 m0, s24, 51200
    s_lshl_b32 s25, s42, 16
    s_add_u32 s25, s25, 768
    buffer_load_dwordx4 v26, s[32:35], s25 offen lds
    s_lshl_b32 s24, s5, 12
    s_add_u32 m0, s24, 52224
    s_lshl_b32 s25, s42, 16
    s_add_u32 s25, s25, 768
    buffer_load_dwordx4 v27, s[32:35], s25 offen lds
    s_waitcnt vmcnt(28)
    s_barrier
    s_cmp_eq_u32 s5, 0
    s_cbranch_scc0 L_own_46
    v_xor_b32 v37, 0, v33
    v_add_u32 v37, v37, v32
    v_add_u32 v37, 65536, v37
    ds_read_b64_tr_b16 a[8:9], v37 offset:0
    ds_read_b64_tr_b16 a[10:11], v37 offset:4096
    ds_read_b64_tr_b16 a[12:13], v37 offset:8192
    ds_read_b64_tr_b16 a[14:15], v37 offset:12288
    v_xor_b32 v37, 32, v33
    v_add_u32 v37, v37, v32
    v_add_u32 v37, 65536, v37
    ds_read_b64_tr_b16 a[24:25], v37 offset:0
    ds_read_b64_tr_b16 a[26:27], v37 offset:4096
    ds_read_b64_tr_b16 a[28:29], v37 offset:8192
    ds_read_b64_tr_b16 a[30:31], v37 offset:12288
    s_waitcnt lgkmcnt(0)
    v_xor_b32 v37, 64, v33
    v_add_u32_e64 v37, v37, v32
    v_add_u32 v37, 65536, v37
    ds_read_b64_tr_b16 a[40:41], v37 offset:0
    ds_read_b64_tr_b16 a[42:43], v37 offset:4096
    ds_read_b64_tr_b16 a[44:45], v37 offset:8192
    ds_read_b64_tr_b16 a[46:47], v37 offset:12288
    v_xor_b32 v37, 96, v33
    v_add_u32_e64 v37, v37, v32
    v_add_u32 v37, 65536, v37
    ds_read_b64_tr_b16 a[56:57], v37 offset:0
    ds_read_b64_tr_b16 a[58:59], v37 offset:4096
    ds_read_b64_tr_b16 a[60:61], v37 offset:8192
    ds_read_b64_tr_b16 a[62:63], v37 offset:12288
    s_waitcnt lgkmcnt(0)
    v_xor_b32 v37, 128, v33
    v_add_u32 v37, v37, v32
    v_add_u32 v37, 65536, v37
    ds_read_b64_tr_b16 a[72:73], v37 offset:0
    ds_read_b64_tr_b16 a[74:75], v37 offset:4096
    ds_read_b64_tr_b16 a[76:77], v37 offset:8192
    ds_read_b64_tr_b16 a[78:79], v37 offset:12288
    v_xor_b32 v37, 160, v33
    v_add_u32_e64 v37, v37, v32
    v_add_u32 v37, 65536, v37
    ds_read_b64_tr_b16 a[88:89], v37 offset:0
    ds_read_b64_tr_b16 a[90:91], v37 offset:4096
    ds_read_b64_tr_b16 a[92:93], v37 offset:8192
    ds_read_b64_tr_b16 a[94:95], v37 offset:12288
    s_waitcnt lgkmcnt(0)
    v_xor_b32 v37, 192, v33
    v_add_u32 v37, v37, v32
    v_add_u32 v37, 65536, v37
    ds_read_b64_tr_b16 a[104:105], v37 offset:0
    ds_read_b64_tr_b16 a[106:107], v37 offset:4096
    ds_read_b64_tr_b16 a[108:109], v37 offset:8192
    ds_read_b64_tr_b16 a[110:111], v37 offset:12288
    v_xor_b32 v37, 224, v33
    v_add_u32_e64 v37, v37, v32
    v_add_u32 v37, 65536, v37
    ds_read_b64_tr_b16 a[120:121], v37 offset:0
    ds_read_b64_tr_b16 a[122:123], v37 offset:4096
    ds_read_b64_tr_b16 a[124:125], v37 offset:8192
    ds_read_b64_tr_b16 a[126:127], v37 offset:12288
    s_waitcnt lgkmcnt(0)
L_own_46:
    s_waitcnt lgkmcnt(0)
    s_barrier
    s_lshl_b32 s24, s5, 12
    s_add_u32 m0, s24, 65536
    s_lshl_b32 s25, s42, 7
    s_add_u32 s25, s25, 0
    buffer_load_dwordx4 v28, s[36:39], s25 offen lds
    s_lshl_b32 s24, s5, 12
    s_add_u32 m0, s24, 66560
    s_lshl_b32 s25, s42, 7
    s_add_u32 s25, s25, 0
    buffer_load_dwordx4 v29, s[36:39], s25 offen lds
    s_lshl_b32 s24, s5, 12
    s_add_u32 m0, s24, 67584
    s_lshl_b32 s25, s42, 7
    s_add_u32 s25, s25, 0
    buffer_load_dwordx4 v30, s[36:39], s25 offen lds
    s_lshl_b32 s24, s5, 12
    s_add_u32 m0, s24, 68608
    s_lshl_b32 s25, s42, 7
    s_add_u32 s25, s25, 0
    buffer_load_dwordx4 v31, s[36:39], s25 offen lds
    s_waitcnt vmcnt(28)
    s_barrier
    s_cmp_eq_u32 s5, 1
    s_cbranch_scc0 L_own_47
    v_xor_b32 v37, 0, v33
    v_add_u32_e64 v37, v37, v32
    v_add_u32 v37, 81920, v37
    ds_read_b64_tr_b16 a[8:9], v37 offset:0
    ds_read_b64_tr_b16 a[10:11], v37 offset:4096
    ds_read_b64_tr_b16 a[12:13], v37 offset:8192
    ds_read_b64_tr_b16 a[14:15], v37 offset:12288
    v_xor_b32 v37, 32, v33
    v_add_u32 v37, v37, v32
    v_add_u32 v37, 81920, v37
    ds_read_b64_tr_b16 a[24:25], v37 offset:0
    ds_read_b64_tr_b16 a[26:27], v37 offset:4096
    ds_read_b64_tr_b16 a[28:29], v37 offset:8192
    ds_read_b64_tr_b16 a[30:31], v37 offset:12288
    s_waitcnt lgkmcnt(0)
    v_xor_b32 v37, 64, v33
    v_add_u32_e64 v37, v37, v32
    v_add_u32 v37, 81920, v37
    ds_read_b64_tr_b16 a[40:41], v37 offset:0
    ds_read_b64_tr_b16 a[42:43], v37 offset:4096
    ds_read_b64_tr_b16 a[44:45], v37 offset:8192
    ds_read_b64_tr_b16 a[46:47], v37 offset:12288
    v_xor_b32 v37, 96, v33
    v_add_u32_e64 v37, v37, v32
    v_add_u32 v37, 81920, v37
    ds_read_b64_tr_b16 a[56:57], v37 offset:0
    ds_read_b64_tr_b16 a[58:59], v37 offset:4096
    ds_read_b64_tr_b16 a[60:61], v37 offset:8192
    ds_read_b64_tr_b16 a[62:63], v37 offset:12288
    s_waitcnt lgkmcnt(0)
    v_xor_b32 v37, 128, v33
    v_add_u32 v37, v37, v32
    v_add_u32 v37, 81920, v37
    ds_read_b64_tr_b16 a[72:73], v37 offset:0
    ds_read_b64_tr_b16 a[74:75], v37 offset:4096
    ds_read_b64_tr_b16 a[76:77], v37 offset:8192
    ds_read_b64_tr_b16 a[78:79], v37 offset:12288
    v_xor_b32 v37, 160, v33
    v_add_u32_e64 v37, v37, v32
    v_add_u32 v37, 81920, v37
    ds_read_b64_tr_b16 a[88:89], v37 offset:0
    ds_read_b64_tr_b16 a[90:91], v37 offset:4096
    ds_read_b64_tr_b16 a[92:93], v37 offset:8192
    ds_read_b64_tr_b16 a[94:95], v37 offset:12288
    s_waitcnt lgkmcnt(0)
    v_xor_b32 v37, 192, v33
    v_add_u32 v37, v37, v32
    v_add_u32 v37, 81920, v37
    ds_read_b64_tr_b16 a[104:105], v37 offset:0
    ds_read_b64_tr_b16 a[106:107], v37 offset:4096
    ds_read_b64_tr_b16 a[108:109], v37 offset:8192
    ds_read_b64_tr_b16 a[110:111], v37 offset:12288
    v_xor_b32 v37, 224, v33
    v_add_u32_e64 v37, v37, v32
    v_add_u32 v37, 81920, v37
    ds_read_b64_tr_b16 a[120:121], v37 offset:0
    ds_read_b64_tr_b16 a[122:123], v37 offset:4096
    ds_read_b64_tr_b16 a[124:125], v37 offset:8192
    ds_read_b64_tr_b16 a[126:127], v37 offset:12288
    s_waitcnt lgkmcnt(0)
L_own_47:
    s_waitcnt lgkmcnt(0)
    s_barrier
    s_lshl_b32 s24, s5, 12
    s_add_u32 m0, s24, 81920
    s_lshl_b32 s25, s42, 7
    s_nop 0
    s_add_u32 s25, s25, 229376
    buffer_load_dwordx4 v28, s[36:39], s25 offen lds
    s_lshl_b32 s24, s5, 12
    s_add_u32 m0, s24, 82944
    s_lshl_b32 s25, s42, 7
    s_add_u32 s25, s25, 229376
    buffer_load_dwordx4 v29, s[36:39], s25 offen lds
    s_lshl_b32 s24, s5, 12
    s_add_u32 m0, s24, 83968
    s_lshl_b32 s25, s42, 7
    s_add_u32 s25, s25, 229376
    buffer_load_dwordx4 v30, s[36:39], s25 offen lds
    s_lshl_b32 s24, s5, 12
    s_add_u32 m0, s24, 84992
    s_lshl_b32 s25, s42, 7
    s_add_u32 s25, s25, 229376
    buffer_load_dwordx4 v31, s[36:39], s25 offen lds
    s_waitcnt vmcnt(28)
    s_barrier
    s_cmp_eq_u32 s5, 2
    s_cbranch_scc0 L_own_48
    v_xor_b32 v37, 0, v33
    v_add_u32 v37, v37, v32
    v_add_u32 v37, 98304, v37
    ds_read_b64_tr_b16 a[8:9], v37 offset:0
    ds_read_b64_tr_b16 a[10:11], v37 offset:4096
    ds_read_b64_tr_b16 a[12:13], v37 offset:8192
    ds_read_b64_tr_b16 a[14:15], v37 offset:12288
    v_xor_b32 v37, 32, v33
    v_add_u32 v37, v37, v32
    v_add_u32 v37, 98304, v37
    ds_read_b64_tr_b16 a[24:25], v37 offset:0
    ds_read_b64_tr_b16 a[26:27], v37 offset:4096
    ds_read_b64_tr_b16 a[28:29], v37 offset:8192
    ds_read_b64_tr_b16 a[30:31], v37 offset:12288
    s_waitcnt lgkmcnt(0)
    v_xor_b32 v37, 64, v33
    v_add_u32_e64 v37, v37, v32
    v_add_u32 v37, 98304, v37
    ds_read_b64_tr_b16 a[40:41], v37 offset:0
    ds_read_b64_tr_b16 a[42:43], v37 offset:4096
    ds_read_b64_tr_b16 a[44:45], v37 offset:8192
    ds_read_b64_tr_b16 a[46:47], v37 offset:12288
    v_xor_b32 v37, 96, v33
    v_add_u32_e64 v37, v37, v32
    v_add_u32 v37, 98304, v37
    ds_read_b64_tr_b16 a[56:57], v37 offset:0
    ds_read_b64_tr_b16 a[58:59], v37 offset:4096
    ds_read_b64_tr_b16 a[60:61], v37 offset:8192
    ds_read_b64_tr_b16 a[62:63], v37 offset:12288
    s_waitcnt lgkmcnt(0)
    v_xor_b32 v37, 128, v33
    v_add_u32 v37, v37, v32
    v_add_u32 v37, 98304, v37
    ds_read_b64_tr_b16 a[72:73], v37 offset:0
    ds_read_b64_tr_b16 a[74:75], v37 offset:4096
    ds_read_b64_tr_b16 a[76:77], v37 offset:8192
    ds_read_b64_tr_b16 a[78:79], v37 offset:12288
    v_xor_b32 v37, 160, v33
    v_add_u32_e64 v37, v37, v32
    v_add_u32 v37, 98304, v37
    ds_read_b64_tr_b16 a[88:89], v37 offset:0
    ds_read_b64_tr_b16 a[90:91], v37 offset:4096
    ds_read_b64_tr_b16 a[92:93], v37 offset:8192
    ds_read_b64_tr_b16 a[94:95], v37 offset:12288
    s_waitcnt lgkmcnt(0)
    v_xor_b32 v37, 192, v33
    v_add_u32 v37, v37, v32
    v_add_u32 v37, 98304, v37
    ds_read_b64_tr_b16 a[104:105], v37 offset:0
    ds_read_b64_tr_b16 a[106:107], v37 offset:4096
    ds_read_b64_tr_b16 a[108:109], v37 offset:8192
    ds_read_b64_tr_b16 a[110:111], v37 offset:12288
    v_xor_b32 v37, 224, v33
    v_add_u32_e64 v37, v37, v32
    v_add_u32 v37, 98304, v37
    ds_read_b64_tr_b16 a[120:121], v37 offset:0
    ds_read_b64_tr_b16 a[122:123], v37 offset:4096
    ds_read_b64_tr_b16 a[124:125], v37 offset:8192
    ds_read_b64_tr_b16 a[126:127], v37 offset:12288
    s_waitcnt lgkmcnt(0)
L_own_48:
    s_waitcnt lgkmcnt(0)
    s_barrier
    s_lshl_b32 s24, s5, 12
    s_add_u32 m0, s24, 98304
    s_lshl_b32 s25, s42, 7
    s_nop 0
    s_add_u32 s25, s25, 458752
    buffer_load_dwordx4 v28, s[36:39], s25 offen lds
    s_lshl_b32 s24, s5, 12
    s_add_u32 m0, s24, 99328
    s_lshl_b32 s25, s42, 7
    s_add_u32 s25, s25, 458752
    buffer_load_dwordx4 v29, s[36:39], s25 offen lds
    s_lshl_b32 s24, s5, 12
    s_add_u32 m0, s24, 100352
    s_lshl_b32 s25, s42, 7
    s_add_u32 s25, s25, 458752
    buffer_load_dwordx4 v30, s[36:39], s25 offen lds
    s_lshl_b32 s24, s5, 12
    s_add_u32 m0, s24, 101376
    s_lshl_b32 s25, s42, 7
    s_add_u32 s25, s25, 458752
    buffer_load_dwordx4 v31, s[36:39], s25 offen lds
    s_waitcnt vmcnt(28)
    s_barrier
    s_cmp_eq_u32 s5, 3
    s_cbranch_scc0 L_own_49
    v_xor_b32 v37, 0, v33
    v_add_u32 v37, v37, v32
    v_add_u32 v37, 114688, v37
    ds_read_b64_tr_b16 a[8:9], v37 offset:0
    ds_read_b64_tr_b16 a[10:11], v37 offset:4096
    ds_read_b64_tr_b16 a[12:13], v37 offset:8192
    ds_read_b64_tr_b16 a[14:15], v37 offset:12288
    v_xor_b32 v37, 32, v33
    v_add_u32 v37, v37, v32
    v_add_u32 v37, 114688, v37
    ds_read_b64_tr_b16 a[24:25], v37 offset:0
    ds_read_b64_tr_b16 a[26:27], v37 offset:4096
    ds_read_b64_tr_b16 a[28:29], v37 offset:8192
    ds_read_b64_tr_b16 a[30:31], v37 offset:12288
    s_waitcnt lgkmcnt(0)
    v_xor_b32 v37, 64, v33
    v_add_u32_e64 v37, v37, v32
    v_add_u32 v37, 114688, v37
    ds_read_b64_tr_b16 a[40:41], v37 offset:0
    ds_read_b64_tr_b16 a[42:43], v37 offset:4096
    ds_read_b64_tr_b16 a[44:45], v37 offset:8192
    ds_read_b64_tr_b16 a[46:47], v37 offset:12288
    v_xor_b32 v37, 96, v33
    v_add_u32_e64 v37, v37, v32
    v_add_u32 v37, 114688, v37
    ds_read_b64_tr_b16 a[56:57], v37 offset:0
    ds_read_b64_tr_b16 a[58:59], v37 offset:4096
    ds_read_b64_tr_b16 a[60:61], v37 offset:8192
    ds_read_b64_tr_b16 a[62:63], v37 offset:12288
    s_waitcnt lgkmcnt(0)
    v_xor_b32 v37, 128, v33
    v_add_u32 v37, v37, v32
    v_add_u32 v37, 114688, v37
    ds_read_b64_tr_b16 a[72:73], v37 offset:0
    ds_read_b64_tr_b16 a[74:75], v37 offset:4096
    ds_read_b64_tr_b16 a[76:77], v37 offset:8192
    ds_read_b64_tr_b16 a[78:79], v37 offset:12288
    v_xor_b32 v37, 160, v33
    v_add_u32_e64 v37, v37, v32
    v_add_u32 v37, 114688, v37
    ds_read_b64_tr_b16 a[88:89], v37 offset:0
    ds_read_b64_tr_b16 a[90:91], v37 offset:4096
    ds_read_b64_tr_b16 a[92:93], v37 offset:8192
    ds_read_b64_tr_b16 a[94:95], v37 offset:12288
    s_waitcnt lgkmcnt(0)
    v_xor_b32 v37, 192, v33
    v_add_u32 v37, v37, v32
    v_add_u32 v37, 114688, v37
    ds_read_b64_tr_b16 a[104:105], v37 offset:0
    ds_read_b64_tr_b16 a[106:107], v37 offset:4096
    ds_read_b64_tr_b16 a[108:109], v37 offset:8192
    ds_read_b64_tr_b16 a[110:111], v37 offset:12288
    v_xor_b32 v37, 224, v33
    v_add_u32_e64 v37, v37, v32
    v_add_u32 v37, 114688, v37
    ds_read_b64_tr_b16 a[120:121], v37 offset:0
    ds_read_b64_tr_b16 a[122:123], v37 offset:4096
    ds_read_b64_tr_b16 a[124:125], v37 offset:8192
    ds_read_b64_tr_b16 a[126:127], v37 offset:12288
    s_waitcnt lgkmcnt(0)
L_own_49:
    s_waitcnt lgkmcnt(0)
    s_barrier
    s_lshl_b32 s24, s5, 12
    s_add_u32 m0, s24, 114688
    s_lshl_b32 s25, s42, 7
    s_nop 0
    s_add_u32 s25, s25, 688128
    buffer_load_dwordx4 v28, s[36:39], s25 offen lds
    s_lshl_b32 s24, s5, 12
    s_add_u32 m0, s24, 115712
    s_lshl_b32 s25, s42, 7
    s_add_u32 s25, s25, 688128
    buffer_load_dwordx4 v29, s[36:39], s25 offen lds
    s_lshl_b32 s24, s5, 12
    s_add_u32 m0, s24, 116736
    s_lshl_b32 s25, s42, 7
    s_add_u32 s25, s25, 688128
    buffer_load_dwordx4 v30, s[36:39], s25 offen lds
    s_lshl_b32 s24, s5, 12
    s_add_u32 m0, s24, 117760
    s_lshl_b32 s25, s42, 7
    s_add_u32 s25, s25, 688128
    buffer_load_dwordx4 v31, s[36:39], s25 offen lds
    s_waitcnt vmcnt(28)
    s_barrier
    s_cmp_eq_u32 s5, 0
    s_cbranch_scc0 L_own_50
    v_xor_b32 v37, 0, v33
    v_add_u32 v37, v37, v32
    v_add_u32_e64 v37, 0, v37
    ds_read_b64_tr_b16 a[128:129], v37 offset:0
    ds_read_b64_tr_b16 a[130:131], v37 offset:4096
    ds_read_b64_tr_b16 a[132:133], v37 offset:8192
    ds_read_b64_tr_b16 a[134:135], v37 offset:12288
    v_xor_b32 v37, 32, v33
    v_add_u32 v37, v37, v32
    v_add_u32_e64 v37, 0, v37
    ds_read_b64_tr_b16 a[136:137], v37 offset:0
    ds_read_b64_tr_b16 a[138:139], v37 offset:4096
    ds_read_b64_tr_b16 a[140:141], v37 offset:8192
    ds_read_b64_tr_b16 a[142:143], v37 offset:12288
    s_waitcnt lgkmcnt(0)
    v_xor_b32 v37, 64, v33
    v_add_u32 v37, v37, v32
    v_add_u32 v37, 0, v37
    ds_read_b64_tr_b16 a[144:145], v37 offset:0
    ds_read_b64_tr_b16 a[146:147], v37 offset:4096
    ds_read_b64_tr_b16 a[148:149], v37 offset:8192
    ds_read_b64_tr_b16 a[150:151], v37 offset:12288
    v_xor_b32 v37, 96, v33
    v_add_u32 v37, v37, v32
    v_add_u32 v37, 0, v37
    ds_read_b64_tr_b16 a[152:153], v37 offset:0
    ds_read_b64_tr_b16 a[154:155], v37 offset:4096
    ds_read_b64_tr_b16 a[156:157], v37 offset:8192
    ds_read_b64_tr_b16 a[158:159], v37 offset:12288
    s_waitcnt lgkmcnt(0)
    v_xor_b32 v37, 128, v33
    v_add_u32 v37, v37, v32
    v_add_u32_e64 v37, 0, v37
    ds_read_b64_tr_b16 a[160:161], v37 offset:0
    ds_read_b64_tr_b16 a[162:163], v37 offset:4096
    ds_read_b64_tr_b16 a[164:165], v37 offset:8192
    ds_read_b64_tr_b16 a[166:167], v37 offset:12288
    v_xor_b32 v37, 160, v33
    v_add_u32 v37, v37, v32
    v_add_u32 v37, 0, v37
    ds_read_b64_tr_b16 a[168:169], v37 offset:0
    ds_read_b64_tr_b16 a[170:171], v37 offset:4096
    ds_read_b64_tr_b16 a[172:173], v37 offset:8192
    ds_read_b64_tr_b16 a[174:175], v37 offset:12288
    s_waitcnt lgkmcnt(0)
    v_xor_b32 v37, 192, v33
    v_add_u32 v37, v37, v32
    v_add_u32_e64 v37, 0, v37
    ds_read_b64_tr_b16 a[176:177], v37 offset:0
    ds_read_b64_tr_b16 a[178:179], v37 offset:4096
    ds_read_b64_tr_b16 a[180:181], v37 offset:8192
    ds_read_b64_tr_b16 a[182:183], v37 offset:12288
    v_xor_b32 v37, 224, v33
    v_add_u32 v37, v37, v32
    v_add_u32 v37, 0, v37
    ds_read_b64_tr_b16 a[184:185], v37 offset:0
    ds_read_b64_tr_b16 a[186:187], v37 offset:4096
    ds_read_b64_tr_b16 a[188:189], v37 offset:8192
    ds_read_b64_tr_b16 a[190:191], v37 offset:12288
    s_waitcnt lgkmcnt(0)
L_own_50:
    s_waitcnt lgkmcnt(0)
    s_barrier
    s_lshl_b32 s24, s5, 12
    s_add_u32 m0, s24, 0
    s_lshl_b32 s25, s42, 7
    s_add_u32 s25, s25, 917504
    buffer_load_dwordx4 v28, s[36:39], s25 offen lds
    s_lshl_b32 s24, s5, 12
    s_add_u32 m0, s24, 1024
    s_lshl_b32 s25, s42, 7
    s_add_u32 s25, s25, 917504
    buffer_load_dwordx4 v29, s[36:39], s25 offen lds
    s_lshl_b32 s24, s5, 12
    s_add_u32 m0, s24, 2048
    s_lshl_b32 s25, s42, 7
    s_add_u32 s25, s25, 917504
    buffer_load_dwordx4 v30, s[36:39], s25 offen lds
    s_lshl_b32 s24, s5, 12
    s_add_u32 m0, s24, 3072
    s_lshl_b32 s25, s42, 7
    s_add_u32 s25, s25, 917504
    buffer_load_dwordx4 v31, s[36:39], s25 offen lds
    s_waitcnt vmcnt(28)
    s_barrier
    s_cmp_eq_u32 s5, 1
    s_cbranch_scc0 L_own_51
    v_xor_b32 v37, 0, v33
    v_add_u32 v37, v37, v32
    v_add_u32 v37, 16384, v37
    ds_read_b64_tr_b16 a[128:129], v37 offset:0
    ds_read_b64_tr_b16 a[130:131], v37 offset:4096
    ds_read_b64_tr_b16 a[132:133], v37 offset:8192
    ds_read_b64_tr_b16 a[134:135], v37 offset:12288
    v_xor_b32 v37, 32, v33
    v_add_u32 v37, v37, v32
    v_add_u32 v37, 16384, v37
    ds_read_b64_tr_b16 a[136:137], v37 offset:0
    ds_read_b64_tr_b16 a[138:139], v37 offset:4096
    ds_read_b64_tr_b16 a[140:141], v37 offset:8192
    ds_read_b64_tr_b16 a[142:143], v37 offset:12288
    s_waitcnt lgkmcnt(0)
    v_xor_b32 v37, 64, v33
    v_add_u32_e64 v37, v37, v32
    v_add_u32 v37, 16384, v37
    ds_read_b64_tr_b16 a[144:145], v37 offset:0
    ds_read_b64_tr_b16 a[146:147], v37 offset:4096
    ds_read_b64_tr_b16 a[148:149], v37 offset:8192
    ds_read_b64_tr_b16 a[150:151], v37 offset:12288
    v_xor_b32 v37, 96, v33
    v_add_u32_e64 v37, v37, v32
    v_add_u32 v37, 16384, v37
    ds_read_b64_tr_b16 a[152:153], v37 offset:0
    ds_read_b64_tr_b16 a[154:155], v37 offset:4096
    ds_read_b64_tr_b16 a[156:157], v37 offset:8192
    ds_read_b64_tr_b16 a[158:159], v37 offset:12288
    s_waitcnt lgkmcnt(0)
    v_xor_b32 v37, 128, v33
    v_add_u32 v37, v37, v32
    v_add_u32 v37, 16384, v37
    ds_read_b64_tr_b16 a[160:161], v37 offset:0
    ds_read_b64_tr_b16 a[162:163], v37 offset:4096
    ds_read_b64_tr_b16 a[164:165], v37 offset:8192
    ds_read_b64_tr_b16 a[166:167], v37 offset:12288
    v_xor_b32 v37, 160, v33
    v_add_u32_e64 v37, v37, v32
    v_add_u32 v37, 16384, v37
    ds_read_b64_tr_b16 a[168:169], v37 offset:0
    ds_read_b64_tr_b16 a[170:171], v37 offset:4096
    ds_read_b64_tr_b16 a[172:173], v37 offset:8192
    ds_read_b64_tr_b16 a[174:175], v37 offset:12288
    s_waitcnt lgkmcnt(0)
    v_xor_b32 v37, 192, v33
    v_add_u32 v37, v37, v32
    v_add_u32 v37, 16384, v37
    ds_read_b64_tr_b16 a[176:177], v37 offset:0
    ds_read_b64_tr_b16 a[178:179], v37 offset:4096
    ds_read_b64_tr_b16 a[180:181], v37 offset:8192
    ds_read_b64_tr_b16 a[182:183], v37 offset:12288
    v_xor_b32 v37, 224, v33
    v_add_u32_e64 v37, v37, v32
    v_add_u32 v37, 16384, v37
    ds_read_b64_tr_b16 a[184:185], v37 offset:0
    ds_read_b64_tr_b16 a[186:187], v37 offset:4096
    ds_read_b64_tr_b16 a[188:189], v37 offset:8192
    ds_read_b64_tr_b16 a[190:191], v37 offset:12288
    s_waitcnt lgkmcnt(0)
L_own_51:
    s_waitcnt lgkmcnt(0)
    s_barrier
    s_lshl_b32 s24, s5, 12
    s_add_u32 m0, s24, 16384
    s_lshl_b32 s25, s42, 7
    s_nop 0
    s_add_u32 s25, s25, 1146880
    buffer_load_dwordx4 v28, s[36:39], s25 offen lds
    s_lshl_b32 s24, s5, 12
    s_add_u32 m0, s24, 17408
    s_lshl_b32 s25, s42, 7
    s_add_u32 s25, s25, 1146880
    buffer_load_dwordx4 v29, s[36:39], s25 offen lds
    s_lshl_b32 s24, s5, 12
    s_add_u32 m0, s24, 18432
    s_lshl_b32 s25, s42, 7
    s_add_u32 s25, s25, 1146880
    buffer_load_dwordx4 v30, s[36:39], s25 offen lds
    s_lshl_b32 s24, s5, 12
    s_add_u32 m0, s24, 19456
    s_lshl_b32 s25, s42, 7
    s_add_u32 s25, s25, 1146880
    buffer_load_dwordx4 v31, s[36:39], s25 offen lds
    s_waitcnt vmcnt(28)
    s_barrier
    s_cmp_eq_u32 s5, 2
    s_cbranch_scc0 L_own_52
    v_xor_b32 v37, 0, v33
    v_add_u32 v37, v37, v32
    v_add_u32 v37, 32768, v37
    ds_read_b64_tr_b16 a[128:129], v37 offset:0
    ds_read_b64_tr_b16 a[130:131], v37 offset:4096
    ds_read_b64_tr_b16 a[132:133], v37 offset:8192
    ds_read_b64_tr_b16 a[134:135], v37 offset:12288
    v_xor_b32 v37, 32, v33
    v_add_u32 v37, v37, v32
    v_add_u32 v37, 32768, v37
    ds_read_b64_tr_b16 a[136:137], v37 offset:0
    ds_read_b64_tr_b16 a[138:139], v37 offset:4096
    ds_read_b64_tr_b16 a[140:141], v37 offset:8192
    ds_read_b64_tr_b16 a[142:143], v37 offset:12288
    s_waitcnt lgkmcnt(0)
    v_xor_b32 v37, 64, v33
    v_add_u32_e64 v37, v37, v32
    v_add_u32 v37, 32768, v37
    ds_read_b64_tr_b16 a[144:145], v37 offset:0
    ds_read_b64_tr_b16 a[146:147], v37 offset:4096
    ds_read_b64_tr_b16 a[148:149], v37 offset:8192
    ds_read_b64_tr_b16 a[150:151], v37 offset:12288
    v_xor_b32 v37, 96, v33
    v_add_u32_e64 v37, v37, v32
    v_add_u32 v37, 32768, v37
    ds_read_b64_tr_b16 a[152:153], v37 offset:0
    ds_read_b64_tr_b16 a[154:155], v37 offset:4096
    ds_read_b64_tr_b16 a[156:157], v37 offset:8192
    ds_read_b64_tr_b16 a[158:159], v37 offset:12288
    s_waitcnt lgkmcnt(0)
    v_xor_b32 v37, 128, v33
    v_add_u32 v37, v37, v32
    v_add_u32 v37, 32768, v37
    ds_read_b64_tr_b16 a[160:161], v37 offset:0
    ds_read_b64_tr_b16 a[162:163], v37 offset:4096
    ds_read_b64_tr_b16 a[164:165], v37 offset:8192
    ds_read_b64_tr_b16 a[166:167], v37 offset:12288
    v_xor_b32 v37, 160, v33
    v_add_u32_e64 v37, v37, v32
    v_add_u32 v37, 32768, v37
    ds_read_b64_tr_b16 a[168:169], v37 offset:0
    ds_read_b64_tr_b16 a[170:171], v37 offset:4096
    ds_read_b64_tr_b16 a[172:173], v37 offset:8192
    ds_read_b64_tr_b16 a[174:175], v37 offset:12288
    s_waitcnt lgkmcnt(0)
    v_xor_b32 v37, 192, v33
    v_add_u32 v37, v37, v32
    v_add_u32 v37, 32768, v37
    ds_read_b64_tr_b16 a[176:177], v37 offset:0
    ds_read_b64_tr_b16 a[178:179], v37 offset:4096
    ds_read_b64_tr_b16 a[180:181], v37 offset:8192
    ds_read_b64_tr_b16 a[182:183], v37 offset:12288
    v_xor_b32 v37, 224, v33
    v_add_u32_e64 v37, v37, v32
    v_add_u32 v37, 32768, v37
    ds_read_b64_tr_b16 a[184:185], v37 offset:0
    ds_read_b64_tr_b16 a[186:187], v37 offset:4096
    ds_read_b64_tr_b16 a[188:189], v37 offset:8192
    ds_read_b64_tr_b16 a[190:191], v37 offset:12288
    s_waitcnt lgkmcnt(0)
L_own_52:
    s_waitcnt lgkmcnt(0)
    s_barrier
    s_lshl_b32 s24, s5, 12
    s_add_u32 m0, s24, 32768
    s_lshl_b32 s25, s42, 7
    s_nop 0
    s_add_u32 s25, s25, 1376256
    buffer_load_dwordx4 v28, s[36:39], s25 offen lds
    s_lshl_b32 s24, s5, 12
    s_add_u32 m0, s24, 33792
    s_lshl_b32 s25, s42, 7
    s_add_u32 s25, s25, 1376256
    buffer_load_dwordx4 v29, s[36:39], s25 offen lds
    s_lshl_b32 s24, s5, 12
    s_add_u32 m0, s24, 34816
    s_lshl_b32 s25, s42, 7
    s_add_u32 s25, s25, 1376256
    buffer_load_dwordx4 v30, s[36:39], s25 offen lds
    s_lshl_b32 s24, s5, 12
    s_add_u32 m0, s24, 35840
    s_lshl_b32 s25, s42, 7
    s_add_u32 s25, s25, 1376256
    buffer_load_dwordx4 v31, s[36:39], s25 offen lds
    s_waitcnt vmcnt(28)
    s_barrier
    s_cmp_eq_u32 s5, 3
    s_cbranch_scc0 L_own_53
    v_xor_b32 v37, 0, v33
    v_add_u32 v37, v37, v32
    v_add_u32 v37, 49152, v37
    ds_read_b64_tr_b16 a[128:129], v37 offset:0
    ds_read_b64_tr_b16 a[130:131], v37 offset:4096
    ds_read_b64_tr_b16 a[132:133], v37 offset:8192
    ds_read_b64_tr_b16 a[134:135], v37 offset:12288
    v_xor_b32 v37, 32, v33
    v_add_u32 v37, v37, v32
    v_add_u32 v37, 49152, v37
    ds_read_b64_tr_b16 a[136:137], v37 offset:0
    ds_read_b64_tr_b16 a[138:139], v37 offset:4096
    ds_read_b64_tr_b16 a[140:141], v37 offset:8192
    ds_read_b64_tr_b16 a[142:143], v37 offset:12288
    s_waitcnt lgkmcnt(0)
    v_xor_b32 v37, 64, v33
    v_add_u32_e64 v37, v37, v32
    v_add_u32 v37, 49152, v37
    ds_read_b64_tr_b16 a[144:145], v37 offset:0
    ds_read_b64_tr_b16 a[146:147], v37 offset:4096
    ds_read_b64_tr_b16 a[148:149], v37 offset:8192
    ds_read_b64_tr_b16 a[150:151], v37 offset:12288
    v_xor_b32 v37, 96, v33
    v_add_u32_e64 v37, v37, v32
    v_add_u32 v37, 49152, v37
    ds_read_b64_tr_b16 a[152:153], v37 offset:0
    ds_read_b64_tr_b16 a[154:155], v37 offset:4096
    ds_read_b64_tr_b16 a[156:157], v37 offset:8192
    ds_read_b64_tr_b16 a[158:159], v37 offset:12288
    s_waitcnt lgkmcnt(0)
    v_xor_b32 v37, 128, v33
    v_add_u32 v37, v37, v32
    v_add_u32 v37, 49152, v37
    ds_read_b64_tr_b16 a[160:161], v37 offset:0
    ds_read_b64_tr_b16 a[162:163], v37 offset:4096
    ds_read_b64_tr_b16 a[164:165], v37 offset:8192
    ds_read_b64_tr_b16 a[166:167], v37 offset:12288
    v_xor_b32 v37, 160, v33
    v_add_u32_e64 v37, v37, v32
    v_add_u32 v37, 49152, v37
    ds_read_b64_tr_b16 a[168:169], v37 offset:0
    ds_read_b64_tr_b16 a[170:171], v37 offset:4096
    ds_read_b64_tr_b16 a[172:173], v37 offset:8192
    ds_read_b64_tr_b16 a[174:175], v37 offset:12288
    s_waitcnt lgkmcnt(0)
    v_xor_b32 v37, 192, v33
    v_add_u32 v37, v37, v32
    v_add_u32 v37, 49152, v37
    ds_read_b64_tr_b16 a[176:177], v37 offset:0
    ds_read_b64_tr_b16 a[178:179], v37 offset:4096
    ds_read_b64_tr_b16 a[180:181], v37 offset:8192
    ds_read_b64_tr_b16 a[182:183], v37 offset:12288
    v_xor_b32 v37, 224, v33
    v_add_u32_e64 v37, v37, v32
    v_add_u32 v37, 49152, v37
    ds_read_b64_tr_b16 a[184:185], v37 offset:0
    ds_read_b64_tr_b16 a[186:187], v37 offset:4096
    ds_read_b64_tr_b16 a[188:189], v37 offset:8192
    ds_read_b64_tr_b16 a[190:191], v37 offset:12288
    s_waitcnt lgkmcnt(0)
L_own_53:
    s_waitcnt lgkmcnt(0)
    s_barrier
    s_lshl_b32 s24, s5, 12
    s_add_u32 m0, s24, 49152
    s_lshl_b32 s25, s42, 7
    s_nop 0
    s_add_u32 s25, s25, 1605632
    buffer_load_dwordx4 v28, s[36:39], s25 offen lds
    s_lshl_b32 s24, s5, 12
    s_add_u32 m0, s24, 50176
    s_lshl_b32 s25, s42, 7
    s_add_u32 s25, s25, 1605632
    buffer_load_dwordx4 v29, s[36:39], s25 offen lds
    s_lshl_b32 s24, s5, 12
    s_add_u32 m0, s24, 51200
    s_lshl_b32 s25, s42, 7
    s_add_u32 s25, s25, 1605632
    buffer_load_dwordx4 v30, s[36:39], s25 offen lds
    s_lshl_b32 s24, s5, 12
    s_add_u32 m0, s24, 52224
    s_lshl_b32 s25, s42, 7
    s_add_u32 s25, s25, 1605632
    buffer_load_dwordx4 v31, s[36:39], s25 offen lds
    s_waitcnt vmcnt(28)
    s_barrier
    v_add_u32 v37, 65536, v36
    ds_read_b64_tr_b16 a[192:193], v37 offset:0
    ds_read_b64_tr_b16 a[194:195], v37 offset:1024
    ds_read_b64_tr_b16 a[196:197], v37 offset:8192
    ds_read_b64_tr_b16 a[198:199], v37 offset:9216
    s_waitcnt lgkmcnt(0)
    s_barrier
    s_waitcnt vmcnt(24)
    s_barrier
    v_add_u32 v37, 81920, v36
    ds_read_b64_tr_b16 a[200:201], v37 offset:0
    ds_read_b64_tr_b16 a[202:203], v37 offset:1024
    ds_read_b64_tr_b16 a[204:205], v37 offset:8192
    ds_read_b64_tr_b16 a[206:207], v37 offset:9216
    s_waitcnt lgkmcnt(0)
    s_barrier
    s_waitcnt vmcnt(20)
    s_barrier
    v_add_u32 v37, 98304, v36
    ds_read_b64_tr_b16 a[208:209], v37 offset:0
    ds_read_b64_tr_b16 a[210:211], v37 offset:1024
    ds_read_b64_tr_b16 a[212:213], v37 offset:8192
    ds_read_b64_tr_b16 a[214:215], v37 offset:9216
    s_waitcnt lgkmcnt(0)
    s_barrier
    s_waitcnt vmcnt(16)
    s_barrier
    v_add_u32 v37, 114688, v36
    ds_read_b64_tr_b16 a[216:217], v37 offset:0
    ds_read_b64_tr_b16 a[218:219], v37 offset:1024
    ds_read_b64_tr_b16 a[220:221], v37 offset:8192
    ds_read_b64_tr_b16 a[222:223], v37 offset:9216
    s_waitcnt lgkmcnt(0)
    s_barrier
    s_waitcnt vmcnt(12)
    s_barrier
    v_add_u32_e64 v37, 0, v36
    ds_read_b64_tr_b16 a[224:225], v37 offset:0
    ds_read_b64_tr_b16 a[226:227], v37 offset:1024
    ds_read_b64_tr_b16 a[228:229], v37 offset:8192
    ds_read_b64_tr_b16 a[230:231], v37 offset:9216
    s_waitcnt lgkmcnt(0)
    s_barrier
    s_waitcnt vmcnt(8)
    s_barrier
    v_add_u32 v37, 16384, v36
    ds_read_b64_tr_b16 a[232:233], v37 offset:0
    ds_read_b64_tr_b16 a[234:235], v37 offset:1024
    ds_read_b64_tr_b16 a[236:237], v37 offset:8192
    ds_read_b64_tr_b16 a[238:239], v37 offset:9216
    s_waitcnt lgkmcnt(0)
    s_barrier
    s_waitcnt vmcnt(4)
    s_barrier
    v_add_u32 v37, 32768, v36
    ds_read_b64_tr_b16 a[240:241], v37 offset:0
    ds_read_b64_tr_b16 a[242:243], v37 offset:1024
    ds_read_b64_tr_b16 a[244:245], v37 offset:8192
    ds_read_b64_tr_b16 a[246:247], v37 offset:9216
    s_waitcnt lgkmcnt(0)
    s_barrier
    s_waitcnt vmcnt(0)
    s_barrier
    v_add_u32 v37, 49152, v36
    ds_read_b64_tr_b16 a[248:249], v37 offset:0
    ds_read_b64_tr_b16 a[250:251], v37 offset:1024
    ds_read_b64_tr_b16 a[252:253], v37 offset:8192
    ds_read_b64_tr_b16 a[254:255], v37 offset:9216
    s_waitcnt lgkmcnt(0)
    s_barrier
    v_lshrrev_b32 v106, 2, v101
    v_and_b32 v107, 3, v101
    v_lshlrev_b32_e64 v1, 10, v101
    v_lshl_add_u32 v1, v102, 4, v1
    s_lshl_b32 s24, s5, 5
    v_add_u32 v105, s24, v101
    v_lshlrev_b32 v2, 5, v105
    v_add_u32 v105, v102, v106
    v_and_b32_e64 v105, 3, v105
    v_lshl_add_u32 v2, v105, 3, v2
    v_add_u32 v2, 45056, v2
    v_lshl_add_u32 v105, v102, 2, v106
    v_lshlrev_b32 v3, 5, v105
    v_add_u32 v105, v107, v102
    v_and_b32_e64 v105, 3, v105
    v_lshl_add_u32 v3, v105, 3, v3
    v_add_u32 v3, 45056, v3
    v_lshlrev_b32_e64 v4, 15, v101
    v_lshl_add_u32 v4, v102, 4, v4
    v_lshlrev_b32_e64 v5, 10, v102
    v_lshl_add_u32 v5, v101, 4, v5
    v_lshlrev_b32_e64 v6, 6, v106
    v_lshl_add_u32 v6, v102, 5, v6
    v_lshl_add_u32 v6, v107, 3, v6
    s_lshl_b32 s24, s5, 8
    v_add_u32 v6, s24, v6
    v_cmp_lt_u32_e64 vcc, 1, v102
    v_mov_b32 v105, 0x7ff00000
    s_nop 0
    v_cndmask_b32 v6, v6, v105, vcc
    v_and_b32 v103, 1, v101
    v_lshlrev_b32 v103, 4, v103
    v_mov_b32 v104, 0x3f80
    v_lshlrev_b32_e64 v104, v103, v104
    v_bfe_u32 v103, v101, 1, 2
    v_cmp_eq_u32 vcc, 0, v103
    v_mov_b32 v12, 0
    s_nop 0
    v_cndmask_b32 v12, v12, v104, vcc
    v_cmp_eq_u32 vcc, 1, v103
    v_mov_b32 v13, 0
    s_nop 0
    v_cndmask_b32 v13, v13, v104, vcc
    v_cmp_eq_u32 vcc, 2, v103
    v_mov_b32 v14, 0
    s_nop 0
    v_cndmask_b32 v14, v14, v104, vcc
    v_cmp_eq_u32 vcc, 3, v103
    v_mov_b32 v15, 0
    s_nop 0
    v_cndmask_b32 v15, v15, v104, vcc
    s_load_dwordx2 s[56:57], s[0:1], 72
    s_waitcnt lgkmcnt(0)
    s_mov_b32 s36, s56
    s_and_b32 s37, s57, 0xffff
    s_mov_b32 s38, 3584
    s_mov_b32 s39, 0x20000
    s_lshl_b32 s24, s42, 7
    s_lshl_b32 s25, s5, 5
    s_add_u32 s24, s24, s25
    v_lshlrev_b32 v103, 3, v102
    buffer_load_dwordx2 v[104:105], v103, s[36:39], s24 offen
    s_waitcnt vmcnt(0)
    v_lshlrev_b32 v8, 16, v104
    v_and_b32 v9, 0xffff0000, v104
    v_lshlrev_b32_e64 v10, 16, v105
    v_and_b32 v11, 0xffff0000, v105
    v_lshl_add_u32 v103, v102, 2, 0
    v_cmp_le_u32 s[72:73], v103, v101
    v_lshl_add_u32 v103, v102, 2, 1
    v_cmp_le_u32 s[74:75], v103, v101
    v_lshl_add_u32 v103, v102, 2, 2
    v_cmp_le_u32 s[76:77], v103, v101
    v_lshl_add_u32 v103, v102, 2, 3
    v_cmp_le_u32 s[78:79], v103, v101
    s_nop 3
    s_cmp_ge_u32 s5, 2
    s_cselect_b64 s[64:65], -1, s[72:73]
    s_cselect_b64 s[72:73], s[72:73], 0
    s_cselect_b64 s[66:67], -1, s[74:75]
    s_cselect_b64 s[74:75], s[74:75], 0
    s_cselect_b64 s[68:69], -1, s[76:77]
    s_cselect_b64 s[76:77], s[76:77], 0
    s_cselect_b64 s[70:71], -1, s[78:79]
    s_cselect_b64 s[78:79], s[78:79], 0
    v_lshlrev_b32 v0, 4, v100
    v_and_b32 v7, 31, v100
    v_lshlrev_b32_e64 v7, 2, v7
    s_load_dwordx2 s[56:57], s[0:1], 0
    s_waitcnt lgkmcnt(0)
    s_mov_b32 s28, s56
    s_and_b32 s29, s57, 0xffff
    s_mov_b32 s30, 2097152
    s_mov_b32 s31, 0x20000
    s_load_dwordx2 s[56:57], s[0:1], 88
    s_waitcnt lgkmcnt(0)
    s_mov_b32 s32, s56
    s_and_b32 s33, s57, 0xffff
    s_mov_b32 s34, 2097152
    s_mov_b32 s35, 0x20000
    s_mov_b32 s80, 0x3e0293ee
    s_mov_b32 s81, 0x3fb8aa3b
    s_lshr_b32 s24, s5, 1
    s_lshl_b32 s24, s24, 10
    s_and_b32 s25, s5, 1
    s_lshl_b32 s26, s25, 3
    s_add_u32 s24, s24, s26
    s_add_u32 s24, s24, 32768
    v_add_u32 v16, s24, v0
    s_lshr_b32 s24, s5, 1
    s_lshl_b32 s24, s24, 12
    s_lshl_b32 s25, s25, 11
    s_add_u32 s24, s24, s25
    s_add_u32 s24, s24, 36864
    v_add_u32 v17, s24, v0
    s_mov_b32 s20, 0
L_wpw_c0b_54:
    s_cmp_eq_u32 s19, 1
    s_cbranch_scc1 L_wpw_c0b_54_d
    buffer_load_dword v105, off, s[52:55], 32 sc1
    s_waitcnt vmcnt(0)
    v_readfirstlane_b32 s24, v105
    s_nop 3
    s_cmp_ge_u32 s24, 224
    s_cbranch_scc1 L_wpw_c0b_54_d
    s_sleep 4
    s_add_u32 s20, s20, 1
    s_cmp_lt_u32 s20, 524288
    s_cbranch_scc1 L_wpw_c0b_54
    s_mov_b32 s19, 1
L_wpw_c0b_54_d:
    s_mov_b32 s22, s40
    s_mov_b32 s21, 0
    s_barrier
    s_lshl_b32 s25, s22, 15
    s_lshr_b32 s26, s5, 1
    s_lshl_b32 s26, s26, 14
    s_add_u32 s25, s25, s26
    s_and_b32 s26, s5, 1
    s_lshl_b32 s26, s26, 9
    s_add_u32 s25, s25, s26
    s_add_u32 s25, s25, 0
    s_lshl_b32 s24, s5, 13
    s_add_u32 m0, s24, 0
    s_nop 0
    buffer_load_dwordx4 v1, s[8:11], s25 offen lds
    s_add_u32 m0, m0, 1024
    s_add_u32 s25, s25, 64
    s_nop 0
    buffer_load_dwordx4 v1, s[8:11], s25 offen lds
    s_add_u32 m0, m0, 1024
    s_add_u32 s25, s25, 64
    s_nop 0
    buffer_load_dwordx4 v1, s[8:11], s25 offen lds
    s_add_u32 m0, m0, 1024
    s_add_u32 s25, s25, 64
    s_nop 0
    buffer_load_dwordx4 v1, s[8:11], s25 offen lds
    s_add_u32 m0, m0, 1024
    s_add_u32 s25, s25, 64
    s_nop 0
    buffer_load_dwordx4 v1, s[8:11], s25 offen lds
    s_add_u32 m0, m0, 1024
    s_add_u32 s25, s25, 64
    s_nop 0
    buffer_load_dwordx4 v1, s[8:11], s25 offen lds
    s_add_u32 m0, m0, 1024
    s_add_u32 s25, s25, 64
    s_nop 0
    buffer_load_dwordx4 v1, s[8:11], s25 offen lds
    s_add_u32 m0, m0, 1024
    s_add_u32 s25, s25, 64
    s_nop 0
    buffer_load_dwordx4 v1, s[8:11], s25 offen lds
L_w2_loop:
    s_waitcnt vmcnt(0)
    s_barrier
    v_mov_b64 v[128:129], 0
    v_mov_b64 v[130:131], 0
    v_mov_b64 v[132:133], 0
    v_mov_b64 v[134:135], 0
    v_mov_b64 v[136:137], 0
    v_mov_b64 v[138:139], 0
    v_mov_b64 v[140:141], 0
    v_mov_b64 v[142:143], 0
    v_mov_b64 v[144:145], 0
    v_mov_b64 v[146:147], 0
    v_mov_b64 v[148:149], 0
    v_mov_b64 v[150:151], 0
    v_mov_b64 v[152:153], 0
    v_mov_b64 v[154:155], 0
    v_mov_b64 v[156:157], 0
    v_mov_b64 v[158:159], 0
    v_mov_b64 v[160:161], 0
    v_mov_b64 v[162:163], 0
    v_mov_b64 v[164:165], 0
    v_mov_b64 v[166:167], 0
    v_mov_b64 v[168:169], 0
    v_mov_b64 v[170:171], 0
    v_mov_b64 v[172:173], 0
    v_mov_b64 v[174:175], 0
    v_mov_b64 v[176:177], 0
    v_mov_b64 v[178:179], 0
    v_mov_b64 v[180:181], 0
    v_mov_b64 v[182:183], 0
    v_mov_b64 v[184:185], 0
    v_mov_b64 v[186:187], 0
    v_mov_b64 v[188:189], 0
    v_mov_b64 v[190:191], 0
    s_cmp_eq_u32 s41, 0
    s_cbranch_scc1 L_w2_noffn_55
    v_mov_b64 v[48:49], 0
    v_mov_b64 v[50:51], 0
    v_mov_b64 v[52:53], 0
    v_mov_b64 v[54:55], 0
    ds_read_b128 v[32:35], v0 offset:0
    ds_read_b128 v[36:39], v0 offset:16384
    ds_read_b128 v[40:43], v0 offset:1024
    ds_read_b128 v[44:47], v0 offset:17408
    s_waitcnt lgkmcnt(2)
    s_nop 0
    v_mfma_f32_16x16x32_bf16 v[48:51], a[192:195], v[32:35], v[48:51]
    v_mfma_f32_16x16x32_bf16 v[52:55], a[192:195], v[36:39], v[52:55]
    ds_read_b128 v[32:35], v0 offset:2048
    ds_read_b128 v[36:39], v0 offset:18432
    s_waitcnt lgkmcnt(2)
    s_nop 0
    v_mfma_f32_16x16x32_bf16 v[48:51], a[196:199], v[40:43], v[48:51]
    v_mfma_f32_16x16x32_bf16 v[52:55], a[196:199], v[44:47], v[52:55]
    ds_read_b128 v[40:43], v0 offset:3072
    ds_read_b128 v[44:47], v0 offset:19456
    s_waitcnt lgkmcnt(2)
    s_nop 0
    v_mfma_f32_16x16x32_bf16 v[48:51], a[200:203], v[32:35], v[48:51]
    v_mfma_f32_16x16x32_bf16 v[52:55], a[200:203], v[36:39], v[52:55]
    ds_read_b128 v[32:35], v0 offset:4096
    ds_read_b128 v[36:39], v0 offset:20480
    s_waitcnt lgkmcnt(2)
    s_nop 0
    v_mfma_f32_16x16x32_bf16 v[48:51], a[204:207], v[40:43], v[48:51]
    v_mfma_f32_16x16x32_bf16 v[52:55], a[204:207], v[44:47], v[52:55]
    ds_read_b128 v[40:43], v0 offset:5120
    ds_read_b128 v[44:47], v0 offset:21504
    s_waitcnt lgkmcnt(2)
    s_nop 0
    v_mfma_f32_16x16x32_bf16 v[48:51], a[208:211], v[32:35], v[48:51]
    v_mfma_f32_16x16x32_bf16 v[52:55], a[208:211], v[36:39], v[52:55]
    ds_read_b128 v[32:35], v0 offset:6144
    ds_read_b128 v[36:39], v0 offset:22528
    s_waitcnt lgkmcnt(2)
    s_nop 0
    v_mfma_f32_16x16x32_bf16 v[48:51], a[212:215], v[40:43], v[48:51]
    v_mfma_f32_16x16x32_bf16 v[52:55], a[212:215], v[44:47], v[52:55]
    ds_read_b128 v[40:43], v0 offset:7168
    ds_read_b128 v[44:47], v0 offset:23552
    s_waitcnt lgkmcnt(2)
    s_nop 0
    v_mfma_f32_16x16x32_bf16 v[48:51], a[216:219], v[32:35], v[48:51]
    v_mfma_f32_16x16x32_bf16 v[52:55], a[216:219], v[36:39], v[52:55]
    ds_read_b128 v[32:35], v0 offset:8192
    ds_read_b128 v[36:39], v0 offset:24576
    s_waitcnt lgkmcnt(2)
    s_nop 0
    v_mfma_f32_16x16x32_bf16 v[48:51], a[220:223], v[40:43], v[48:51]
    v_mfma_f32_16x16x32_bf16 v[52:55], a[220:223], v[44:47], v[52:55]
    ds_read_b128 v[40:43], v0 offset:9216
    ds_read_b128 v[44:47], v0 offset:25600
    s_waitcnt lgkmcnt(2)
    s_nop 0
    v_mfma_f32_16x16x32_bf16 v[48:51], a[224:227], v[32:35], v[48:51]
    v_mfma_f32_16x16x32_bf16 v[52:55], a[224:227], v[36:39], v[52:55]
    ds_read_b128 v[32:35], v0 offset:10240
    ds_read_b128 v[36:39], v0 offset:26624
    s_waitcnt lgkmcnt(2)
    s_nop 0
    v_mfma_f32_16x16x32_bf16 v[48:51], a[228:231], v[40:43], v[48:51]
    v_mfma_f32_16x16x32_bf16 v[52:55], a[228:231], v[44:47], v[52:55]
    ds_read_b128 v[40:43], v0 offset:11264
    ds_read_b128 v[44:47], v0 offset:27648
    s_waitcnt lgkmcnt(2)
    s_nop 0
    v_mfma_f32_16x16x32_bf16 v[48:51], a[232:235], v[32:35], v[48:51]
    v_mfma_f32_16x16x32_bf16 v[52:55], a[232:235], v[36:39], v[52:55]
    ds_read_b128 v[32:35], v0 offset:12288
    ds_read_b128 v[36:39], v0 offset:28672
    s_waitcnt lgkmcnt(2)
    s_nop 0
    v_mfma_f32_16x16x32_bf16 v[48:51], a[236:239], v[40:43], v[48:51]
    v_mfma_f32_16x16x32_bf16 v[52:55], a[236:239], v[44:47], v[52:55]
    ds_read_b128 v[40:43], v0 offset:13312
    ds_read_b128 v[44:47], v0 offset:29696
    s_waitcnt lgkmcnt(2)
    s_nop 0
    v_mfma_f32_16x16x32_bf16 v[48:51], a[240:243], v[32:35], v[48:51]
    v_mfma_f32_16x16x32_bf16 v[52:55], a[240:243], v[36:39], v[52:55]
    ds_read_b128 v[32:35], v0 offset:14336
    ds_read_b128 v[36:39], v0 offset:30720
    s_waitcnt lgkmcnt(2)
    s_nop 0
    v_mfma_f32_16x16x32_bf16 v[48:51], a[244:247], v[40:43], v[48:51]
    v_mfma_f32_16x16x32_bf16 v[52:55], a[244:247], v[44:47], v[52:55]
    ds_read_b128 v[40:43], v0 offset:15360
    ds_read_b128 v[44:47], v0 offset:31744
    s_waitcnt lgkmcnt(2)
    s_nop 0
    v_mfma_f32_16x16x32_bf16 v[48:51], a[248:251], v[32:35], v[48:51]
    v_mfma_f32_16x16x32_bf16 v[52:55], a[248:251], v[36:39], v[52:55]
    s_waitcnt lgkmcnt(0)
    s_nop 0
    v_mfma_f32_16x16x32_bf16 v[48:51], a[252:255], v[40:43], v[48:51]
    v_mfma_f32_16x16x32_bf16 v[52:55], a[252:255], v[44:47], v[52:55]
    s_nop 7
    v_add_f32 v48, v48, v8
    v_mul_f32_e64 v56, s81, v48
    v_exp_f32 v56, -|v56|
    v_cmp_le_f32 vcc, 0, v48
    v_add_f32 v59, v56, v56
    v_fma_f32 v57, v56, v56, v59
    v_add_f32 v58, 1.0, v59
    v_mul_f32 v59, v59, v56
    v_cndmask_b32 v57, v57, v58, vcc
    v_cndmask_b32 v59, 2.0, v59, vcc
    v_add_f32 v58, v57, v59
    v_rcp_f32 v58, v58
    v_mul_f32 v57, v57, v48
    v_mul_f32 v48, v57, v58
    v_add_f32 v49, v49, v9
    v_mul_f32 v56, s81, v49
    v_exp_f32 v56, -|v56|
    v_cmp_le_f32 vcc, 0, v49
    v_add_f32 v59, v56, v56
    v_fma_f32 v57, v56, v56, v59
    v_add_f32 v58, 1.0, v59
    v_mul_f32 v59, v59, v56
    v_cndmask_b32 v57, v57, v58, vcc
    v_cndmask_b32 v59, 2.0, v59, vcc
    v_add_f32 v58, v57, v59
    v_rcp_f32 v58, v58
    v_mul_f32 v57, v57, v49
    v_mul_f32 v49, v57, v58
    v_add_f32 v50, v50, v10
    v_mul_f32 v56, s81, v50
    v_exp_f32 v56, -|v56|
    v_cmp_le_f32 vcc, 0, v50
    v_add_f32 v59, v56, v56
    v_fma_f32 v57, v56, v56, v59
    v_add_f32 v58, 1.0, v59
    v_mul_f32 v59, v59, v56
    v_cndmask_b32 v57, v57, v58, vcc
    v_cndmask_b32 v59, 2.0, v59, vcc
    v_add_f32 v58, v57, v59
    v_rcp_f32 v58, v58
    v_mul_f32 v57, v57, v50
    v_mul_f32 v50, v57, v58
    v_add_f32 v51, v51, v11
    v_mul_f32 v56, s81, v51
    v_exp_f32 v56, -|v56|
    v_cmp_le_f32 vcc, 0, v51
    v_add_f32 v59, v56, v56
    v_fma_f32 v57, v56, v56, v59
    v_add_f32 v58, 1.0, v59
    v_mul_f32 v59, v59, v56
    v_cndmask_b32 v57, v57, v58, vcc
    v_cndmask_b32 v59, 2.0, v59, vcc
    v_add_f32 v58, v57, v59
    v_rcp_f32 v58, v58
    v_mul_f32 v57, v57, v51
    v_mul_f32 v51, v57, v58
    v_cvt_pk_bf16_f32 v48, v48, v49
    v_cvt_pk_bf16_f32 v49, v50, v51
    ds_write_b64 v16, v[48:49] offset:0
    v_add_f32 v52, v52, v8
    v_mul_f32 v56, s81, v52
    v_exp_f32 v56, -|v56|
    v_cmp_le_f32 vcc, 0, v52
    v_add_f32 v59, v56, v56
    v_fma_f32 v57, v56, v56, v59
    v_add_f32 v58, 1.0, v59
    v_mul_f32 v59, v59, v56
    v_cndmask_b32 v57, v57, v58, vcc
    v_cndmask_b32 v59, 2.0, v59, vcc
    v_add_f32 v58, v57, v59
    v_rcp_f32 v58, v58
    v_mul_f32 v57, v57, v52
    v_mul_f32 v52, v57, v58
    v_add_f32 v53, v53, v9
    v_mul_f32 v56, s81, v53
    v_exp_f32 v56, -|v56|
    v_cmp_le_f32 vcc, 0, v53
    v_add_f32 v59, v56, v56
    v_fma_f32 v57, v56, v56, v59
    v_add_f32 v58, 1.0, v59
    v_mul_f32 v59, v59, v56
    v_cndmask_b32 v57, v57, v58, vcc
    v_cndmask_b32 v59, 2.0, v59, vcc
    v_add_f32 v58, v57, v59
    v_rcp_f32 v58, v58
    v_mul_f32 v57, v57, v53
    v_mul_f32 v53, v57, v58
    v_add_f32 v54, v54, v10
    v_mul_f32 v56, s81, v54
    v_exp_f32 v56, -|v56|
    v_cmp_le_f32 vcc, 0, v54
    v_add_f32 v59, v56, v56
    v_fma_f32 v57, v56, v56, v59
    v_add_f32 v58, 1.0, v59
    v_mul_f32 v59, v59, v56
    v_cndmask_b32 v57, v57, v58, vcc
    v_cndmask_b32 v59, 2.0, v59, vcc
    v_add_f32 v58, v57, v59
    v_rcp_f32 v58, v58
    v_mul_f32 v57, v57, v54
    v_mul_f32 v54, v57, v58
    v_add_f32 v55, v55, v11
    v_mul_f32 v56, s81, v55
    v_exp_f32 v56, -|v56|
    v_cmp_le_f32 vcc, 0, v55
    v_add_f32 v59, v56, v56
    v_fma_f32 v57, v56, v56, v59
    v_add_f32 v58, 1.0, v59
    v_mul_f32 v59, v59, v56
    v_cndmask_b32 v57, v57, v58, vcc
    v_cndmask_b32 v59, 2.0, v59, vcc
    v_add_f32 v58, v57, v59
    v_rcp_f32 v58, v58
    v_mul_f32 v57, v57, v55
    v_mul_f32 v55, v57, v58
    v_cvt_pk_bf16_f32 v52, v52, v53
    v_cvt_pk_bf16_f32 v53, v54, v55
    ds_write_b64 v16, v[52:53] offset:2048
L_w2_noffn_55:
    s_waitcnt lgkmcnt(0)
    s_barrier
    s_add_u32 s27, s22, 4
    s_min_u32 s44, s27, 63
    s_lshl_b32 s25, s44, 15
    s_lshr_b32 s26, s5, 1
    s_lshl_b32 s26, s26, 14
    s_add_u32 s25, s25, s26
    s_and_b32 s26, s5, 1
    s_lshl_b32 s26, s26, 9
    s_add_u32 s25, s25, s26
    s_add_u32 s25, s25, 0
    s_lshl_b32 s24, s5, 13
    s_add_u32 m0, s24, 0
    s_nop 0
    s_nop 0
    buffer_load_dwordx4 v1, s[8:11], s25 offen lds
    s_add_u32 m0, m0, 1024
    s_add_u32 s25, s25, 64
    s_nop 0
    buffer_load_dwordx4 v1, s[8:11], s25 offen lds
    s_add_u32 m0, m0, 1024
    s_add_u32 s25, s25, 64
    s_nop 0
    buffer_load_dwordx4 v1, s[8:11], s25 offen lds
    s_add_u32 m0, m0, 1024
    s_add_u32 s25, s25, 64
    s_nop 0
    buffer_load_dwordx4 v1, s[8:11], s25 offen lds
    s_add_u32 m0, m0, 1024
    s_add_u32 s25, s25, 64
    s_nop 0
    buffer_load_dwordx4 v1, s[8:11], s25 offen lds
    s_add_u32 m0, m0, 1024
    s_add_u32 s25, s25, 64
    s_nop 0
    buffer_load_dwordx4 v1, s[8:11], s25 offen lds
    s_add_u32 m0, m0, 1024
    s_add_u32 s25, s25, 64
    s_nop 0
    buffer_load_dwordx4 v1, s[8:11], s25 offen lds
    s_add_u32 m0, m0, 1024
    s_add_u32 s25, s25, 64
    s_nop 0
    buffer_load_dwordx4 v1, s[8:11], s25 offen lds
    s_cmp_eq_u32 s41, 0
    s_cbranch_scc1 L_w2_noffn2_56
    ds_read_b128 v[32:35], v0 offset:32768
    ds_read_b128 v[36:39], v0 offset:33792
    ds_read_b128 v[40:43], v0 offset:34816
    ds_read_b128 v[44:47], v0 offset:35840
    s_waitcnt lgkmcnt(0)
    s_nop 0
    v_mfma_f32_16x16x32_bf16 v[128:131], a[128:131], v[32:35], v[128:131]
    v_mfma_f32_16x16x32_bf16 v[128:131], a[132:135], v[36:39], v[128:131]
    v_mfma_f32_16x16x32_bf16 v[132:135], a[136:139], v[32:35], v[132:135]
    v_mfma_f32_16x16x32_bf16 v[132:135], a[140:143], v[36:39], v[132:135]
    v_mfma_f32_16x16x32_bf16 v[136:139], a[144:147], v[32:35], v[136:139]
    v_mfma_f32_16x16x32_bf16 v[136:139], a[148:151], v[36:39], v[136:139]
    v_mfma_f32_16x16x32_bf16 v[140:143], a[152:155], v[32:35], v[140:143]
    v_mfma_f32_16x16x32_bf16 v[140:143], a[156:159], v[36:39], v[140:143]
    v_mfma_f32_16x16x32_bf16 v[144:147], a[160:163], v[32:35], v[144:147]
    v_mfma_f32_16x16x32_bf16 v[144:147], a[164:167], v[36:39], v[144:147]
    v_mfma_f32_16x16x32_bf16 v[148:151], a[168:171], v[32:35], v[148:151]
    v_mfma_f32_16x16x32_bf16 v[148:151], a[172:175], v[36:39], v[148:151]
    v_mfma_f32_16x16x32_bf16 v[152:155], a[176:179], v[32:35], v[152:155]
    v_mfma_f32_16x16x32_bf16 v[152:155], a[180:183], v[36:39], v[152:155]
    v_mfma_f32_16x16x32_bf16 v[156:159], a[184:187], v[32:35], v[156:159]
    v_mfma_f32_16x16x32_bf16 v[156:159], a[188:191], v[36:39], v[156:159]
    v_mfma_f32_16x16x32_bf16 v[160:163], a[128:131], v[40:43], v[160:163]
    v_mfma_f32_16x16x32_bf16 v[160:163], a[132:135], v[44:47], v[160:163]
    v_mfma_f32_16x16x32_bf16 v[164:167], a[136:139], v[40:43], v[164:167]
    v_mfma_f32_16x16x32_bf16 v[164:167], a[140:143], v[44:47], v[164:167]
    v_mfma_f32_16x16x32_bf16 v[168:171], a[144:147], v[40:43], v[168:171]
    v_mfma_f32_16x16x32_bf16 v[168:171], a[148:151], v[44:47], v[168:171]
    v_mfma_f32_16x16x32_bf16 v[172:175], a[152:155], v[40:43], v[172:175]
    v_mfma_f32_16x16x32_bf16 v[172:175], a[156:159], v[44:47], v[172:175]
    v_mfma_f32_16x16x32_bf16 v[176:179], a[160:163], v[40:43], v[176:179]
    v_mfma_f32_16x16x32_bf16 v[176:179], a[164:167], v[44:47], v[176:179]
    v_mfma_f32_16x16x32_bf16 v[180:183], a[168:171], v[40:43], v[180:183]
    v_mfma_f32_16x16x32_bf16 v[180:183], a[172:175], v[44:47], v[180:183]
    v_mfma_f32_16x16x32_bf16 v[184:187], a[176:179], v[40:43], v[184:187]
    v_mfma_f32_16x16x32_bf16 v[184:187], a[180:183], v[44:47], v[184:187]
    v_mfma_f32_16x16x32_bf16 v[188:191], a[184:187], v[40:43], v[188:191]
    v_mfma_f32_16x16x32_bf16 v[188:191], a[188:191], v[44:47], v[188:191]
L_w2_noffn2_56:
    s_lshl_b32 s25, s22, 5
    s_add_u32 s25, s25, s4
    s_mov_b32 s46, s25
    s_lshl_b32 s25, s25, 2
    s_add_u32 s45, s25, 61407232
    s_mov_b32 s20, 0
L_wpw_kv_57:
    s_cmp_eq_u32 s19, 1
    s_cbranch_scc1 L_wpw_kv_57_d
    buffer_load_dword v105, off, s[8:11], s45 sc1
    s_waitcnt vmcnt(0)
    v_readfirstlane_b32 s24, v105
    s_nop 3
    s_cmp_eq_u32 s24, 1
    s_cbranch_scc1 L_wpw_kv_57_d
    s_sleep 4
    s_add_u32 s20, s20, 1
    s_cmp_lt_u32 s20, 524288
    s_cbranch_scc1 L_wpw_kv_57
    s_mov_b32 s19, 1
L_wpw_kv_57_d:
    s_add_u32 s45, s45, 8192
    s_mov_b32 s20, 0
L_wpw_kvm_58:
    s_cmp_eq_u32 s19, 1
    s_cbranch_scc1 L_wpw_kvm_58_d
    buffer_load_dword v105, off, s[8:11], s45 sc1
    s_waitcnt vmcnt(0)
    v_readfirstlane_b32 s24, v105
    s_nop 3
    s_cmp_lg_u32 s24, 0
    s_cbranch_scc1 L_wpw_kvm_58_d
    s_sleep 4
    s_add_u32 s20, s20, 1
    s_cmp_lt_u32 s20, 524288
    s_cbranch_scc1 L_wpw_kvm_58
    s_mov_b32 s19, 1
L_wpw_kvm_58_d:
    s_lshl_b32 s45, s46, 13
    s_lshr_b32 s24, s5, 1
    s_lshl_b32 s24, s24, 12
    s_add_u32 s25, s45, s24
    s_add_u32 s25, s25, 2097152
    buffer_load_dwordx4 v[32:35], v0, s[8:11], s25 offen offset:0 sc1
    buffer_load_dwordx4 v[36:39], v0, s[8:11], s25 offen offset:1024 sc1
    buffer_load_dwordx4 v[40:43], v0, s[8:11], s25 offen offset:2048 sc1
    buffer_load_dwordx4 v[44:47], v0, s[8:11], s25 offen offset:3072 sc1
    s_add_u32 s25, s45, 18874368
    buffer_load_dwordx4 v[48:51], v0, s[8:11], s25 offen offset:0 sc1
    buffer_load_dwordx4 v[52:55], v0, s[8:11], s25 offen offset:1024 sc1
    buffer_load_dwordx4 v[56:59], v0, s[8:11], s25 offen offset:2048 sc1
    buffer_load_dwordx4 v[60:63], v0, s[8:11], s25 offen offset:3072 sc1
    s_add_u32 s25, s25, 4096
    buffer_load_dwordx4 v[64:67], v0, s[8:11], s25 offen offset:0 sc1
    buffer_load_dwordx4 v[68:71], v0, s[8:11], s25 offen offset:1024 sc1
    buffer_load_dwordx4 v[72:75], v0, s[8:11], s25 offen offset:2048 sc1
    buffer_load_dwordx4 v[76:79], v0, s[8:11], s25 offen offset:3072 sc1
    s_and_b32 s24, s5, 1
    s_lshl_b32 s26, s24, 12
    s_add_u32 s25, s45, s26
    s_nop 0
    s_add_u32 s25, s25, 35651584
    buffer_load_dwordx4 v[80:83], v0, s[8:11], s25 offen offset:0 sc1
    buffer_load_dwordx4 v[84:87], v0, s[8:11], s25 offen offset:1024 sc1
    buffer_load_dwordx4 v[88:91], v0, s[8:11], s25 offen offset:2048 sc1
    buffer_load_dwordx4 v[92:95], v0, s[8:11], s25 offen offset:3072 sc1
    s_lshl_b32 s45, s46, 12
    s_add_u32 s45, s45, 52428800
    s_lshl_b32 s25, s5, 10
    s_add_u32 s25, s25, s45
    buffer_load_dwordx2 v[96:97], v0, s[8:11], s25 offen sc1
    s_lshl_b32 s25, s24, 11
    s_add_u32 s25, s25, s45
    s_nop 0
    buffer_load_dwordx2 v[98:99], v0, s[8:11], s25 offen offset:8 sc1
    buffer_load_dwordx2 v[100:101], v0, s[8:11], s25 offen offset:1032 sc1
    s_waitcnt vmcnt(2)
    s_nop 0
    ds_write_b32 v2, v96
    ds_write_b32 v2, v97 offset:512
    s_waitcnt vmcnt(0) lgkmcnt(0)
    s_barrier
    ds_read_b64_tr_b16 v[104:105], v3 offset:0
    ds_read_b64_tr_b16 v[106:107], v3 offset:512
    ds_read_b64_tr_b16 v[108:109], v3 offset:1024
    ds_read_b64_tr_b16 v[110:111], v3 offset:1536
    ds_read_b64_tr_b16 v[112:113], v3 offset:2048
    ds_read_b64_tr_b16 v[114:115], v3 offset:2560
    ds_read_b64_tr_b16 v[116:117], v3 offset:3072
    ds_read_b64_tr_b16 v[118:119], v3 offset:3584
    v_mfma_f32_16x16x32_bf16 v[20:23], v[48:51], v[32:35], 0
    v_mfma_f32_16x16x32_bf16 v[24:27], v[64:67], v[32:35], 0
    v_mfma_f32_16x16x32_bf16 v[20:23], v[52:55], v[36:39], v[20:23]
    v_mfma_f32_16x16x32_bf16 v[24:27], v[68:71], v[36:39], v[24:27]
    v_mfma_f32_16x16x32_bf16 v[20:23], v[56:59], v[40:43], v[20:23]
    v_mfma_f32_16x16x32_bf16 v[24:27], v[72:75], v[40:43], v[24:27]
    v_mfma_f32_16x16x32_bf16 v[20:23], v[60:63], v[44:47], v[20:23]
    v_mfma_f32_16x16x32_bf16 v[24:27], v[76:79], v[44:47], v[24:27]
    s_waitcnt lgkmcnt(0)
    s_nop 0
    v_mfma_f32_16x16x32_bf16 v[28:31], v[104:107], v[32:35], 0
    v_mfma_f32_16x16x32_bf16 v[28:31], v[108:111], v[36:39], v[28:31]
    v_mfma_f32_16x16x32_bf16 v[28:31], v[112:115], v[40:43], v[28:31]
    v_mfma_f32_16x16x32_bf16 v[28:31], v[116:119], v[44:47], v[28:31]
    v_mov_b32 v120, 0xf149f2ca
    s_nop 6
    s_nop 0
    v_cndmask_b32 v20, v120, v20, s[64:65]
    v_cndmask_b32 v24, v120, v24, s[72:73]
    v_cndmask_b32 v21, v120, v21, s[66:67]
    v_cndmask_b32 v25, v120, v25, s[74:75]
    v_cndmask_b32 v22, v120, v22, s[68:69]
    v_cndmask_b32 v26, v120, v26, s[76:77]
    v_cndmask_b32 v23, v120, v23, s[70:71]
    v_cndmask_b32 v27, v120, v27, s[78:79]
    v_max3_f32 v121, v20, v21, v22
    v_max3_f32 v122, v23, v24, v25
    v_max3_f32 v121, v121, v26, v27
    v_max3_f32 v122, v122, v28, v29
    v_max_f32 v121, v121, v122
    v_mov_b32 v122, v121
    s_nop 1
    v_permlane32_swap_b32 v121, v122
    v_max_f32 v121, v121, v122
    v_mov_b32 v122, v121
    s_nop 1
    v_permlane16_swap_b32 v121, v122
    v_max_f32 v121, v121, v122
    v_mul_f32 v121, s80, v121
    v_fma_f32 v20, v20, s80, -v121
    v_fma_f32 v21, v21, s80, -v121
    v_fma_f32 v22, v22, s80, -v121
    v_fma_f32 v23, v23, s80, -v121
    v_fma_f32 v24, v24, s80, -v121
    v_fma_f32 v25, v25, s80, -v121
    v_fma_f32 v26, v26, s80, -v121
    v_fma_f32 v27, v27, s80, -v121
    v_fma_f32 v28, v28, s80, -v121
    v_fma_f32 v29, v29, s80, -v121
    v_exp_f32 v20, v20
    v_exp_f32 v21, v21
    v_exp_f32 v22, v22
    v_exp_f32 v23, v23
    v_exp_f32 v24, v24
    v_exp_f32 v25, v25
    v_exp_f32 v26, v26
    v_exp_f32 v27, v27
    v_exp_f32 v28, v28
    v_exp_f32_e64 v29, v29
    s_nop 0
    v_cvt_pk_bf16_f32 v32, v20, v21
    v_cvt_pk_bf16_f32 v33, v22, v23
    v_cvt_pk_bf16_f32 v34, v24, v25
    v_cvt_pk_bf16_f32 v35, v26, v27
    v_cvt_pk_bf16_f32 v36, v28, v29
    v_cvt_pk_bf16_f32 v39, v28, v29
    v_mov_b32 v37, 0
    v_mov_b32_e64 v38, 0
    s_nop 1
    v_mfma_f32_16x16x32_bf16 v[48:51], v[80:83], v[32:35], 0
    v_mfma_f32_16x16x32_bf16 v[52:55], v[84:87], v[32:35], 0
    v_mfma_f32_16x16x32_bf16 v[56:59], v[88:91], v[32:35], 0
    v_mfma_f32_16x16x32_bf16 v[60:63], v[92:95], v[32:35], 0
    v_mfma_f32_16x16x16_bf16 v[48:51], v[98:99], v[36:37], v[48:51]
    v_mfma_f32_16x16x16_bf16 v[52:55], v[98:99], v[38:39], v[52:55]
    v_mfma_f32_16x16x16_bf16 v[56:59], v[100:101], v[36:37], v[56:59]
    v_mfma_f32_16x16x16_bf16 v[60:63], v[100:101], v[38:39], v[60:63]
    v_add_f32 v123, v20, v21
    v_add_f32 v123, v123, v22
    v_add_f32 v123, v123, v23
    v_add_f32 v123, v123, v24
    v_add_f32 v123, v123, v25
    v_add_f32 v123, v123, v26
    v_add_f32 v123, v123, v27
    v_add_f32 v123, v123, v28
    v_add_f32 v123, v123, v29
    v_mov_b32 v124, v123
    s_nop 1
    v_permlane32_swap_b32 v123, v124
    v_add_f32 v123, v123, v124
    v_mov_b32 v124, v123
    s_nop 1
    v_permlane16_swap_b32 v123, v124
    v_add_f32 v123, v123, v124
    v_rcp_f32 v123, v123
    s_nop 3
    v_mul_f32 v48, v48, v123
    v_mul_f32 v49, v49, v123
    v_mul_f32 v50, v50, v123
    v_mul_f32 v51, v51, v123
    v_mul_f32 v52, v52, v123
    v_mul_f32 v53, v53, v123
    v_mul_f32 v54, v54, v123
    v_mul_f32 v55, v55, v123
    v_mul_f32 v56, v56, v123
    v_mul_f32 v57, v57, v123
    v_mul_f32 v58, v58, v123
    v_mul_f32 v59, v59, v123
    v_mul_f32 v60, v60, v123
    v_mul_f32 v61, v61, v123
    v_mul_f32 v62, v62, v123
    v_mul_f32_e64 v63, v63, v123
    v_cvt_pk_bf16_f32 v48, v48, v49
    v_cvt_pk_bf16_f32 v49, v50, v51
    ds_write_b64 v17, v[48:49] offset:0
    v_cvt_pk_bf16_f32 v52, v52, v53
    v_cvt_pk_bf16_f32 v53, v54, v55
    ds_write_b64 v17, v[52:53] offset:8
    v_cvt_pk_bf16_f32 v56, v56, v57
    v_cvt_pk_bf16_f32 v57, v58, v59
    ds_write_b64 v17, v[56:57] offset:1024
    v_cvt_pk_bf16_f32 v60, v60, v61
    v_cvt_pk_bf16_f32 v61, v62, v63
    ds_write_b64 v17, v[60:61] offset:1032
    s_waitcnt lgkmcnt(0)
    s_barrier
    ds_read_b128 v[64:67], v0 offset:36864
    ds_read_b128 v[68:71], v0 offset:37888
    ds_read_b128 v[72:75], v0 offset:38912
    ds_read_b128 v[76:79], v0 offset:39936
    ds_read_b128 v[80:83], v0 offset:40960
    ds_read_b128 v[84:87], v0 offset:41984
    ds_read_b128 v[88:91], v0 offset:43008
    ds_read_b128 v[92:95], v0 offset:44032
    s_waitcnt lgkmcnt(0)
    s_nop 0
    v_mfma_f32_16x16x32_bf16 v[128:131], a[0:3], v[64:67], v[128:131]
    v_mfma_f32_16x16x32_bf16 v[128:131], a[4:7], v[68:71], v[128:131]
    v_mfma_f32_16x16x32_bf16 v[128:131], a[8:11], v[72:75], v[128:131]
    v_mfma_f32_16x16x32_bf16 v[128:131], a[12:15], v[76:79], v[128:131]
    v_mfma_f32_16x16x32_bf16 v[132:135], a[16:19], v[64:67], v[132:135]
    v_mfma_f32_16x16x32_bf16 v[132:135], a[20:23], v[68:71], v[132:135]
    v_mfma_f32_16x16x32_bf16 v[132:135], a[24:27], v[72:75], v[132:135]
    v_mfma_f32_16x16x32_bf16 v[132:135], a[28:31], v[76:79], v[132:135]
    v_mfma_f32_16x16x32_bf16 v[136:139], a[32:35], v[64:67], v[136:139]
    v_mfma_f32_16x16x32_bf16 v[136:139], a[36:39], v[68:71], v[136:139]
    v_mfma_f32_16x16x32_bf16 v[136:139], a[40:43], v[72:75], v[136:139]
    v_mfma_f32_16x16x32_bf16 v[136:139], a[44:47], v[76:79], v[136:139]
    v_mfma_f32_16x16x32_bf16 v[140:143], a[48:51], v[64:67], v[140:143]
    v_mfma_f32_16x16x32_bf16 v[140:143], a[52:55], v[68:71], v[140:143]
    v_mfma_f32_16x16x32_bf16 v[140:143], a[56:59], v[72:75], v[140:143]
    v_mfma_f32_16x16x32_bf16 v[140:143], a[60:63], v[76:79], v[140:143]
    v_mfma_f32_16x16x32_bf16 v[144:147], a[64:67], v[64:67], v[144:147]
    v_mfma_f32_16x16x32_bf16 v[144:147], a[68:71], v[68:71], v[144:147]
    v_mfma_f32_16x16x32_bf16 v[144:147], a[72:75], v[72:75], v[144:147]
    v_mfma_f32_16x16x32_bf16 v[144:147], a[76:79], v[76:79], v[144:147]
    v_mfma_f32_16x16x32_bf16 v[148:151], a[80:83], v[64:67], v[148:151]
    v_mfma_f32_16x16x32_bf16 v[148:151], a[84:87], v[68:71], v[148:151]
    v_mfma_f32_16x16x32_bf16 v[148:151], a[88:91], v[72:75], v[148:151]
    v_mfma_f32_16x16x32_bf16 v[148:151], a[92:95], v[76:79], v[148:151]
    v_mfma_f32_16x16x32_bf16 v[152:155], a[96:99], v[64:67], v[152:155]
    v_mfma_f32_16x16x32_bf16 v[152:155], a[100:103], v[68:71], v[152:155]
    v_mfma_f32_16x16x32_bf16 v[152:155], a[104:107], v[72:75], v[152:155]
    v_mfma_f32_16x16x32_bf16 v[152:155], a[108:111], v[76:79], v[152:155]
    v_mfma_f32_16x16x32_bf16 v[156:159], a[112:115], v[64:67], v[156:159]
    v_mfma_f32_16x16x32_bf16 v[156:159], a[116:119], v[68:71], v[156:159]
    v_mfma_f32_16x16x32_bf16 v[156:159], a[120:123], v[72:75], v[156:159]
    v_mfma_f32_16x16x32_bf16 v[156:159], a[124:127], v[76:79], v[156:159]
    v_mfma_f32_16x16x32_bf16 v[160:163], a[0:3], v[80:83], v[160:163]
    v_mfma_f32_16x16x32_bf16 v[160:163], a[4:7], v[84:87], v[160:163]
    v_mfma_f32_16x16x32_bf16 v[160:163], a[8:11], v[88:91], v[160:163]
    v_mfma_f32_16x16x32_bf16 v[160:163], a[12:15], v[92:95], v[160:163]
    v_mfma_f32_16x16x32_bf16 v[164:167], a[16:19], v[80:83], v[164:167]
    v_mfma_f32_16x16x32_bf16 v[164:167], a[20:23], v[84:87], v[164:167]
    v_mfma_f32_16x16x32_bf16 v[164:167], a[24:27], v[88:91], v[164:167]
    v_mfma_f32_16x16x32_bf16 v[164:167], a[28:31], v[92:95], v[164:167]
    v_mfma_f32_16x16x32_bf16 v[168:171], a[32:35], v[80:83], v[168:171]
    v_mfma_f32_16x16x32_bf16 v[168:171], a[36:39], v[84:87], v[168:171]
    v_mfma_f32_16x16x32_bf16 v[168:171], a[40:43], v[88:91], v[168:171]
    v_mfma_f32_16x16x32_bf16 v[168:171], a[44:47], v[92:95], v[168:171]
    v_mfma_f32_16x16x32_bf16 v[172:175], a[48:51], v[80:83], v[172:175]
    v_mfma_f32_16x16x32_bf16 v[172:175], a[52:55], v[84:87], v[172:175]
    v_mfma_f32_16x16x32_bf16 v[172:175], a[56:59], v[88:91], v[172:175]
    v_mfma_f32_16x16x32_bf16 v[172:175], a[60:63], v[92:95], v[172:175]
    v_mfma_f32_16x16x32_bf16 v[176:179], a[64:67], v[80:83], v[176:179]
    v_mfma_f32_16x16x32_bf16 v[176:179], a[68:71], v[84:87], v[176:179]
    v_mfma_f32_16x16x32_bf16 v[176:179], a[72:75], v[88:91], v[176:179]
    v_mfma_f32_16x16x32_bf16 v[176:179], a[76:79], v[92:95], v[176:179]
    v_mfma_f32_16x16x32_bf16 v[180:183], a[80:83], v[80:83], v[180:183]
    v_mfma_f32_16x16x32_bf16 v[180:183], a[84:87], v[84:87], v[180:183]
    v_mfma_f32_16x16x32_bf16 v[180:183], a[88:91], v[88:91], v[180:183]
    v_mfma_f32_16x16x32_bf16 v[180:183], a[92:95], v[92:95], v[180:183]
    v_mfma_f32_16x16x32_bf16 v[184:187], a[96:99], v[80:83], v[184:187]
    v_mfma_f32_16x16x32_bf16 v[184:187], a[100:103], v[84:87], v[184:187]
    v_mfma_f32_16x16x32_bf16 v[184:187], a[104:107], v[88:91], v[184:187]
    v_mfma_f32_16x16x32_bf16 v[184:187], a[108:111], v[92:95], v[184:187]
    v_mfma_f32_16x16x32_bf16 v[188:191], a[112:115], v[80:83], v[188:191]
    v_mfma_f32_16x16x32_bf16 v[188:191], a[116:119], v[84:87], v[188:191]
    v_mfma_f32_16x16x32_bf16 v[188:191], a[120:123], v[88:91], v[188:191]
    v_mfma_f32_16x16x32_bf16 v[188:191], a[124:127], v[92:95], v[188:191]
    s_nop 7
    s_and_b32 s24, s21, 1
    s_lshl_b32 s24, s24, 20
    s_lshl_b32 s25, s40, 21
    s_add_u32 s24, s24, s25
    s_add_u32 s47, s24, 61865984
    s_lshl_b32 s24, s4, 10
    s_lshl_b32 s25, s5, 8
    s_add_u32 s24, s24, s25
    s_add_u32 s24, s24, s47
    s_nop 0
    v_cvt_pk_bf16_f32 v32, v128, v129
    v_cvt_pk_bf16_f32 v33, v130, v131
    v_cvt_pk_bf16_f32 v34, v132, v133
    v_cvt_pk_bf16_f32 v35, v134, v135
    buffer_store_dwordx4 v[32:35], v4, s[8:11], s24 offen offset:0 sc1
    v_cvt_pk_bf16_f32 v36, v136, v137
    v_cvt_pk_bf16_f32 v37, v138, v139
    v_cvt_pk_bf16_f32 v38, v140, v141
    v_cvt_pk_bf16_f32 v39, v142, v143
    buffer_store_dwordx4 v[36:39], v4, s[8:11], s24 offen offset:64 sc1
    v_cvt_pk_bf16_f32 v40, v144, v145
    v_cvt_pk_bf16_f32 v41, v146, v147
    v_cvt_pk_bf16_f32 v42, v148, v149
    v_cvt_pk_bf16_f32 v43, v150, v151
    buffer_store_dwordx4 v[40:43], v4, s[8:11], s24 offen offset:128 sc1
    v_cvt_pk_bf16_f32 v44, v152, v153
    v_cvt_pk_bf16_f32 v45, v154, v155
    v_cvt_pk_bf16_f32 v46, v156, v157
    v_cvt_pk_bf16_f32 v47, v158, v159
    buffer_store_dwordx4 v[44:47], v4, s[8:11], s24 offen offset:192 sc1
    s_add_u32 s24, s24, 524288
    v_cvt_pk_bf16_f32 v48, v160, v161
    v_cvt_pk_bf16_f32 v49, v162, v163
    v_cvt_pk_bf16_f32 v50, v164, v165
    v_cvt_pk_bf16_f32 v51, v166, v167
    buffer_store_dwordx4 v[48:51], v4, s[8:11], s24 offen offset:0 sc1
    v_cvt_pk_bf16_f32 v52, v168, v169
    v_cvt_pk_bf16_f32 v53, v170, v171
    v_cvt_pk_bf16_f32 v54, v172, v173
    v_cvt_pk_bf16_f32 v55, v174, v175
    buffer_store_dwordx4 v[52:55], v4, s[8:11], s24 offen offset:64 sc1
    v_cvt_pk_bf16_f32 v56, v176, v177
    v_cvt_pk_bf16_f32 v57, v178, v179
    v_cvt_pk_bf16_f32 v58, v180, v181
    v_cvt_pk_bf16_f32 v59, v182, v183
    buffer_store_dwordx4 v[56:59], v4, s[8:11], s24 offen offset:128 sc1
    v_cvt_pk_bf16_f32 v60, v184, v185
    v_cvt_pk_bf16_f32 v61, v186, v187
    v_cvt_pk_bf16_f32 v62, v188, v189
    v_cvt_pk_bf16_f32 v63, v190, v191
    buffer_store_dwordx4 v[60:63], v4, s[8:11], s24 offen offset:192 sc1
    s_lshl_b32 s25, s22, 5
    s_add_u32 s25, s25, s4
    s_lshl_b32 s46, s25, 10
    buffer_load_dwordx2 v[64:65], v6, s[28:31], s46 offen
    s_waitcnt vmcnt(0)
    s_barrier
    s_add_u32 s21, s21, 1
    s_lshl_b32 s45, s40, 7
    s_add_u32 s45, s45, 61423616
    s_cmp_eq_u32 s5, 0
    s_cbranch_scc0 L_w2_flag_59
    v_mov_b32 v105, s21
    s_lshl_b32 s24, s4, 2
    s_add_u32 s24, s24, s45
    buffer_store_dword v105, off, s[8:11], s24
L_w2_flag_59:
    s_mov_b32 s20, 0
L_w2_poll_60:
    s_cmp_eq_u32 s19, 1
    s_cbranch_scc1 L_w2_poll_60_d
    buffer_load_dword v104, v7, s[8:11], s45 offen sc1
    s_waitcnt vmcnt(0)
    v_cmp_gt_u32 vcc, s21, v104
    s_cbranch_vccz L_w2_poll_60_d
    s_sleep 1
    s_add_u32 s20, s20, 1
    s_cmp_lt_u32 s20, 524288
    s_cbranch_scc1 L_w2_poll_60
    s_mov_b32 s19, 1
L_w2_poll_60_d:
    s_lshl_b32 s24, s4, 15
    s_lshl_b32 s25, s5, 8
    s_add_u32 s24, s24, s25
    s_add_u32 s24, s24, s47
    buffer_load_dwordx4 v[32:35], v5, s[8:11], s24 offen sc1
    s_add_u32 s24, s24, 4096
    buffer_load_dwordx4 v[36:39], v5, s[8:11], s24 offen sc1
    s_add_u32 s24, s24, 4096
    buffer_load_dwordx4 v[40:43], v5, s[8:11], s24 offen sc1
    s_add_u32 s24, s24, 4096
    buffer_load_dwordx4 v[44:47], v5, s[8:11], s24 offen sc1
    s_add_u32 s24, s24, 4096
    buffer_load_dwordx4 v[48:51], v5, s[8:11], s24 offen sc1
    s_add_u32 s24, s24, 4096
    buffer_load_dwordx4 v[52:55], v5, s[8:11], s24 offen sc1
    s_add_u32 s24, s24, 4096
    buffer_load_dwordx4 v[56:59], v5, s[8:11], s24 offen sc1
    s_add_u32 s24, s24, 4096
    buffer_load_dwordx4 v[60:63], v5, s[8:11], s24 offen sc1
    s_waitcnt vmcnt(7)
    v_mfma_f32_16x16x32_bf16 v[68:71], v[12:15], v[32:35], 0
    s_waitcnt vmcnt(6)
    v_mfma_f32_16x16x32_bf16 v[68:71], v[12:15], v[36:39], v[68:71]
    s_waitcnt vmcnt(5)
    v_mfma_f32_16x16x32_bf16 v[68:71], v[12:15], v[40:43], v[68:71]
    s_waitcnt vmcnt(4)
    v_mfma_f32_16x16x32_bf16 v[68:71], v[12:15], v[44:47], v[68:71]
    s_waitcnt vmcnt(3)
    v_mfma_f32_16x16x32_bf16 v[68:71], v[12:15], v[48:51], v[68:71]
    s_waitcnt vmcnt(2)
    v_mfma_f32_16x16x32_bf16 v[68:71], v[12:15], v[52:55], v[68:71]
    s_waitcnt vmcnt(1)
    v_mfma_f32_16x16x32_bf16 v[68:71], v[12:15], v[56:59], v[68:71]
    s_waitcnt vmcnt(0)
    v_mfma_f32_16x16x32_bf16 v[68:71], v[12:15], v[60:63], v[68:71]
    v_lshlrev_b32_e64 v72, 16, v64
    v_and_b32 v73, 0xffff0000, v64
    v_lshlrev_b32_e64 v74, 16, v65
    v_and_b32 v75, 0xffff0000, v65
    s_nop 4
    v_add_f32 v68, v68, v72
    v_add_f32 v69, v69, v73
    v_add_f32 v70, v70, v74
    v_add_f32_e64 v71, v71, v75
    v_cvt_pk_bf16_f32 v68, v68, v69
    v_cvt_pk_bf16_f32 v69, v70, v71
    buffer_store_dwordx2 v[68:69], v6, s[32:35], s46 offen sc1
    s_add_u32 s22, s22, 4
    s_cmp_lt_u32 s22, 64
    s_cbranch_scc1 L_w2_loop
    s_waitcnt vmcnt(0)
    s_mov_b32 s94, s92
L_fin_all:
L_end:
    s_endpgm

.section .rodata,"a"
.p2align 6
.amdhsa_kernel parallel_sum__memory_aug_recurrent_mem_tr__dense_activation_mish__prompt_kernel
  .amdhsa_next_free_vgpr 512
  .amdhsa_next_free_sgpr 96
  .amdhsa_accum_offset 256
  .amdhsa_group_segment_fixed_size 0
  .amdhsa_kernarg_size 112
  .amdhsa_user_sgpr_count 2
  .amdhsa_user_sgpr_kernarg_segment_ptr 1
  .amdhsa_system_sgpr_workgroup_id_x 1
  .amdhsa_float_denorm_mode_32 3
.end_amdhsa_kernel
```
